```python
import torch

def _softmax(x, axis=-1):
    return torch.softmax(x, dim=axis)

def _gelu(x):
    return torch.nn.functional.gelu(x, approximate='tanh')

def _silu(x):
    return torch.nn.functional.silu(x)

def _sigmoid(x):
    return torch.sigmoid(x)

def _layernorm(x, axis=-1, eps=1e-05):
    m = x.mean(dim=axis, keepdim=True)
    v = x.var(dim=axis, keepdim=True, unbiased=False)
    return (x - m) / torch.sqrt(v + eps)

def _scatter_add(tgt, idx, src, axis=0):
    return tgt.clone().index_add_(axis, idx, src)

def _segment_sum(src, seg, n):
    out = torch.zeros((n,) + src.shape[1:], dtype=src.dtype)
    return out.index_add_(0, seg, src)

def _pad(x, pw):
    flat = tuple((v for pair in reversed(pw) for v in pair))
    return torch.nn.functional.pad(x, flat)
kernel_name = 'interleave_layers__sliding_local_dilated__memory_aug_recurrent_mem_tr__prompt'

def setup_inputs():

    _w = lambda a: (lambda t: t.to(torch.bfloat16) if t.is_floating_point() else t)(torch.as_tensor(a))

    def _A_setup():
        B, S, D = (1, 2048, 512)
        return {'x': _w((lambda *s: torch.randn(*s, dtype=torch.bfloat16) * 0.05)(B, S, D)), 'wqkv': _w((lambda *s: torch.randn(*s, dtype=torch.bfloat16) * 0.05)(D, 3 * D)), 'wo': _w((lambda *s: torch.randn(*s, dtype=torch.bfloat16) * 0.05)(D, D))}
    _A_in = _A_setup()

    def _B_setup():
        B, S, Dm = (1, 2048, 512)
        H, Dh = (32, 128)
        M, seg = (8, 32)
        seg = min(seg, S)
        S = S // seg * seg
        return {'x': _w((lambda *s: torch.randn(*s, dtype=torch.bfloat16) * 0.05)(B, S, Dm)), 'mem0': _w((lambda *s: torch.randn(*s, dtype=torch.bfloat16) * 0.8)(B, M, Dm)), 'Wq': _w((lambda *s: torch.randn(*s, dtype=torch.bfloat16) * 1.6)(Dm, H, Dh) * Dm ** (-0.5)), 'Wk': _w((lambda *s: torch.randn(*s, dtype=torch.bfloat16) * 1.6)(Dm, H, Dh) * Dm ** (-0.5)), 'Wv': _w((lambda *s: torch.randn(*s, dtype=torch.bfloat16) * 0.8)(Dm, H, Dh) * Dm ** (-0.5)), 'Wo': _w((lambda *s: torch.randn(*s, dtype=torch.bfloat16) * 0.8)(H, Dh, Dm) * (H * Dh) ** (-0.5)), 'seg_len': seg}
    _B_in = _B_setup()
    return {'A_x': _A_in['x'], 'A_wqkv': _A_in['wqkv'], 'A_wo': _A_in['wo'], 'B_x': _B_in['x'], 'B_mem0': _B_in['mem0'], 'B_Wq': _B_in['Wq'], 'B_Wk': _B_in['Wk'], 'B_Wv': _B_in['Wv'], 'B_Wo': _B_in['Wo'], 'B_seg_len': _B_in['seg_len']}

def reference(A_x, A_wqkv, A_wo, B_x, B_mem0, B_Wq, B_Wk, B_Wv, B_Wo, B_seg_len):

    def _A_ref(x, wqkv, wo):
        B, S, D = x.shape
        H = 32
        Dh = D // H
        W, dil = (8, 2)
        qkv = (lambda x, *d: x.permute(*d))((x @ wqkv).reshape(B, S, 3, H, Dh), 2, 0, 3, 1, 4)
        q, k, v = (qkv[0], qkv[1], qkv[2])
        scale = Dh ** (-0.5)
        pos = torch.arange(S)
        off = torch.arange(W) * dil
        idx = pos[:, None] - off[None, :]
        mask = idx >= 0
        idx_c = torch.where(mask, idx, 0).reshape(-1)
        kg = k[:, :, idx_c, :].reshape(B, H, S, W, Dh)
        vg = v[:, :, idx_c, :].reshape(B, H, S, W, Dh)
        logits = torch.einsum('bhsd,bhswd->bhsw', q, kg) * scale
        logits = torch.where(mask[None, None, :, :], logits, -1000000000.0)
        attn = _softmax(logits, axis=-1)
        o = torch.einsum('bhsw,bhswd->bhsd', attn, vg)
        return (lambda x, *d: x.permute(*d))(o, 0, 2, 1, 3).reshape(B, S, D) @ wo

    def _B_ref(x, mem0, Wq, Wk, Wv, Wo, seg_len):
        B, S, Dm = x.shape
        H, Dh = (Wq.shape[1], Wq.shape[2])
        M = mem0.shape[1]
        scale = Dh ** (-0.5)
        n_seg = S // seg_len
        L = M + seg_len
        idx = torch.arange(L)
        mask = (idx[:, None] < M) | (idx[:, None] >= idx[None, :])
        mem = mem0
        outs = []
        for s in range(n_seg):
            xs = x[:, s * seg_len:(s + 1) * seg_len, :].clone()
            h = torch.concatenate([mem, xs], axis=1)
            q = torch.einsum('btd,dhe->bhte', h, Wq)
            k = torch.einsum('btd,dhe->bhte', h, Wk)
            v = torch.einsum('btd,dhe->bhte', h, Wv)
            scores = torch.einsum('bhqe,bhke->bhqk', q, k) * scale
            scores = torch.where(mask[None, None], scores, -1000000000.0)
            p = _softmax(scores, axis=-1)
            o = torch.einsum('bhqk,bhke->bhqe', p, v)
            o = torch.einsum('bhte,hed->btd', o, Wo)
            mem = o[:, :M, :].clone()
            outs.append(o[:, M:, :])
        return torch.concatenate(outs, axis=1)
    x = A_x
    x = x + _A_ref(_layernorm(x, axis=-1), A_wqkv, A_wo)
    x = x + _B_ref(_layernorm(x, axis=-1), B_mem0, B_Wq, B_Wk, B_Wv, B_Wo, B_seg_len)
    x = x + _A_ref(_layernorm(x, axis=-1), A_wqkv, A_wo)
    x = x + _B_ref(_layernorm(x, axis=-1), B_mem0, B_Wq, B_Wk, B_Wv, B_Wo, B_seg_len)
    return x
```

```asm
; @launch grid=(256,1,1) block=(256,1,1) lds=163840
.amdgcn_target "amdgcn-amd-amdhsa--gfx950"
.text
CODE_BEGIN:
.globl interleave_layers__sliding_local_dilated__memory_aug_recurrent_mem_tr__prompt_kernel
.p2align 8
.type interleave_layers__sliding_local_dilated__memory_aug_recurrent_mem_tr__prompt_kernel,@function
interleave_layers__sliding_local_dilated__memory_aug_recurrent_mem_tr__prompt_kernel:
    s_cmp_ge_u32 s2, 256
    s_cbranch_scc1 L_exit_m
    s_load_dwordx2 s[8:9], s[0:1], 96
    v_readfirstlane_b32 s5, v0
    s_nop 1
    s_lshr_b32 s5, s5, 6
    s_waitcnt lgkmcnt(0)
    s_cmp_eq_u32 s5, 0
    s_cbranch_scc1 L_nopf
    s_getpc_b64 s[14:15]
L_pfpc:
    s_add_u32 s14, s14, ROLE_R-L_pfpc
    s_addc_u32 s15, s15, 0
    v_subrev_u32 v1, 64, v0
    v_lshlrev_b32 v1, 7, v1
    s_mov_b32 s16, CODE_END-ROLE_R-4
    v_min_u32 v2, s16, v1
    v_and_b32 v2, -4, v2
    global_load_dword v255, v2, s[14:15]
    v_add_u32 v1, 24576, v1
    v_min_u32 v2, s16, v1
    v_and_b32 v2, -4, v2
    global_load_dword v255, v2, s[14:15]
    v_add_u32 v1, 24576, v1
    v_min_u32 v2, s16, v1
    v_and_b32 v2, -4, v2
    global_load_dword v255, v2, s[14:15]
    v_add_u32 v1, 24576, v1
    v_min_u32 v2, s16, v1
    v_and_b32 v2, -4, v2
    global_load_dword v255, v2, s[14:15]
    v_add_u32 v1, 24576, v1
L_nopf:
    s_load_dwordx2 s[46:47], s[0:1], 88
    s_waitcnt lgkmcnt(0)
    s_getreg_b32 s34, hwreg(HW_REG_XCC_ID, 0, 4)
    s_and_b32 s34, s34, 7
    s_cmp_lg_u32 s5, 0
    s_cbranch_scc1 L_tkm
    s_and_b32 s35, s34, 3
    s_lshl_b32 s35, s35, 6
    s_lshr_b32 s37, s34, 2
    s_lshl_b32 s37, s37, 2
    s_add_u32 s35, s35, s37
    s_mov_b64 exec, 1
    v_mov_b32 v1, s35
    v_mov_b32 v2, 1
    global_atomic_add v3, v1, v2, s[46:47] sc0 sc1
    s_waitcnt vmcnt(0)
    v_readfirstlane_b32 s4, v3
    s_nop 1
    s_cmp_lt_u32 s4, 32
    s_cbranch_scc1 L_tkok
    v_mov_b32 v1, 24
    global_atomic_add v3, v1, v2, s[46:47] sc0 sc1
    s_waitcnt vmcnt(0)
    v_readfirstlane_b32 s35, v3
    s_mov_b64 exec, 0xff
    v_and_b32 v1, 3, v0
    v_lshlrev_b32 v1, 6, v1
    v_bfe_u32 v2, v0, 2, 1
    v_lshl_add_u32 v1, v2, 2, v1
    s_mov_b32 s37, 0
L_ovf_spin:
    global_load_dword v3, v1, s[46:47] sc1
    s_add_u32 s37, s37, 1
    s_cmp_gt_u32 s37, 262144
    s_cbranch_scc1 L_ovf_fail
    s_waitcnt vmcnt(0)
    s_mov_b32 s38, 0
    v_readlane_b32 s48, v3, 0
    v_readlane_b32 s49, v3, 1
    v_readlane_b32 s50, v3, 2
    v_readlane_b32 s51, v3, 3
    v_readlane_b32 s52, v3, 4
    v_readlane_b32 s53, v3, 5
    v_readlane_b32 s54, v3, 6
    v_readlane_b32 s55, v3, 7
    s_nop 1
    s_add_u32 s38, s38, s48
    s_add_u32 s38, s38, s49
    s_add_u32 s38, s38, s50
    s_add_u32 s38, s38, s51
    s_add_u32 s38, s38, s52
    s_add_u32 s38, s38, s53
    s_add_u32 s38, s38, s54
    s_add_u32 s38, s38, s55
    s_cmp_lt_u32 s38, 256
    s_cbranch_scc1 L_ovf_spin
    s_min_u32 s39, s48, 32
    s_sub_u32 s38, 32, s39
    s_cmp_lt_u32 s35, s38
    s_cbranch_scc0 L_ovf_n0
    s_mov_b32 s34, 0
    s_add_u32 s4, s39, s35
    s_branch L_tkok
L_ovf_n0:
    s_sub_u32 s35, s35, s38
    s_min_u32 s39, s49, 32
    s_sub_u32 s38, 32, s39
    s_cmp_lt_u32 s35, s38
    s_cbranch_scc0 L_ovf_n1
    s_mov_b32 s34, 1
    s_add_u32 s4, s39, s35
    s_branch L_tkok
L_ovf_n1:
    s_sub_u32 s35, s35, s38
    s_min_u32 s39, s50, 32
    s_sub_u32 s38, 32, s39
    s_cmp_lt_u32 s35, s38
    s_cbranch_scc0 L_ovf_n2
    s_mov_b32 s34, 2
    s_add_u32 s4, s39, s35
    s_branch L_tkok
L_ovf_n2:
    s_sub_u32 s35, s35, s38
    s_min_u32 s39, s51, 32
    s_sub_u32 s38, 32, s39
    s_cmp_lt_u32 s35, s38
    s_cbranch_scc0 L_ovf_n3
    s_mov_b32 s34, 3
    s_add_u32 s4, s39, s35
    s_branch L_tkok
L_ovf_n3:
    s_sub_u32 s35, s35, s38
    s_min_u32 s39, s52, 32
    s_sub_u32 s38, 32, s39
    s_cmp_lt_u32 s35, s38
    s_cbranch_scc0 L_ovf_n4
    s_mov_b32 s34, 4
    s_add_u32 s4, s39, s35
    s_branch L_tkok
L_ovf_n4:
    s_sub_u32 s35, s35, s38
    s_min_u32 s39, s53, 32
    s_sub_u32 s38, 32, s39
    s_cmp_lt_u32 s35, s38
    s_cbranch_scc0 L_ovf_n5
    s_mov_b32 s34, 5
    s_add_u32 s4, s39, s35
    s_branch L_tkok
L_ovf_n5:
    s_sub_u32 s35, s35, s38
    s_min_u32 s39, s54, 32
    s_sub_u32 s38, 32, s39
    s_cmp_lt_u32 s35, s38
    s_cbranch_scc0 L_ovf_n6
    s_mov_b32 s34, 6
    s_add_u32 s4, s39, s35
    s_branch L_tkok
L_ovf_n6:
    s_sub_u32 s35, s35, s38
    s_min_u32 s39, s55, 32
    s_sub_u32 s38, 32, s39
    s_cmp_lt_u32 s35, s38
    s_cbranch_scc0 L_ovf_n7
    s_mov_b32 s34, 7
    s_add_u32 s4, s39, s35
    s_branch L_tkok
L_ovf_n7:
    s_sub_u32 s35, s35, s38
L_ovf_fail:
    s_waitcnt vmcnt(0)
    s_mov_b32 s4, 255
L_tkok:
    s_mov_b64 exec, 1
    v_mov_b32 v1, 0
    v_mov_b32 v2, s4
    v_mov_b32 v3, s34
    ds_write_b64 v1, v[2:3]
    s_waitcnt lgkmcnt(0)
    s_mov_b64 exec, -1
L_tkm:
    s_barrier
    v_mov_b32 v1, 0
    ds_read_b64 v[2:3], v1
    s_waitcnt lgkmcnt(0)
    v_readfirstlane_b32 s4, v2
    v_readfirstlane_b32 s34, v3
    s_barrier
    s_cmp_ge_u32 s4, 32
    s_cbranch_scc1 L_exit_m
    s_mov_b32 s36, 0
    s_cmp_eq_u32 s34, 1
    s_cbranch_scc1 L_doinit
    s_mov_b32 s36, 1
    s_cmp_eq_u32 s34, 4
    s_cbranch_scc1 L_doinit
    s_mov_b32 s36, 2
    s_cmp_eq_u32 s34, 5
    s_cbranch_scc1 L_doinit
    s_mov_b32 s36, 3
    s_cmp_eq_u32 s34, 7
    s_cbranch_scc1 L_doinit
    s_branch L_noinit
L_doinit:
    s_lshl_b32 s36, s36, 5
    s_add_u32 s36, s36, s4
    s_load_dwordx2 s[10:11], s[0:1], 0
    s_load_dwordx2 s[12:13], s[0:1], 32
    s_load_dwordx2 s[14:15], s[0:1], 88
    v_and_b32 v240, 63, v0
    v_and_b32 v241, 15, v240
    v_lshrrev_b32 v242, 4, v240
    s_lshl_b32 s17, s5, 2
    v_add_u32 v243, s17, v242
    s_lshl_b32 s17, s36, 4
    v_add_u32 v244, s17, v241
    v_lshlrev_b32 v5, 10, v244
    v_lshl_add_u32 v5, v243, 6, v5
    v_lshrrev_b32 v245, 5, v244
    v_lshlrev_b32 v245, 15, v245
    v_and_b32 v246, 31, v244
    v_lshl_add_u32 v245, v246, 4, v245
    v_lshl_add_u32 v4, v243, 11, v245
    s_lshl_b32 s17, s5, 7
    v_lshlrev_b32 v7, 3, v241
    v_add_u32 v6, s17, v7
    s_waitcnt lgkmcnt(0)
    global_load_dwordx4 v[16:19], v5, s[10:11] offset:0
    global_load_dwordx4 v[20:23], v5, s[10:11] offset:16
    global_load_dwordx4 v[24:27], v5, s[10:11] offset:32
    global_load_dwordx4 v[28:31], v5, s[10:11] offset:48
    v_mov_b32 v60, -1
    v_mov_b32 v61, -1
    v_mov_b32 v62, -1
    v_mov_b32 v63, -1
    v_lshlrev_b32 v64, 4, v0
    s_lshr_b32 s17, s36, 6
    s_mul_i32 s17, s17, 1048576
    s_and_b32 s18, s36, 63
    s_lshl_b32 s18, s18, 12
    s_add_u32 s17, s17, s18
    s_add_u32 s17, s17, 2097152
    v_add_u32 v65, s17, v64
    global_store_dwordx4 v65, v[60:63], s[8:9] sc1
    s_cmp_lg_u32 s5, 0
    s_cbranch_scc1 Lnf_1
    v_mov_b32 v66, 0
    v_lshlrev_b32 v67, 2, v240
    s_lshl_b32 s17, s36, 8
    v_add_u32 v67, s17, v67
    global_store_dword v67, v66, s[8:9] sc1
Lnf_1:
    s_cmp_ge_u32 s36, 8
    s_cbranch_scc1 Lnm_2
    s_and_b32 s17, s36, 1
    s_lshl_b32 s17, s17, 12
    v_add_u32 v68, s17, v64
    s_lshr_b32 s17, s36, 2
    s_mul_i32 s17, s17, 589824
    s_add_u32 s17, s17, 65536
    s_bitcmp1_b32 s36, 1
    s_cbranch_scc1 Lns_3
    global_load_dwordx4 v[72:75], v68, s[12:13]
    v_add_u32 v68, s17, v68
    s_waitcnt vmcnt(0)
    global_store_dwordx4 v68, v[72:75], s[8:9] sc1
    s_branch Lnm_2
Lns_3:
    s_add_u32 s17, s17, 8192
    v_add_u32 v68, s17, v68
    global_store_dwordx4 v68, v[60:63], s[8:9] sc1
Lnm_2:
    s_waitcnt vmcnt(0)
    v_add_u32 v65, 4194304, v4
    global_store_dwordx4 v65, v[16:19], s[8:9] offset:0 sc1
    global_store_dwordx4 v65, v[20:23], s[8:9] offset:512 sc1
    global_store_dwordx4 v65, v[24:27], s[8:9] offset:1024 sc1
    global_store_dwordx4 v65, v[28:31], s[8:9] offset:1536 sc1
    v_mov_b32 v48, 0
    v_mov_b32 v49, 0
    s_mov_b32 s17, 1065369472
    v_dot2_f32_bf16 v48, v16, s17, v48
    v_dot2_f32_bf16 v49, v16, v16, v49
    v_dot2_f32_bf16 v48, v17, s17, v48
    v_dot2_f32_bf16 v49, v17, v17, v49
    v_dot2_f32_bf16 v48, v18, s17, v48
    v_dot2_f32_bf16 v49, v18, v18, v49
    v_dot2_f32_bf16 v48, v19, s17, v48
    v_dot2_f32_bf16 v49, v19, v19, v49
    v_dot2_f32_bf16 v48, v20, s17, v48
    v_dot2_f32_bf16 v49, v20, v20, v49
    v_dot2_f32_bf16 v48, v21, s17, v48
    v_dot2_f32_bf16 v49, v21, v21, v49
    v_dot2_f32_bf16 v48, v22, s17, v48
    v_dot2_f32_bf16 v49, v22, v22, v49
    v_dot2_f32_bf16 v48, v23, s17, v48
    v_dot2_f32_bf16 v49, v23, v23, v49
    v_dot2_f32_bf16 v48, v24, s17, v48
    v_dot2_f32_bf16 v49, v24, v24, v49
    v_dot2_f32_bf16 v48, v25, s17, v48
    v_dot2_f32_bf16 v49, v25, v25, v49
    v_dot2_f32_bf16 v48, v26, s17, v48
    v_dot2_f32_bf16 v49, v26, v26, v49
    v_dot2_f32_bf16 v48, v27, s17, v48
    v_dot2_f32_bf16 v49, v27, v27, v49
    v_dot2_f32_bf16 v48, v28, s17, v48
    v_dot2_f32_bf16 v49, v28, v28, v49
    v_dot2_f32_bf16 v48, v29, s17, v48
    v_dot2_f32_bf16 v49, v29, v29, v49
    v_dot2_f32_bf16 v48, v30, s17, v48
    v_dot2_f32_bf16 v49, v30, v30, v49
    v_dot2_f32_bf16 v48, v31, s17, v48
    v_dot2_f32_bf16 v49, v31, v31, v49
    s_nop 2
    v_mov_b32 v50, v48
    s_nop 1
    v_permlane32_swap_b32 v48, v50
    v_add_f32 v48, v48, v50
    v_mov_b32 v50, v48
    s_nop 1
    v_permlane16_swap_b32 v48, v50
    v_add_f32 v48, v48, v50
    v_mov_b32 v50, v49
    s_nop 1
    v_permlane32_swap_b32 v49, v50
    v_add_f32 v49, v49, v50
    v_mov_b32 v50, v49
    s_nop 1
    v_permlane16_swap_b32 v49, v50
    v_add_f32 v49, v49, v50
    ds_write_b64 v6, v[48:49]
    s_waitcnt lgkmcnt(0)
    s_barrier
    ds_read_b64 v[52:53], v7 offset:0
    ds_read_b64 v[54:55], v7 offset:128
    ds_read_b64 v[56:57], v7 offset:256
    ds_read_b64 v[58:59], v7 offset:384
    s_waitcnt lgkmcnt(0)
    v_add_f32 v52, v52, v54
    v_add_f32 v53, v53, v55
    v_add_f32 v56, v56, v58
    v_add_f32 v57, v57, v59
    v_add_f32 v48, v52, v56
    v_add_f32 v49, v53, v57
    v_mul_f32 v48, 0x3b000000, v48
    v_mul_f32 v49, 0x3b000000, v49
    v_fma_f32 v49, -v48, v48, v49
    v_max_f32 v49, 0, v49
    v_add_f32 v49, 0x3727c5ac, v49
    v_rsq_f32 v49, v49
    s_nop 0
    v_lshlrev_b32 v50, 16, v16
    v_and_b32 v51, 0xffff0000, v16
    v_sub_f32 v50, v50, v48
    v_sub_f32 v51, v51, v48
    v_mul_f32 v50, v50, v49
    v_mul_f32 v51, v51, v49
    v_cvt_pk_bf16_f32 v32, v50, v51
    v_lshlrev_b32 v50, 16, v17
    v_and_b32 v51, 0xffff0000, v17
    v_sub_f32 v50, v50, v48
    v_sub_f32 v51, v51, v48
    v_mul_f32 v50, v50, v49
    v_mul_f32 v51, v51, v49
    v_cvt_pk_bf16_f32 v33, v50, v51
    v_lshlrev_b32 v50, 16, v18
    v_and_b32 v51, 0xffff0000, v18
    v_sub_f32 v50, v50, v48
    v_sub_f32 v51, v51, v48
    v_mul_f32 v50, v50, v49
    v_mul_f32 v51, v51, v49
    v_cvt_pk_bf16_f32 v34, v50, v51
    v_lshlrev_b32 v50, 16, v19
    v_and_b32 v51, 0xffff0000, v19
    v_sub_f32 v50, v50, v48
    v_sub_f32 v51, v51, v48
    v_mul_f32 v50, v50, v49
    v_mul_f32 v51, v51, v49
    v_cvt_pk_bf16_f32 v35, v50, v51
    v_lshlrev_b32 v50, 16, v20
    v_and_b32 v51, 0xffff0000, v20
    v_sub_f32 v50, v50, v48
    v_sub_f32 v51, v51, v48
    v_mul_f32 v50, v50, v49
    v_mul_f32 v51, v51, v49
    v_cvt_pk_bf16_f32 v36, v50, v51
    v_lshlrev_b32 v50, 16, v21
    v_and_b32 v51, 0xffff0000, v21
    v_sub_f32 v50, v50, v48
    v_sub_f32 v51, v51, v48
    v_mul_f32 v50, v50, v49
    v_mul_f32 v51, v51, v49
    v_cvt_pk_bf16_f32 v37, v50, v51
    v_lshlrev_b32 v50, 16, v22
    v_and_b32 v51, 0xffff0000, v22
    v_sub_f32 v50, v50, v48
    v_sub_f32 v51, v51, v48
    v_mul_f32 v50, v50, v49
    v_mul_f32 v51, v51, v49
    v_cvt_pk_bf16_f32 v38, v50, v51
    v_lshlrev_b32 v50, 16, v23
    v_and_b32 v51, 0xffff0000, v23
    v_sub_f32 v50, v50, v48
    v_sub_f32 v51, v51, v48
    v_mul_f32 v50, v50, v49
    v_mul_f32 v51, v51, v49
    v_cvt_pk_bf16_f32 v39, v50, v51
    v_lshlrev_b32 v50, 16, v24
    v_and_b32 v51, 0xffff0000, v24
    v_sub_f32 v50, v50, v48
    v_sub_f32 v51, v51, v48
    v_mul_f32 v50, v50, v49
    v_mul_f32 v51, v51, v49
    v_cvt_pk_bf16_f32 v40, v50, v51
    v_lshlrev_b32 v50, 16, v25
    v_and_b32 v51, 0xffff0000, v25
    v_sub_f32 v50, v50, v48
    v_sub_f32 v51, v51, v48
    v_mul_f32 v50, v50, v49
    v_mul_f32 v51, v51, v49
    v_cvt_pk_bf16_f32 v41, v50, v51
    v_lshlrev_b32 v50, 16, v26
    v_and_b32 v51, 0xffff0000, v26
    v_sub_f32 v50, v50, v48
    v_sub_f32 v51, v51, v48
    v_mul_f32 v50, v50, v49
    v_mul_f32 v51, v51, v49
    v_cvt_pk_bf16_f32 v42, v50, v51
    v_lshlrev_b32 v50, 16, v27
    v_and_b32 v51, 0xffff0000, v27
    v_sub_f32 v50, v50, v48
    v_sub_f32 v51, v51, v48
    v_mul_f32 v50, v50, v49
    v_mul_f32 v51, v51, v49
    v_cvt_pk_bf16_f32 v43, v50, v51
    v_lshlrev_b32 v50, 16, v28
    v_and_b32 v51, 0xffff0000, v28
    v_sub_f32 v50, v50, v48
    v_sub_f32 v51, v51, v48
    v_mul_f32 v50, v50, v49
    v_mul_f32 v51, v51, v49
    v_cvt_pk_bf16_f32 v44, v50, v51
    v_lshlrev_b32 v50, 16, v29
    v_and_b32 v51, 0xffff0000, v29
    v_sub_f32 v50, v50, v48
    v_sub_f32 v51, v51, v48
    v_mul_f32 v50, v50, v49
    v_mul_f32 v51, v51, v49
    v_cvt_pk_bf16_f32 v45, v50, v51
    v_lshlrev_b32 v50, 16, v30
    v_and_b32 v51, 0xffff0000, v30
    v_sub_f32 v50, v50, v48
    v_sub_f32 v51, v51, v48
    v_mul_f32 v50, v50, v49
    v_mul_f32 v51, v51, v49
    v_cvt_pk_bf16_f32 v46, v50, v51
    v_lshlrev_b32 v50, 16, v31
    v_and_b32 v51, 0xffff0000, v31
    v_sub_f32 v50, v50, v48
    v_sub_f32 v51, v51, v48
    v_mul_f32 v50, v50, v49
    v_mul_f32 v51, v51, v49
    v_cvt_pk_bf16_f32 v47, v50, v51
    v_add_u32 v65, 8388608, v4
    global_store_dwordx4 v65, v[32:35], s[8:9] offset:0 sc1
    global_store_dwordx4 v65, v[36:39], s[8:9] offset:512 sc1
    global_store_dwordx4 v65, v[40:43], s[8:9] offset:1024 sc1
    global_store_dwordx4 v65, v[44:47], s[8:9] offset:1536 sc1
    s_waitcnt vmcnt(0)
    s_barrier
    s_cmp_lg_u32 s5, 0
    s_cbranch_scc1 Linits_4
    s_mov_b64 exec, 1
    v_mov_b32 v66, 16
    v_mov_b32 v67, 1
    global_atomic_add v68, v66, v67, s[14:15] sc0 sc1
    s_waitcnt vmcnt(0)
    v_cmp_eq_u32 vcc, 127, v68
    s_cbranch_vccz Linits2_5
    v_mov_b32 v66, 248
    global_store_dword v66, v67, s[14:15] sc1
    s_waitcnt vmcnt(0)
Linits2_5:
    s_mov_b64 exec, -1
Linits_4:
L_noinit:
    s_cmp_ge_u32 s34, 2
    s_cbranch_scc1 L_d1
    s_xor_b32 s6, s34, 0
    s_branch ROLE_R
L_d1:
    s_cmp_ge_u32 s34, 6
    s_cbranch_scc1 L_d2
    s_sub_u32 s6, s34, 2
    s_lshr_b32 s6, s6, 1
    s_and_b32 s33, s34, 1
    s_cmp_lg_u32 s33, 0
    s_cbranch_scc1 L_d1b
    s_branch ROLE_T3q
L_d1b:
    s_cmp_ge_u32 s4, 16
    s_cbranch_scc1 L_d1c
    s_add_u32 s4, s4, 32
    s_branch ROLE_T3v
L_d1c:
    s_sub_u32 s4, s4, 16
    s_branch ROLE_T5
L_d2:
    s_sub_u32 s6, s34, 6
    s_cmp_ge_u32 s4, 16
    s_cbranch_scc1 L_d2b
    s_cmp_lg_u32 s6, 0
    s_cbranch_scc1 L_d2a
    s_load_dwordx2 s[10:11], s[0:1], 8
    s_load_dwordx2 s[12:13], s[0:1], 16
    s_lshl_b32 s17, s4, 2
    s_add_u32 s17, s17, s5
    v_and_b32 v4, 63, v0
    v_lshlrev_b32 v4, 6, v4
    s_mul_i32 s18, s17, 24576
    v_add_u32 v5, s18, v4
    s_lshl_b32 s18, s17, 13
    v_add_u32 v6, s18, v4
    s_waitcnt lgkmcnt(0)
    global_load_dword v8, v5, s[10:11]
    v_add_u32 v5, 4096, v5
    global_load_dword v9, v5, s[10:11]
    v_add_u32 v5, 4096, v5
    global_load_dword v10, v5, s[10:11]
    v_add_u32 v5, 4096, v5
    global_load_dword v11, v5, s[10:11]
    v_add_u32 v5, 4096, v5
    global_load_dword v12, v5, s[10:11]
    v_add_u32 v5, 4096, v5
    global_load_dword v13, v5, s[10:11]
    v_add_u32 v5, 4096, v5
    global_load_dword v16, v6, s[12:13]
    v_add_u32 v6, 4096, v6
    global_load_dword v17, v6, s[12:13]
    v_add_u32 v6, 4096, v6
    s_waitcnt vmcnt(0)
L_d2a:
    s_branch ROLE_T4
L_d2b:
    s_cmp_ge_u32 s4, 24
    s_cbranch_scc1 L_d2c
    s_sub_u32 s4, s4, 16
    s_branch ROLE_TA
L_d2c:
    s_cmp_ge_u32 s4, 26
    s_cbranch_scc1 L_d2d
    s_sub_u32 s4, s4, 24
    s_branch ROLE_TW
L_d2d:
    s_cmp_ge_u32 s4, 30
    s_cbranch_scc1 L_exit_m
    s_sub_u32 s4, s4, 26
    s_branch ROLE_T6
L_exit_m:
    s_endpgm
ROLE_R:
    s_cmp_eq_u32 s6, 0
    s_cbranch_scc1 Lws_6
    s_load_dwordx2 s[42:43], s[0:1], 88
    s_mov_b32 s40, 0
    s_mov_b32 s7, 0
    v_mov_b32 v32, 248
    s_waitcnt lgkmcnt(0)
Lwi_9:
    global_load_dword v33, v32, s[42:43] sc1
    s_add_u32 s40, s40, 1
    s_cmp_gt_u32 s40, 262144
    s_cbranch_scc1 Lwito_10
    s_waitcnt vmcnt(0)
    v_cmp_gt_u32 vcc, 1, v33
    s_cbranch_vccnz Lwi_9
    s_branch Lwisk_11
Lwito_10:
    s_load_dwordx2 s[42:43], s[0:1], 88
    s_waitcnt lgkmcnt(0)
    s_mov_b64 exec, 1
    v_mov_b32 v32, 180
    v_mov_b32 v33, s7
    v_add_u32 v33, 0x10000, v33
    global_store_dword v32, v33, s[42:43] sc1
    s_waitcnt vmcnt(0)
    s_endpgm
Lwisk_11:
    s_mov_b32 s40, 0
    s_mov_b32 s7, 0
    v_mov_b32 v2, 0
Lwsp_7:
    global_load_dword v3, v2, s[8:9] sc1
    s_add_u32 s40, s40, 1
    s_cmp_gt_u32 s40, 262144
    s_cbranch_scc1 Lwsto_8
    s_waitcnt vmcnt(0)
    v_cmp_gt_u32 vcc, 1, v3
    s_cbranch_vccnz Lwsp_7
    s_branch Lws_6
Lwsto_8:
    s_load_dwordx2 s[42:43], s[0:1], 88
    s_waitcnt lgkmcnt(0)
    s_mov_b64 exec, 1
    v_mov_b32 v32, 172
    v_mov_b32 v33, s7
    v_add_u32 v33, 0x10000, v33
    global_store_dword v32, v33, s[42:43] sc1
    s_waitcnt vmcnt(0)
    s_endpgm
Lws_6:
    v_and_b32 v40, 63, v0
    v_and_b32 v41, 15, v40
    v_lshrrev_b32 v42, 4, v40
    v_lshlrev_b32 v0, 4, v40
    v_add_u32 v43, 0, v42
    v_lshlrev_b32 v43, 1, v43
    v_xor_b32 v43, v43, v41
    v_lshlrev_b32 v43, 4, v43
    v_lshlrev_b32 v44, 13, v42
    v_add_u32 v46, v43, v44
    v_add_u32 v43, 4, v42
    v_lshlrev_b32 v43, 1, v43
    v_xor_b32 v43, v43, v41
    v_lshlrev_b32 v43, 4, v43
    v_lshlrev_b32 v44, 13, v42
    v_add_u32 v47, v43, v44
    v_lshrrev_b32 v43, 2, v41
    v_lshl_add_u32 v43, v42, 2, v43
    v_and_b32 v44, 7, v43
    v_lshlrev_b32 v44, 1, v44
    v_and_b32 v45, 3, v41
    v_lshrrev_b32 v45, 1, v45
    s_lshl_b32 s37, s5, 2
    v_add_u32 v45, s37, v45
    v_add_u32 v48, 0, v45
    v_xor_b32 v48, v48, v44
    v_lshlrev_b32 v48, 4, v48
    v_lshl_add_u32 v48, v43, 8, v48
    v_and_b32 v49, 1, v41
    v_lshl_add_u32 v50, v49, 3, v48
    v_add_u32 v52, 0x10000, v50
    v_add_u32 v48, 2, v45
    v_xor_b32 v48, v48, v44
    v_lshlrev_b32 v48, 4, v48
    v_lshl_add_u32 v48, v43, 8, v48
    v_and_b32 v49, 1, v41
    v_lshl_add_u32 v51, v49, 3, v48
    v_add_u32 v53, 0x10000, v51
    v_xor_b32 v64, 0, v40
    v_lshlrev_b32 v64, 4, v64
    v_xor_b32 v65, 2, v40
    v_lshlrev_b32 v65, 4, v65
    v_xor_b32 v66, 4, v40
    v_lshlrev_b32 v66, 4, v66
    v_xor_b32 v67, 6, v40
    v_lshlrev_b32 v67, 4, v67
    v_xor_b32 v68, 8, v40
    v_lshlrev_b32 v68, 4, v68
    v_xor_b32 v69, 10, v40
    v_lshlrev_b32 v69, 4, v69
    v_xor_b32 v70, 12, v40
    v_lshlrev_b32 v70, 4, v70
    v_xor_b32 v71, 14, v40
    v_lshlrev_b32 v71, 4, v71
    v_lshrrev_b32 v72, 2, v41
    v_lshl_add_u32 v72, v42, 2, v72
    v_and_b32 v73, 7, v72
    v_lshlrev_b32 v73, 1, v73
    v_and_b32 v74, 3, v41
    v_lshrrev_b32 v74, 1, v74
    s_lshl_b32 s37, s5, 4
    v_add_u32 v74, s37, v74
    v_lshlrev_b32 v75, 10, v72
    v_and_b32 v76, 1, v41
    v_lshl_add_u32 v75, v76, 3, v75
    s_lshl_b32 s37, s5, 13
    v_add_u32 v77, s37, v0
    s_load_dwordx2 s[42:43], s[0:1], 40
    s_lshl_b32 s37, s4, 8
    s_lshl_b32 s38, s5, 19
    s_add_u32 s37, s37, s38
    s_add_u32 s37, s37, 0
    s_lshl_b32 s39, s5, 14
    s_add_u32 s39, s39, 0
    s_waitcnt lgkmcnt(0)
    s_add_u32 s42, s42, s37
    s_addc_u32 s43, s43, 0
    s_mov_b32 m0, s39
    s_add_u32 s39, s39, 1024
    global_load_lds_dwordx4 v46, s[42:43]
    s_add_u32 s42, s42, 32768
    s_addc_u32 s43, s43, 0
    s_mov_b32 m0, s39
    s_add_u32 s39, s39, 1024
    global_load_lds_dwordx4 v47, s[42:43]
    s_add_u32 s42, s42, 32768
    s_addc_u32 s43, s43, 0
    s_mov_b32 m0, s39
    s_add_u32 s39, s39, 1024
    global_load_lds_dwordx4 v46, s[42:43]
    s_add_u32 s42, s42, 32768
    s_addc_u32 s43, s43, 0
    s_mov_b32 m0, s39
    s_add_u32 s39, s39, 1024
    global_load_lds_dwordx4 v47, s[42:43]
    s_add_u32 s42, s42, 32768
    s_addc_u32 s43, s43, 0
    s_mov_b32 m0, s39
    s_add_u32 s39, s39, 1024
    global_load_lds_dwordx4 v46, s[42:43]
    s_add_u32 s42, s42, 32768
    s_addc_u32 s43, s43, 0
    s_mov_b32 m0, s39
    s_add_u32 s39, s39, 1024
    global_load_lds_dwordx4 v47, s[42:43]
    s_add_u32 s42, s42, 32768
    s_addc_u32 s43, s43, 0
    s_mov_b32 m0, s39
    s_add_u32 s39, s39, 1024
    global_load_lds_dwordx4 v46, s[42:43]
    s_add_u32 s42, s42, 32768
    s_addc_u32 s43, s43, 0
    s_mov_b32 m0, s39
    s_add_u32 s39, s39, 1024
    global_load_lds_dwordx4 v47, s[42:43]
    s_add_u32 s42, s42, 32768
    s_addc_u32 s43, s43, 0
    s_mov_b32 m0, s39
    s_add_u32 s39, s39, 1024
    global_load_lds_dwordx4 v46, s[42:43]
    s_add_u32 s42, s42, 32768
    s_addc_u32 s43, s43, 0
    s_mov_b32 m0, s39
    s_add_u32 s39, s39, 1024
    global_load_lds_dwordx4 v47, s[42:43]
    s_add_u32 s42, s42, 32768
    s_addc_u32 s43, s43, 0
    s_mov_b32 m0, s39
    s_add_u32 s39, s39, 1024
    global_load_lds_dwordx4 v46, s[42:43]
    s_add_u32 s42, s42, 32768
    s_addc_u32 s43, s43, 0
    s_mov_b32 m0, s39
    s_add_u32 s39, s39, 1024
    global_load_lds_dwordx4 v47, s[42:43]
    s_add_u32 s42, s42, 32768
    s_addc_u32 s43, s43, 0
    s_mov_b32 m0, s39
    s_add_u32 s39, s39, 1024
    global_load_lds_dwordx4 v46, s[42:43]
    s_add_u32 s42, s42, 32768
    s_addc_u32 s43, s43, 0
    s_mov_b32 m0, s39
    s_add_u32 s39, s39, 1024
    global_load_lds_dwordx4 v47, s[42:43]
    s_add_u32 s42, s42, 32768
    s_addc_u32 s43, s43, 0
    s_mov_b32 m0, s39
    s_add_u32 s39, s39, 1024
    global_load_lds_dwordx4 v46, s[42:43]
    s_add_u32 s42, s42, 32768
    s_addc_u32 s43, s43, 0
    s_mov_b32 m0, s39
    s_add_u32 s39, s39, 1024
    global_load_lds_dwordx4 v47, s[42:43]
    s_add_u32 s42, s42, 32768
    s_addc_u32 s43, s43, 0
    s_load_dwordx2 s[42:43], s[0:1], 40
    s_lshl_b32 s37, s4, 8
    s_lshl_b32 s38, s5, 19
    s_add_u32 s37, s37, s38
    s_add_u32 s37, s37, 2097152
    s_lshl_b32 s39, s5, 14
    s_add_u32 s39, s39, 65536
    s_waitcnt lgkmcnt(0)
    s_add_u32 s42, s42, s37
    s_addc_u32 s43, s43, 0
    s_mov_b32 m0, s39
    s_add_u32 s39, s39, 1024
    global_load_lds_dwordx4 v46, s[42:43]
    s_add_u32 s42, s42, 32768
    s_addc_u32 s43, s43, 0
    s_mov_b32 m0, s39
    s_add_u32 s39, s39, 1024
    global_load_lds_dwordx4 v47, s[42:43]
    s_add_u32 s42, s42, 32768
    s_addc_u32 s43, s43, 0
    s_mov_b32 m0, s39
    s_add_u32 s39, s39, 1024
    global_load_lds_dwordx4 v46, s[42:43]
    s_add_u32 s42, s42, 32768
    s_addc_u32 s43, s43, 0
    s_mov_b32 m0, s39
    s_add_u32 s39, s39, 1024
    global_load_lds_dwordx4 v47, s[42:43]
    s_add_u32 s42, s42, 32768
    s_addc_u32 s43, s43, 0
    s_mov_b32 m0, s39
    s_add_u32 s39, s39, 1024
    global_load_lds_dwordx4 v46, s[42:43]
    s_add_u32 s42, s42, 32768
    s_addc_u32 s43, s43, 0
    s_mov_b32 m0, s39
    s_add_u32 s39, s39, 1024
    global_load_lds_dwordx4 v47, s[42:43]
    s_add_u32 s42, s42, 32768
    s_addc_u32 s43, s43, 0
    s_mov_b32 m0, s39
    s_add_u32 s39, s39, 1024
    global_load_lds_dwordx4 v46, s[42:43]
    s_add_u32 s42, s42, 32768
    s_addc_u32 s43, s43, 0
    s_mov_b32 m0, s39
    s_add_u32 s39, s39, 1024
    global_load_lds_dwordx4 v47, s[42:43]
    s_add_u32 s42, s42, 32768
    s_addc_u32 s43, s43, 0
    s_mov_b32 m0, s39
    s_add_u32 s39, s39, 1024
    global_load_lds_dwordx4 v46, s[42:43]
    s_add_u32 s42, s42, 32768
    s_addc_u32 s43, s43, 0
    s_mov_b32 m0, s39
    s_add_u32 s39, s39, 1024
    global_load_lds_dwordx4 v47, s[42:43]
    s_add_u32 s42, s42, 32768
    s_addc_u32 s43, s43, 0
    s_mov_b32 m0, s39
    s_add_u32 s39, s39, 1024
    global_load_lds_dwordx4 v46, s[42:43]
    s_add_u32 s42, s42, 32768
    s_addc_u32 s43, s43, 0
    s_mov_b32 m0, s39
    s_add_u32 s39, s39, 1024
    global_load_lds_dwordx4 v47, s[42:43]
    s_add_u32 s42, s42, 32768
    s_addc_u32 s43, s43, 0
    s_mov_b32 m0, s39
    s_add_u32 s39, s39, 1024
    global_load_lds_dwordx4 v46, s[42:43]
    s_add_u32 s42, s42, 32768
    s_addc_u32 s43, s43, 0
    s_mov_b32 m0, s39
    s_add_u32 s39, s39, 1024
    global_load_lds_dwordx4 v47, s[42:43]
    s_add_u32 s42, s42, 32768
    s_addc_u32 s43, s43, 0
    s_mov_b32 m0, s39
    s_add_u32 s39, s39, 1024
    global_load_lds_dwordx4 v46, s[42:43]
    s_add_u32 s42, s42, 32768
    s_addc_u32 s43, s43, 0
    s_mov_b32 m0, s39
    s_add_u32 s39, s39, 1024
    global_load_lds_dwordx4 v47, s[42:43]
    s_add_u32 s42, s42, 32768
    s_addc_u32 s43, s43, 0
    s_waitcnt vmcnt(16)
    s_barrier
    ds_read_b64_tr_b16 v[56:57], v50 offset:0
    ds_read_b64_tr_b16 v[58:59], v51 offset:0
    ds_read_b64_tr_b16 v[60:61], v50 offset:4096
    ds_read_b64_tr_b16 v[62:63], v51 offset:4096
    s_waitcnt lgkmcnt(0)
    v_accvgpr_write_b32 a0, v56
    v_accvgpr_write_b32 a2, v57
    v_accvgpr_write_b32 a1, v58
    v_accvgpr_write_b32 a3, v59
    v_accvgpr_write_b32 a4, v60
    v_accvgpr_write_b32 a6, v61
    v_accvgpr_write_b32 a5, v62
    v_accvgpr_write_b32 a7, v63
    ds_read_b64_tr_b16 v[56:57], v50 offset:8192
    ds_read_b64_tr_b16 v[58:59], v51 offset:8192
    ds_read_b64_tr_b16 v[60:61], v50 offset:12288
    ds_read_b64_tr_b16 v[62:63], v51 offset:12288
    s_waitcnt lgkmcnt(0)
    v_accvgpr_write_b32 a8, v56
    v_accvgpr_write_b32 a10, v57
    v_accvgpr_write_b32 a9, v58
    v_accvgpr_write_b32 a11, v59
    v_accvgpr_write_b32 a12, v60
    v_accvgpr_write_b32 a14, v61
    v_accvgpr_write_b32 a13, v62
    v_accvgpr_write_b32 a15, v63
    ds_read_b64_tr_b16 v[56:57], v50 offset:16384
    ds_read_b64_tr_b16 v[58:59], v51 offset:16384
    ds_read_b64_tr_b16 v[60:61], v50 offset:20480
    ds_read_b64_tr_b16 v[62:63], v51 offset:20480
    s_waitcnt lgkmcnt(0)
    v_accvgpr_write_b32 a16, v56
    v_accvgpr_write_b32 a18, v57
    v_accvgpr_write_b32 a17, v58
    v_accvgpr_write_b32 a19, v59
    v_accvgpr_write_b32 a20, v60
    v_accvgpr_write_b32 a22, v61
    v_accvgpr_write_b32 a21, v62
    v_accvgpr_write_b32 a23, v63
    ds_read_b64_tr_b16 v[56:57], v50 offset:24576
    ds_read_b64_tr_b16 v[58:59], v51 offset:24576
    ds_read_b64_tr_b16 v[60:61], v50 offset:28672
    ds_read_b64_tr_b16 v[62:63], v51 offset:28672
    s_waitcnt lgkmcnt(0)
    v_accvgpr_write_b32 a24, v56
    v_accvgpr_write_b32 a26, v57
    v_accvgpr_write_b32 a25, v58
    v_accvgpr_write_b32 a27, v59
    v_accvgpr_write_b32 a28, v60
    v_accvgpr_write_b32 a30, v61
    v_accvgpr_write_b32 a29, v62
    v_accvgpr_write_b32 a31, v63
    ds_read_b64_tr_b16 v[56:57], v50 offset:32768
    ds_read_b64_tr_b16 v[58:59], v51 offset:32768
    ds_read_b64_tr_b16 v[60:61], v50 offset:36864
    ds_read_b64_tr_b16 v[62:63], v51 offset:36864
    s_waitcnt lgkmcnt(0)
    v_accvgpr_write_b32 a32, v56
    v_accvgpr_write_b32 a34, v57
    v_accvgpr_write_b32 a33, v58
    v_accvgpr_write_b32 a35, v59
    v_accvgpr_write_b32 a36, v60
    v_accvgpr_write_b32 a38, v61
    v_accvgpr_write_b32 a37, v62
    v_accvgpr_write_b32 a39, v63
    ds_read_b64_tr_b16 v[56:57], v50 offset:40960
    ds_read_b64_tr_b16 v[58:59], v51 offset:40960
    ds_read_b64_tr_b16 v[60:61], v50 offset:45056
    ds_read_b64_tr_b16 v[62:63], v51 offset:45056
    s_waitcnt lgkmcnt(0)
    v_accvgpr_write_b32 a40, v56
    v_accvgpr_write_b32 a42, v57
    v_accvgpr_write_b32 a41, v58
    v_accvgpr_write_b32 a43, v59
    v_accvgpr_write_b32 a44, v60
    v_accvgpr_write_b32 a46, v61
    v_accvgpr_write_b32 a45, v62
    v_accvgpr_write_b32 a47, v63
    ds_read_b64_tr_b16 v[56:57], v50 offset:49152
    ds_read_b64_tr_b16 v[58:59], v51 offset:49152
    ds_read_b64_tr_b16 v[60:61], v50 offset:53248
    ds_read_b64_tr_b16 v[62:63], v51 offset:53248
    s_waitcnt lgkmcnt(0)
    v_accvgpr_write_b32 a48, v56
    v_accvgpr_write_b32 a50, v57
    v_accvgpr_write_b32 a49, v58
    v_accvgpr_write_b32 a51, v59
    v_accvgpr_write_b32 a52, v60
    v_accvgpr_write_b32 a54, v61
    v_accvgpr_write_b32 a53, v62
    v_accvgpr_write_b32 a55, v63
    ds_read_b64_tr_b16 v[56:57], v50 offset:57344
    ds_read_b64_tr_b16 v[58:59], v51 offset:57344
    ds_read_b64_tr_b16 v[60:61], v50 offset:61440
    ds_read_b64_tr_b16 v[62:63], v51 offset:61440
    s_waitcnt lgkmcnt(0)
    v_accvgpr_write_b32 a56, v56
    v_accvgpr_write_b32 a58, v57
    v_accvgpr_write_b32 a57, v58
    v_accvgpr_write_b32 a59, v59
    v_accvgpr_write_b32 a60, v60
    v_accvgpr_write_b32 a62, v61
    v_accvgpr_write_b32 a61, v62
    v_accvgpr_write_b32 a63, v63
    s_barrier
    s_load_dwordx2 s[42:43], s[0:1], 48
    s_lshl_b32 s37, s4, 8
    s_lshl_b32 s38, s5, 19
    s_add_u32 s37, s37, s38
    s_add_u32 s37, s37, 0
    s_lshl_b32 s39, s5, 14
    s_add_u32 s39, s39, 0
    s_waitcnt lgkmcnt(0)
    s_add_u32 s42, s42, s37
    s_addc_u32 s43, s43, 0
    s_mov_b32 m0, s39
    s_add_u32 s39, s39, 1024
    global_load_lds_dwordx4 v46, s[42:43]
    s_add_u32 s42, s42, 32768
    s_addc_u32 s43, s43, 0
    s_mov_b32 m0, s39
    s_add_u32 s39, s39, 1024
    global_load_lds_dwordx4 v47, s[42:43]
    s_add_u32 s42, s42, 32768
    s_addc_u32 s43, s43, 0
    s_mov_b32 m0, s39
    s_add_u32 s39, s39, 1024
    global_load_lds_dwordx4 v46, s[42:43]
    s_add_u32 s42, s42, 32768
    s_addc_u32 s43, s43, 0
    s_mov_b32 m0, s39
    s_add_u32 s39, s39, 1024
    global_load_lds_dwordx4 v47, s[42:43]
    s_add_u32 s42, s42, 32768
    s_addc_u32 s43, s43, 0
    s_mov_b32 m0, s39
    s_add_u32 s39, s39, 1024
    global_load_lds_dwordx4 v46, s[42:43]
    s_add_u32 s42, s42, 32768
    s_addc_u32 s43, s43, 0
    s_mov_b32 m0, s39
    s_add_u32 s39, s39, 1024
    global_load_lds_dwordx4 v47, s[42:43]
    s_add_u32 s42, s42, 32768
    s_addc_u32 s43, s43, 0
    s_mov_b32 m0, s39
    s_add_u32 s39, s39, 1024
    global_load_lds_dwordx4 v46, s[42:43]
    s_add_u32 s42, s42, 32768
    s_addc_u32 s43, s43, 0
    s_mov_b32 m0, s39
    s_add_u32 s39, s39, 1024
    global_load_lds_dwordx4 v47, s[42:43]
    s_add_u32 s42, s42, 32768
    s_addc_u32 s43, s43, 0
    s_mov_b32 m0, s39
    s_add_u32 s39, s39, 1024
    global_load_lds_dwordx4 v46, s[42:43]
    s_add_u32 s42, s42, 32768
    s_addc_u32 s43, s43, 0
    s_mov_b32 m0, s39
    s_add_u32 s39, s39, 1024
    global_load_lds_dwordx4 v47, s[42:43]
    s_add_u32 s42, s42, 32768
    s_addc_u32 s43, s43, 0
    s_mov_b32 m0, s39
    s_add_u32 s39, s39, 1024
    global_load_lds_dwordx4 v46, s[42:43]
    s_add_u32 s42, s42, 32768
    s_addc_u32 s43, s43, 0
    s_mov_b32 m0, s39
    s_add_u32 s39, s39, 1024
    global_load_lds_dwordx4 v47, s[42:43]
    s_add_u32 s42, s42, 32768
    s_addc_u32 s43, s43, 0
    s_mov_b32 m0, s39
    s_add_u32 s39, s39, 1024
    global_load_lds_dwordx4 v46, s[42:43]
    s_add_u32 s42, s42, 32768
    s_addc_u32 s43, s43, 0
    s_mov_b32 m0, s39
    s_add_u32 s39, s39, 1024
    global_load_lds_dwordx4 v47, s[42:43]
    s_add_u32 s42, s42, 32768
    s_addc_u32 s43, s43, 0
    s_mov_b32 m0, s39
    s_add_u32 s39, s39, 1024
    global_load_lds_dwordx4 v46, s[42:43]
    s_add_u32 s42, s42, 32768
    s_addc_u32 s43, s43, 0
    s_mov_b32 m0, s39
    s_add_u32 s39, s39, 1024
    global_load_lds_dwordx4 v47, s[42:43]
    s_add_u32 s42, s42, 32768
    s_addc_u32 s43, s43, 0
    s_waitcnt vmcnt(16)
    s_barrier
    ds_read_b64_tr_b16 v[56:57], v52 offset:0
    ds_read_b64_tr_b16 v[58:59], v53 offset:0
    ds_read_b64_tr_b16 v[60:61], v52 offset:4096
    ds_read_b64_tr_b16 v[62:63], v53 offset:4096
    s_waitcnt lgkmcnt(0)
    v_accvgpr_write_b32 a64, v56
    v_accvgpr_write_b32 a66, v57
    v_accvgpr_write_b32 a65, v58
    v_accvgpr_write_b32 a67, v59
    v_accvgpr_write_b32 a68, v60
    v_accvgpr_write_b32 a70, v61
    v_accvgpr_write_b32 a69, v62
    v_accvgpr_write_b32 a71, v63
    ds_read_b64_tr_b16 v[56:57], v52 offset:8192
    ds_read_b64_tr_b16 v[58:59], v53 offset:8192
    ds_read_b64_tr_b16 v[60:61], v52 offset:12288
    ds_read_b64_tr_b16 v[62:63], v53 offset:12288
    s_waitcnt lgkmcnt(0)
    v_accvgpr_write_b32 a72, v56
    v_accvgpr_write_b32 a74, v57
    v_accvgpr_write_b32 a73, v58
    v_accvgpr_write_b32 a75, v59
    v_accvgpr_write_b32 a76, v60
    v_accvgpr_write_b32 a78, v61
    v_accvgpr_write_b32 a77, v62
    v_accvgpr_write_b32 a79, v63
    ds_read_b64_tr_b16 v[56:57], v52 offset:16384
    ds_read_b64_tr_b16 v[58:59], v53 offset:16384
    ds_read_b64_tr_b16 v[60:61], v52 offset:20480
    ds_read_b64_tr_b16 v[62:63], v53 offset:20480
    s_waitcnt lgkmcnt(0)
    v_accvgpr_write_b32 a80, v56
    v_accvgpr_write_b32 a82, v57
    v_accvgpr_write_b32 a81, v58
    v_accvgpr_write_b32 a83, v59
    v_accvgpr_write_b32 a84, v60
    v_accvgpr_write_b32 a86, v61
    v_accvgpr_write_b32 a85, v62
    v_accvgpr_write_b32 a87, v63
    ds_read_b64_tr_b16 v[56:57], v52 offset:24576
    ds_read_b64_tr_b16 v[58:59], v53 offset:24576
    ds_read_b64_tr_b16 v[60:61], v52 offset:28672
    ds_read_b64_tr_b16 v[62:63], v53 offset:28672
    s_waitcnt lgkmcnt(0)
    v_accvgpr_write_b32 a88, v56
    v_accvgpr_write_b32 a90, v57
    v_accvgpr_write_b32 a89, v58
    v_accvgpr_write_b32 a91, v59
    v_accvgpr_write_b32 a92, v60
    v_accvgpr_write_b32 a94, v61
    v_accvgpr_write_b32 a93, v62
    v_accvgpr_write_b32 a95, v63
    ds_read_b64_tr_b16 v[56:57], v52 offset:32768
    ds_read_b64_tr_b16 v[58:59], v53 offset:32768
    ds_read_b64_tr_b16 v[60:61], v52 offset:36864
    ds_read_b64_tr_b16 v[62:63], v53 offset:36864
    s_waitcnt lgkmcnt(0)
    v_accvgpr_write_b32 a96, v56
    v_accvgpr_write_b32 a98, v57
    v_accvgpr_write_b32 a97, v58
    v_accvgpr_write_b32 a99, v59
    v_accvgpr_write_b32 a100, v60
    v_accvgpr_write_b32 a102, v61
    v_accvgpr_write_b32 a101, v62
    v_accvgpr_write_b32 a103, v63
    ds_read_b64_tr_b16 v[56:57], v52 offset:40960
    ds_read_b64_tr_b16 v[58:59], v53 offset:40960
    ds_read_b64_tr_b16 v[60:61], v52 offset:45056
    ds_read_b64_tr_b16 v[62:63], v53 offset:45056
    s_waitcnt lgkmcnt(0)
    v_accvgpr_write_b32 a104, v56
    v_accvgpr_write_b32 a106, v57
    v_accvgpr_write_b32 a105, v58
    v_accvgpr_write_b32 a107, v59
    v_accvgpr_write_b32 a108, v60
    v_accvgpr_write_b32 a110, v61
    v_accvgpr_write_b32 a109, v62
    v_accvgpr_write_b32 a111, v63
    ds_read_b64_tr_b16 v[56:57], v52 offset:49152
    ds_read_b64_tr_b16 v[58:59], v53 offset:49152
    ds_read_b64_tr_b16 v[60:61], v52 offset:53248
    ds_read_b64_tr_b16 v[62:63], v53 offset:53248
    s_waitcnt lgkmcnt(0)
    v_accvgpr_write_b32 a112, v56
    v_accvgpr_write_b32 a114, v57
    v_accvgpr_write_b32 a113, v58
    v_accvgpr_write_b32 a115, v59
    v_accvgpr_write_b32 a116, v60
    v_accvgpr_write_b32 a118, v61
    v_accvgpr_write_b32 a117, v62
    v_accvgpr_write_b32 a119, v63
    ds_read_b64_tr_b16 v[56:57], v52 offset:57344
    ds_read_b64_tr_b16 v[58:59], v53 offset:57344
    ds_read_b64_tr_b16 v[60:61], v52 offset:61440
    ds_read_b64_tr_b16 v[62:63], v53 offset:61440
    s_waitcnt lgkmcnt(0)
    v_accvgpr_write_b32 a120, v56
    v_accvgpr_write_b32 a122, v57
    v_accvgpr_write_b32 a121, v58
    v_accvgpr_write_b32 a123, v59
    v_accvgpr_write_b32 a124, v60
    v_accvgpr_write_b32 a126, v61
    v_accvgpr_write_b32 a125, v62
    v_accvgpr_write_b32 a127, v63
    s_barrier
    s_load_dwordx2 s[42:43], s[0:1], 48
    s_lshl_b32 s37, s4, 8
    s_lshl_b32 s38, s5, 19
    s_add_u32 s37, s37, s38
    s_add_u32 s37, s37, 2097152
    s_lshl_b32 s39, s5, 14
    s_add_u32 s39, s39, 65536
    s_waitcnt lgkmcnt(0)
    s_add_u32 s42, s42, s37
    s_addc_u32 s43, s43, 0
    s_mov_b32 m0, s39
    s_add_u32 s39, s39, 1024
    global_load_lds_dwordx4 v46, s[42:43]
    s_add_u32 s42, s42, 32768
    s_addc_u32 s43, s43, 0
    s_mov_b32 m0, s39
    s_add_u32 s39, s39, 1024
    global_load_lds_dwordx4 v47, s[42:43]
    s_add_u32 s42, s42, 32768
    s_addc_u32 s43, s43, 0
    s_mov_b32 m0, s39
    s_add_u32 s39, s39, 1024
    global_load_lds_dwordx4 v46, s[42:43]
    s_add_u32 s42, s42, 32768
    s_addc_u32 s43, s43, 0
    s_mov_b32 m0, s39
    s_add_u32 s39, s39, 1024
    global_load_lds_dwordx4 v47, s[42:43]
    s_add_u32 s42, s42, 32768
    s_addc_u32 s43, s43, 0
    s_mov_b32 m0, s39
    s_add_u32 s39, s39, 1024
    global_load_lds_dwordx4 v46, s[42:43]
    s_add_u32 s42, s42, 32768
    s_addc_u32 s43, s43, 0
    s_mov_b32 m0, s39
    s_add_u32 s39, s39, 1024
    global_load_lds_dwordx4 v47, s[42:43]
    s_add_u32 s42, s42, 32768
    s_addc_u32 s43, s43, 0
    s_mov_b32 m0, s39
    s_add_u32 s39, s39, 1024
    global_load_lds_dwordx4 v46, s[42:43]
    s_add_u32 s42, s42, 32768
    s_addc_u32 s43, s43, 0
    s_mov_b32 m0, s39
    s_add_u32 s39, s39, 1024
    global_load_lds_dwordx4 v47, s[42:43]
    s_add_u32 s42, s42, 32768
    s_addc_u32 s43, s43, 0
    s_mov_b32 m0, s39
    s_add_u32 s39, s39, 1024
    global_load_lds_dwordx4 v46, s[42:43]
    s_add_u32 s42, s42, 32768
    s_addc_u32 s43, s43, 0
    s_mov_b32 m0, s39
    s_add_u32 s39, s39, 1024
    global_load_lds_dwordx4 v47, s[42:43]
    s_add_u32 s42, s42, 32768
    s_addc_u32 s43, s43, 0
    s_mov_b32 m0, s39
    s_add_u32 s39, s39, 1024
    global_load_lds_dwordx4 v46, s[42:43]
    s_add_u32 s42, s42, 32768
    s_addc_u32 s43, s43, 0
    s_mov_b32 m0, s39
    s_add_u32 s39, s39, 1024
    global_load_lds_dwordx4 v47, s[42:43]
    s_add_u32 s42, s42, 32768
    s_addc_u32 s43, s43, 0
    s_mov_b32 m0, s39
    s_add_u32 s39, s39, 1024
    global_load_lds_dwordx4 v46, s[42:43]
    s_add_u32 s42, s42, 32768
    s_addc_u32 s43, s43, 0
    s_mov_b32 m0, s39
    s_add_u32 s39, s39, 1024
    global_load_lds_dwordx4 v47, s[42:43]
    s_add_u32 s42, s42, 32768
    s_addc_u32 s43, s43, 0
    s_mov_b32 m0, s39
    s_add_u32 s39, s39, 1024
    global_load_lds_dwordx4 v46, s[42:43]
    s_add_u32 s42, s42, 32768
    s_addc_u32 s43, s43, 0
    s_mov_b32 m0, s39
    s_add_u32 s39, s39, 1024
    global_load_lds_dwordx4 v47, s[42:43]
    s_add_u32 s42, s42, 32768
    s_addc_u32 s43, s43, 0
    s_waitcnt vmcnt(16)
    s_barrier
    ds_read_b64_tr_b16 v[56:57], v50 offset:0
    ds_read_b64_tr_b16 v[58:59], v51 offset:0
    ds_read_b64_tr_b16 v[60:61], v50 offset:4096
    ds_read_b64_tr_b16 v[62:63], v51 offset:4096
    s_waitcnt lgkmcnt(0)
    v_accvgpr_write_b32 a128, v56
    v_accvgpr_write_b32 a130, v57
    v_accvgpr_write_b32 a129, v58
    v_accvgpr_write_b32 a131, v59
    v_accvgpr_write_b32 a132, v60
    v_accvgpr_write_b32 a134, v61
    v_accvgpr_write_b32 a133, v62
    v_accvgpr_write_b32 a135, v63
    ds_read_b64_tr_b16 v[56:57], v50 offset:8192
    ds_read_b64_tr_b16 v[58:59], v51 offset:8192
    ds_read_b64_tr_b16 v[60:61], v50 offset:12288
    ds_read_b64_tr_b16 v[62:63], v51 offset:12288
    s_waitcnt lgkmcnt(0)
    v_accvgpr_write_b32 a136, v56
    v_accvgpr_write_b32 a138, v57
    v_accvgpr_write_b32 a137, v58
    v_accvgpr_write_b32 a139, v59
    v_accvgpr_write_b32 a140, v60
    v_accvgpr_write_b32 a142, v61
    v_accvgpr_write_b32 a141, v62
    v_accvgpr_write_b32 a143, v63
    ds_read_b64_tr_b16 v[56:57], v50 offset:16384
    ds_read_b64_tr_b16 v[58:59], v51 offset:16384
    ds_read_b64_tr_b16 v[60:61], v50 offset:20480
    ds_read_b64_tr_b16 v[62:63], v51 offset:20480
    s_waitcnt lgkmcnt(0)
    v_accvgpr_write_b32 a144, v56
    v_accvgpr_write_b32 a146, v57
    v_accvgpr_write_b32 a145, v58
    v_accvgpr_write_b32 a147, v59
    v_accvgpr_write_b32 a148, v60
    v_accvgpr_write_b32 a150, v61
    v_accvgpr_write_b32 a149, v62
    v_accvgpr_write_b32 a151, v63
    ds_read_b64_tr_b16 v[56:57], v50 offset:24576
    ds_read_b64_tr_b16 v[58:59], v51 offset:24576
    ds_read_b64_tr_b16 v[60:61], v50 offset:28672
    ds_read_b64_tr_b16 v[62:63], v51 offset:28672
    s_waitcnt lgkmcnt(0)
    v_accvgpr_write_b32 a152, v56
    v_accvgpr_write_b32 a154, v57
    v_accvgpr_write_b32 a153, v58
    v_accvgpr_write_b32 a155, v59
    v_accvgpr_write_b32 a156, v60
    v_accvgpr_write_b32 a158, v61
    v_accvgpr_write_b32 a157, v62
    v_accvgpr_write_b32 a159, v63
    ds_read_b64_tr_b16 v[56:57], v50 offset:32768
    ds_read_b64_tr_b16 v[58:59], v51 offset:32768
    ds_read_b64_tr_b16 v[60:61], v50 offset:36864
    ds_read_b64_tr_b16 v[62:63], v51 offset:36864
    s_waitcnt lgkmcnt(0)
    v_accvgpr_write_b32 a160, v56
    v_accvgpr_write_b32 a162, v57
    v_accvgpr_write_b32 a161, v58
    v_accvgpr_write_b32 a163, v59
    v_accvgpr_write_b32 a164, v60
    v_accvgpr_write_b32 a166, v61
    v_accvgpr_write_b32 a165, v62
    v_accvgpr_write_b32 a167, v63
    ds_read_b64_tr_b16 v[56:57], v50 offset:40960
    ds_read_b64_tr_b16 v[58:59], v51 offset:40960
    ds_read_b64_tr_b16 v[60:61], v50 offset:45056
    ds_read_b64_tr_b16 v[62:63], v51 offset:45056
    s_waitcnt lgkmcnt(0)
    v_accvgpr_write_b32 a168, v56
    v_accvgpr_write_b32 a170, v57
    v_accvgpr_write_b32 a169, v58
    v_accvgpr_write_b32 a171, v59
    v_accvgpr_write_b32 a172, v60
    v_accvgpr_write_b32 a174, v61
    v_accvgpr_write_b32 a173, v62
    v_accvgpr_write_b32 a175, v63
    ds_read_b64_tr_b16 v[56:57], v50 offset:49152
    ds_read_b64_tr_b16 v[58:59], v51 offset:49152
    ds_read_b64_tr_b16 v[60:61], v50 offset:53248
    ds_read_b64_tr_b16 v[62:63], v51 offset:53248
    s_waitcnt lgkmcnt(0)
    v_accvgpr_write_b32 a176, v56
    v_accvgpr_write_b32 a178, v57
    v_accvgpr_write_b32 a177, v58
    v_accvgpr_write_b32 a179, v59
    v_accvgpr_write_b32 a180, v60
    v_accvgpr_write_b32 a182, v61
    v_accvgpr_write_b32 a181, v62
    v_accvgpr_write_b32 a183, v63
    ds_read_b64_tr_b16 v[56:57], v50 offset:57344
    ds_read_b64_tr_b16 v[58:59], v51 offset:57344
    ds_read_b64_tr_b16 v[60:61], v50 offset:61440
    ds_read_b64_tr_b16 v[62:63], v51 offset:61440
    s_waitcnt lgkmcnt(0)
    v_accvgpr_write_b32 a184, v56
    v_accvgpr_write_b32 a186, v57
    v_accvgpr_write_b32 a185, v58
    v_accvgpr_write_b32 a187, v59
    v_accvgpr_write_b32 a188, v60
    v_accvgpr_write_b32 a190, v61
    v_accvgpr_write_b32 a189, v62
    v_accvgpr_write_b32 a191, v63
    s_barrier
    s_load_dwordx2 s[42:43], s[0:1], 56
    s_lshl_b32 s37, s4, 8
    s_lshl_b32 s38, s5, 19
    s_add_u32 s37, s37, s38
    s_add_u32 s37, s37, 0
    s_lshl_b32 s39, s5, 14
    s_add_u32 s39, s39, 0
    s_waitcnt lgkmcnt(0)
    s_add_u32 s42, s42, s37
    s_addc_u32 s43, s43, 0
    s_mov_b32 m0, s39
    s_add_u32 s39, s39, 1024
    global_load_lds_dwordx4 v46, s[42:43]
    s_add_u32 s42, s42, 32768
    s_addc_u32 s43, s43, 0
    s_mov_b32 m0, s39
    s_add_u32 s39, s39, 1024
    global_load_lds_dwordx4 v47, s[42:43]
    s_add_u32 s42, s42, 32768
    s_addc_u32 s43, s43, 0
    s_mov_b32 m0, s39
    s_add_u32 s39, s39, 1024
    global_load_lds_dwordx4 v46, s[42:43]
    s_add_u32 s42, s42, 32768
    s_addc_u32 s43, s43, 0
    s_mov_b32 m0, s39
    s_add_u32 s39, s39, 1024
    global_load_lds_dwordx4 v47, s[42:43]
    s_add_u32 s42, s42, 32768
    s_addc_u32 s43, s43, 0
    s_mov_b32 m0, s39
    s_add_u32 s39, s39, 1024
    global_load_lds_dwordx4 v46, s[42:43]
    s_add_u32 s42, s42, 32768
    s_addc_u32 s43, s43, 0
    s_mov_b32 m0, s39
    s_add_u32 s39, s39, 1024
    global_load_lds_dwordx4 v47, s[42:43]
    s_add_u32 s42, s42, 32768
    s_addc_u32 s43, s43, 0
    s_mov_b32 m0, s39
    s_add_u32 s39, s39, 1024
    global_load_lds_dwordx4 v46, s[42:43]
    s_add_u32 s42, s42, 32768
    s_addc_u32 s43, s43, 0
    s_mov_b32 m0, s39
    s_add_u32 s39, s39, 1024
    global_load_lds_dwordx4 v47, s[42:43]
    s_add_u32 s42, s42, 32768
    s_addc_u32 s43, s43, 0
    s_mov_b32 m0, s39
    s_add_u32 s39, s39, 1024
    global_load_lds_dwordx4 v46, s[42:43]
    s_add_u32 s42, s42, 32768
    s_addc_u32 s43, s43, 0
    s_mov_b32 m0, s39
    s_add_u32 s39, s39, 1024
    global_load_lds_dwordx4 v47, s[42:43]
    s_add_u32 s42, s42, 32768
    s_addc_u32 s43, s43, 0
    s_mov_b32 m0, s39
    s_add_u32 s39, s39, 1024
    global_load_lds_dwordx4 v46, s[42:43]
    s_add_u32 s42, s42, 32768
    s_addc_u32 s43, s43, 0
    s_mov_b32 m0, s39
    s_add_u32 s39, s39, 1024
    global_load_lds_dwordx4 v47, s[42:43]
    s_add_u32 s42, s42, 32768
    s_addc_u32 s43, s43, 0
    s_mov_b32 m0, s39
    s_add_u32 s39, s39, 1024
    global_load_lds_dwordx4 v46, s[42:43]
    s_add_u32 s42, s42, 32768
    s_addc_u32 s43, s43, 0
    s_mov_b32 m0, s39
    s_add_u32 s39, s39, 1024
    global_load_lds_dwordx4 v47, s[42:43]
    s_add_u32 s42, s42, 32768
    s_addc_u32 s43, s43, 0
    s_mov_b32 m0, s39
    s_add_u32 s39, s39, 1024
    global_load_lds_dwordx4 v46, s[42:43]
    s_add_u32 s42, s42, 32768
    s_addc_u32 s43, s43, 0
    s_mov_b32 m0, s39
    s_add_u32 s39, s39, 1024
    global_load_lds_dwordx4 v47, s[42:43]
    s_add_u32 s42, s42, 32768
    s_addc_u32 s43, s43, 0
    s_waitcnt vmcnt(16)
    s_barrier
    ds_read_b64_tr_b16 v[56:57], v52 offset:0
    ds_read_b64_tr_b16 v[58:59], v53 offset:0
    ds_read_b64_tr_b16 v[60:61], v52 offset:4096
    ds_read_b64_tr_b16 v[62:63], v53 offset:4096
    s_waitcnt lgkmcnt(0)
    v_accvgpr_write_b32 a192, v56
    v_accvgpr_write_b32 a194, v57
    v_accvgpr_write_b32 a193, v58
    v_accvgpr_write_b32 a195, v59
    v_accvgpr_write_b32 a196, v60
    v_accvgpr_write_b32 a198, v61
    v_accvgpr_write_b32 a197, v62
    v_accvgpr_write_b32 a199, v63
    ds_read_b64_tr_b16 v[56:57], v52 offset:8192
    ds_read_b64_tr_b16 v[58:59], v53 offset:8192
    ds_read_b64_tr_b16 v[60:61], v52 offset:12288
    ds_read_b64_tr_b16 v[62:63], v53 offset:12288
    s_waitcnt lgkmcnt(0)
    v_accvgpr_write_b32 a200, v56
    v_accvgpr_write_b32 a202, v57
    v_accvgpr_write_b32 a201, v58
    v_accvgpr_write_b32 a203, v59
    v_accvgpr_write_b32 a204, v60
    v_accvgpr_write_b32 a206, v61
    v_accvgpr_write_b32 a205, v62
    v_accvgpr_write_b32 a207, v63
    ds_read_b64_tr_b16 v[56:57], v52 offset:16384
    ds_read_b64_tr_b16 v[58:59], v53 offset:16384
    ds_read_b64_tr_b16 v[60:61], v52 offset:20480
    ds_read_b64_tr_b16 v[62:63], v53 offset:20480
    s_waitcnt lgkmcnt(0)
    v_accvgpr_write_b32 a208, v56
    v_accvgpr_write_b32 a210, v57
    v_accvgpr_write_b32 a209, v58
    v_accvgpr_write_b32 a211, v59
    v_accvgpr_write_b32 a212, v60
    v_accvgpr_write_b32 a214, v61
    v_accvgpr_write_b32 a213, v62
    v_accvgpr_write_b32 a215, v63
    ds_read_b64_tr_b16 v[56:57], v52 offset:24576
    ds_read_b64_tr_b16 v[58:59], v53 offset:24576
    ds_read_b64_tr_b16 v[60:61], v52 offset:28672
    ds_read_b64_tr_b16 v[62:63], v53 offset:28672
    s_waitcnt lgkmcnt(0)
    v_accvgpr_write_b32 a216, v56
    v_accvgpr_write_b32 a218, v57
    v_accvgpr_write_b32 a217, v58
    v_accvgpr_write_b32 a219, v59
    v_accvgpr_write_b32 a220, v60
    v_accvgpr_write_b32 a222, v61
    v_accvgpr_write_b32 a221, v62
    v_accvgpr_write_b32 a223, v63
    ds_read_b64_tr_b16 v[56:57], v52 offset:32768
    ds_read_b64_tr_b16 v[58:59], v53 offset:32768
    ds_read_b64_tr_b16 v[60:61], v52 offset:36864
    ds_read_b64_tr_b16 v[62:63], v53 offset:36864
    s_waitcnt lgkmcnt(0)
    v_accvgpr_write_b32 a224, v56
    v_accvgpr_write_b32 a226, v57
    v_accvgpr_write_b32 a225, v58
    v_accvgpr_write_b32 a227, v59
    v_accvgpr_write_b32 a228, v60
    v_accvgpr_write_b32 a230, v61
    v_accvgpr_write_b32 a229, v62
    v_accvgpr_write_b32 a231, v63
    ds_read_b64_tr_b16 v[56:57], v52 offset:40960
    ds_read_b64_tr_b16 v[58:59], v53 offset:40960
    ds_read_b64_tr_b16 v[60:61], v52 offset:45056
    ds_read_b64_tr_b16 v[62:63], v53 offset:45056
    s_waitcnt lgkmcnt(0)
    v_accvgpr_write_b32 a232, v56
    v_accvgpr_write_b32 a234, v57
    v_accvgpr_write_b32 a233, v58
    v_accvgpr_write_b32 a235, v59
    v_accvgpr_write_b32 a236, v60
    v_accvgpr_write_b32 a238, v61
    v_accvgpr_write_b32 a237, v62
    v_accvgpr_write_b32 a239, v63
    ds_read_b64_tr_b16 v[56:57], v52 offset:49152
    ds_read_b64_tr_b16 v[58:59], v53 offset:49152
    ds_read_b64_tr_b16 v[60:61], v52 offset:53248
    ds_read_b64_tr_b16 v[62:63], v53 offset:53248
    s_waitcnt lgkmcnt(0)
    v_accvgpr_write_b32 a240, v56
    v_accvgpr_write_b32 a242, v57
    v_accvgpr_write_b32 a241, v58
    v_accvgpr_write_b32 a243, v59
    v_accvgpr_write_b32 a244, v60
    v_accvgpr_write_b32 a246, v61
    v_accvgpr_write_b32 a245, v62
    v_accvgpr_write_b32 a247, v63
    ds_read_b64_tr_b16 v[56:57], v52 offset:57344
    ds_read_b64_tr_b16 v[58:59], v53 offset:57344
    ds_read_b64_tr_b16 v[60:61], v52 offset:61440
    ds_read_b64_tr_b16 v[62:63], v53 offset:61440
    s_waitcnt lgkmcnt(0)
    v_accvgpr_write_b32 a248, v56
    v_accvgpr_write_b32 a250, v57
    v_accvgpr_write_b32 a249, v58
    v_accvgpr_write_b32 a251, v59
    v_accvgpr_write_b32 a252, v60
    v_accvgpr_write_b32 a254, v61
    v_accvgpr_write_b32 a253, v62
    v_accvgpr_write_b32 a255, v63
    s_barrier
    s_load_dwordx2 s[42:43], s[0:1], 56
    s_lshl_b32 s37, s4, 8
    s_lshl_b32 s38, s5, 19
    s_add_u32 s37, s37, s38
    s_add_u32 s37, s37, 2097152
    s_lshl_b32 s39, s5, 14
    s_add_u32 s39, s39, 65536
    s_waitcnt lgkmcnt(0)
    s_add_u32 s42, s42, s37
    s_addc_u32 s43, s43, 0
    s_mov_b32 m0, s39
    s_add_u32 s39, s39, 1024
    global_load_lds_dwordx4 v46, s[42:43]
    s_add_u32 s42, s42, 32768
    s_addc_u32 s43, s43, 0
    s_mov_b32 m0, s39
    s_add_u32 s39, s39, 1024
    global_load_lds_dwordx4 v47, s[42:43]
    s_add_u32 s42, s42, 32768
    s_addc_u32 s43, s43, 0
    s_mov_b32 m0, s39
    s_add_u32 s39, s39, 1024
    global_load_lds_dwordx4 v46, s[42:43]
    s_add_u32 s42, s42, 32768
    s_addc_u32 s43, s43, 0
    s_mov_b32 m0, s39
    s_add_u32 s39, s39, 1024
    global_load_lds_dwordx4 v47, s[42:43]
    s_add_u32 s42, s42, 32768
    s_addc_u32 s43, s43, 0
    s_mov_b32 m0, s39
    s_add_u32 s39, s39, 1024
    global_load_lds_dwordx4 v46, s[42:43]
    s_add_u32 s42, s42, 32768
    s_addc_u32 s43, s43, 0
    s_mov_b32 m0, s39
    s_add_u32 s39, s39, 1024
    global_load_lds_dwordx4 v47, s[42:43]
    s_add_u32 s42, s42, 32768
    s_addc_u32 s43, s43, 0
    s_mov_b32 m0, s39
    s_add_u32 s39, s39, 1024
    global_load_lds_dwordx4 v46, s[42:43]
    s_add_u32 s42, s42, 32768
    s_addc_u32 s43, s43, 0
    s_mov_b32 m0, s39
    s_add_u32 s39, s39, 1024
    global_load_lds_dwordx4 v47, s[42:43]
    s_add_u32 s42, s42, 32768
    s_addc_u32 s43, s43, 0
    s_mov_b32 m0, s39
    s_add_u32 s39, s39, 1024
    global_load_lds_dwordx4 v46, s[42:43]
    s_add_u32 s42, s42, 32768
    s_addc_u32 s43, s43, 0
    s_mov_b32 m0, s39
    s_add_u32 s39, s39, 1024
    global_load_lds_dwordx4 v47, s[42:43]
    s_add_u32 s42, s42, 32768
    s_addc_u32 s43, s43, 0
    s_mov_b32 m0, s39
    s_add_u32 s39, s39, 1024
    global_load_lds_dwordx4 v46, s[42:43]
    s_add_u32 s42, s42, 32768
    s_addc_u32 s43, s43, 0
    s_mov_b32 m0, s39
    s_add_u32 s39, s39, 1024
    global_load_lds_dwordx4 v47, s[42:43]
    s_add_u32 s42, s42, 32768
    s_addc_u32 s43, s43, 0
    s_mov_b32 m0, s39
    s_add_u32 s39, s39, 1024
    global_load_lds_dwordx4 v46, s[42:43]
    s_add_u32 s42, s42, 32768
    s_addc_u32 s43, s43, 0
    s_mov_b32 m0, s39
    s_add_u32 s39, s39, 1024
    global_load_lds_dwordx4 v47, s[42:43]
    s_add_u32 s42, s42, 32768
    s_addc_u32 s43, s43, 0
    s_mov_b32 m0, s39
    s_add_u32 s39, s39, 1024
    global_load_lds_dwordx4 v46, s[42:43]
    s_add_u32 s42, s42, 32768
    s_addc_u32 s43, s43, 0
    s_mov_b32 m0, s39
    s_add_u32 s39, s39, 1024
    global_load_lds_dwordx4 v47, s[42:43]
    s_add_u32 s42, s42, 32768
    s_addc_u32 s43, s43, 0
    s_waitcnt vmcnt(16)
    s_barrier
    ds_read_b64_tr_b16 v[56:57], v50 offset:0
    ds_read_b64_tr_b16 v[58:59], v51 offset:0
    ds_read_b64_tr_b16 v[60:61], v50 offset:4096
    ds_read_b64_tr_b16 v[62:63], v51 offset:4096
    s_waitcnt lgkmcnt(0)
    v_mov_b32 v128, v56
    v_mov_b32 v130, v57
    v_mov_b32 v129, v58
    v_mov_b32 v131, v59
    v_mov_b32 v132, v60
    v_mov_b32 v134, v61
    v_mov_b32 v133, v62
    v_mov_b32 v135, v63
    ds_read_b64_tr_b16 v[56:57], v50 offset:8192
    ds_read_b64_tr_b16 v[58:59], v51 offset:8192
    ds_read_b64_tr_b16 v[60:61], v50 offset:12288
    ds_read_b64_tr_b16 v[62:63], v51 offset:12288
    s_waitcnt lgkmcnt(0)
    v_mov_b32 v136, v56
    v_mov_b32 v138, v57
    v_mov_b32 v137, v58
    v_mov_b32 v139, v59
    v_mov_b32 v140, v60
    v_mov_b32 v142, v61
    v_mov_b32 v141, v62
    v_mov_b32 v143, v63
    ds_read_b64_tr_b16 v[56:57], v50 offset:16384
    ds_read_b64_tr_b16 v[58:59], v51 offset:16384
    ds_read_b64_tr_b16 v[60:61], v50 offset:20480
    ds_read_b64_tr_b16 v[62:63], v51 offset:20480
    s_waitcnt lgkmcnt(0)
    v_mov_b32 v144, v56
    v_mov_b32 v146, v57
    v_mov_b32 v145, v58
    v_mov_b32 v147, v59
    v_mov_b32 v148, v60
    v_mov_b32 v150, v61
    v_mov_b32 v149, v62
    v_mov_b32 v151, v63
    ds_read_b64_tr_b16 v[56:57], v50 offset:24576
    ds_read_b64_tr_b16 v[58:59], v51 offset:24576
    ds_read_b64_tr_b16 v[60:61], v50 offset:28672
    ds_read_b64_tr_b16 v[62:63], v51 offset:28672
    s_waitcnt lgkmcnt(0)
    v_mov_b32 v152, v56
    v_mov_b32 v154, v57
    v_mov_b32 v153, v58
    v_mov_b32 v155, v59
    v_mov_b32 v156, v60
    v_mov_b32 v158, v61
    v_mov_b32 v157, v62
    v_mov_b32 v159, v63
    ds_read_b64_tr_b16 v[56:57], v50 offset:32768
    ds_read_b64_tr_b16 v[58:59], v51 offset:32768
    ds_read_b64_tr_b16 v[60:61], v50 offset:36864
    ds_read_b64_tr_b16 v[62:63], v51 offset:36864
    s_waitcnt lgkmcnt(0)
    v_mov_b32 v160, v56
    v_mov_b32 v162, v57
    v_mov_b32 v161, v58
    v_mov_b32 v163, v59
    v_mov_b32 v164, v60
    v_mov_b32 v166, v61
    v_mov_b32 v165, v62
    v_mov_b32 v167, v63
    ds_read_b64_tr_b16 v[56:57], v50 offset:40960
    ds_read_b64_tr_b16 v[58:59], v51 offset:40960
    ds_read_b64_tr_b16 v[60:61], v50 offset:45056
    ds_read_b64_tr_b16 v[62:63], v51 offset:45056
    s_waitcnt lgkmcnt(0)
    v_mov_b32 v168, v56
    v_mov_b32 v170, v57
    v_mov_b32 v169, v58
    v_mov_b32 v171, v59
    v_mov_b32 v172, v60
    v_mov_b32 v174, v61
    v_mov_b32 v173, v62
    v_mov_b32 v175, v63
    ds_read_b64_tr_b16 v[56:57], v50 offset:49152
    ds_read_b64_tr_b16 v[58:59], v51 offset:49152
    ds_read_b64_tr_b16 v[60:61], v50 offset:53248
    ds_read_b64_tr_b16 v[62:63], v51 offset:53248
    s_waitcnt lgkmcnt(0)
    v_mov_b32 v176, v56
    v_mov_b32 v178, v57
    v_mov_b32 v177, v58
    v_mov_b32 v179, v59
    v_mov_b32 v180, v60
    v_mov_b32 v182, v61
    v_mov_b32 v181, v62
    v_mov_b32 v183, v63
    ds_read_b64_tr_b16 v[56:57], v50 offset:57344
    ds_read_b64_tr_b16 v[58:59], v51 offset:57344
    ds_read_b64_tr_b16 v[60:61], v50 offset:61440
    ds_read_b64_tr_b16 v[62:63], v51 offset:61440
    s_waitcnt lgkmcnt(0)
    v_mov_b32 v184, v56
    v_mov_b32 v186, v57
    v_mov_b32 v185, v58
    v_mov_b32 v187, v59
    v_mov_b32 v188, v60
    v_mov_b32 v190, v61
    v_mov_b32 v189, v62
    v_mov_b32 v191, v63
    s_barrier
    s_load_dwordx2 s[42:43], s[0:1], 64
    s_lshl_b32 s37, s4, 17
    s_lshl_b32 s38, s5, 14
    s_add_u32 s37, s37, s38
    s_add_u32 s37, s37, 0
    s_add_u32 s39, s38, 0
    s_waitcnt lgkmcnt(0)
    s_add_u32 s42, s42, s37
    s_addc_u32 s43, s43, 0
    s_mov_b32 m0, s39
    s_add_u32 s39, s39, 1024
    global_load_lds_dwordx4 v64, s[42:43]
    s_add_u32 s42, s42, 1024
    s_addc_u32 s43, s43, 0
    s_mov_b32 m0, s39
    s_add_u32 s39, s39, 1024
    global_load_lds_dwordx4 v65, s[42:43]
    s_add_u32 s42, s42, 1024
    s_addc_u32 s43, s43, 0
    s_mov_b32 m0, s39
    s_add_u32 s39, s39, 1024
    global_load_lds_dwordx4 v66, s[42:43]
    s_add_u32 s42, s42, 1024
    s_addc_u32 s43, s43, 0
    s_mov_b32 m0, s39
    s_add_u32 s39, s39, 1024
    global_load_lds_dwordx4 v67, s[42:43]
    s_add_u32 s42, s42, 1024
    s_addc_u32 s43, s43, 0
    s_mov_b32 m0, s39
    s_add_u32 s39, s39, 1024
    global_load_lds_dwordx4 v68, s[42:43]
    s_add_u32 s42, s42, 1024
    s_addc_u32 s43, s43, 0
    s_mov_b32 m0, s39
    s_add_u32 s39, s39, 1024
    global_load_lds_dwordx4 v69, s[42:43]
    s_add_u32 s42, s42, 1024
    s_addc_u32 s43, s43, 0
    s_mov_b32 m0, s39
    s_add_u32 s39, s39, 1024
    global_load_lds_dwordx4 v70, s[42:43]
    s_add_u32 s42, s42, 1024
    s_addc_u32 s43, s43, 0
    s_mov_b32 m0, s39
    s_add_u32 s39, s39, 1024
    global_load_lds_dwordx4 v71, s[42:43]
    s_add_u32 s42, s42, 1024
    s_addc_u32 s43, s43, 0
    s_mov_b32 m0, s39
    s_add_u32 s39, s39, 1024
    global_load_lds_dwordx4 v64, s[42:43]
    s_add_u32 s42, s42, 1024
    s_addc_u32 s43, s43, 0
    s_mov_b32 m0, s39
    s_add_u32 s39, s39, 1024
    global_load_lds_dwordx4 v65, s[42:43]
    s_add_u32 s42, s42, 1024
    s_addc_u32 s43, s43, 0
    s_mov_b32 m0, s39
    s_add_u32 s39, s39, 1024
    global_load_lds_dwordx4 v66, s[42:43]
    s_add_u32 s42, s42, 1024
    s_addc_u32 s43, s43, 0
    s_mov_b32 m0, s39
    s_add_u32 s39, s39, 1024
    global_load_lds_dwordx4 v67, s[42:43]
    s_add_u32 s42, s42, 1024
    s_addc_u32 s43, s43, 0
    s_mov_b32 m0, s39
    s_add_u32 s39, s39, 1024
    global_load_lds_dwordx4 v68, s[42:43]
    s_add_u32 s42, s42, 1024
    s_addc_u32 s43, s43, 0
    s_mov_b32 m0, s39
    s_add_u32 s39, s39, 1024
    global_load_lds_dwordx4 v69, s[42:43]
    s_add_u32 s42, s42, 1024
    s_addc_u32 s43, s43, 0
    s_mov_b32 m0, s39
    s_add_u32 s39, s39, 1024
    global_load_lds_dwordx4 v70, s[42:43]
    s_add_u32 s42, s42, 1024
    s_addc_u32 s43, s43, 0
    s_mov_b32 m0, s39
    s_add_u32 s39, s39, 1024
    global_load_lds_dwordx4 v71, s[42:43]
    s_add_u32 s42, s42, 1024
    s_addc_u32 s43, s43, 0
    s_waitcnt vmcnt(16)
    s_barrier
    ds_read_b64_tr_b16 v[56:57], v52 offset:0
    ds_read_b64_tr_b16 v[58:59], v53 offset:0
    ds_read_b64_tr_b16 v[60:61], v52 offset:4096
    ds_read_b64_tr_b16 v[62:63], v53 offset:4096
    s_waitcnt lgkmcnt(0)
    v_mov_b32 v192, v56
    v_mov_b32 v194, v57
    v_mov_b32 v193, v58
    v_mov_b32 v195, v59
    v_mov_b32 v196, v60
    v_mov_b32 v198, v61
    v_mov_b32 v197, v62
    v_mov_b32 v199, v63
    ds_read_b64_tr_b16 v[56:57], v52 offset:8192
    ds_read_b64_tr_b16 v[58:59], v53 offset:8192
    ds_read_b64_tr_b16 v[60:61], v52 offset:12288
    ds_read_b64_tr_b16 v[62:63], v53 offset:12288
    s_waitcnt lgkmcnt(0)
    v_mov_b32 v200, v56
    v_mov_b32 v202, v57
    v_mov_b32 v201, v58
    v_mov_b32 v203, v59
    v_mov_b32 v204, v60
    v_mov_b32 v206, v61
    v_mov_b32 v205, v62
    v_mov_b32 v207, v63
    ds_read_b64_tr_b16 v[56:57], v52 offset:16384
    ds_read_b64_tr_b16 v[58:59], v53 offset:16384
    ds_read_b64_tr_b16 v[60:61], v52 offset:20480
    ds_read_b64_tr_b16 v[62:63], v53 offset:20480
    s_waitcnt lgkmcnt(0)
    v_mov_b32 v208, v56
    v_mov_b32 v210, v57
    v_mov_b32 v209, v58
    v_mov_b32 v211, v59
    v_mov_b32 v212, v60
    v_mov_b32 v214, v61
    v_mov_b32 v213, v62
    v_mov_b32 v215, v63
    ds_read_b64_tr_b16 v[56:57], v52 offset:24576
    ds_read_b64_tr_b16 v[58:59], v53 offset:24576
    ds_read_b64_tr_b16 v[60:61], v52 offset:28672
    ds_read_b64_tr_b16 v[62:63], v53 offset:28672
    s_waitcnt lgkmcnt(0)
    v_mov_b32 v216, v56
    v_mov_b32 v218, v57
    v_mov_b32 v217, v58
    v_mov_b32 v219, v59
    v_mov_b32 v220, v60
    v_mov_b32 v222, v61
    v_mov_b32 v221, v62
    v_mov_b32 v223, v63
    ds_read_b64_tr_b16 v[56:57], v52 offset:32768
    ds_read_b64_tr_b16 v[58:59], v53 offset:32768
    ds_read_b64_tr_b16 v[60:61], v52 offset:36864
    ds_read_b64_tr_b16 v[62:63], v53 offset:36864
    s_waitcnt lgkmcnt(0)
    v_mov_b32 v224, v56
    v_mov_b32 v226, v57
    v_mov_b32 v225, v58
    v_mov_b32 v227, v59
    v_mov_b32 v228, v60
    v_mov_b32 v230, v61
    v_mov_b32 v229, v62
    v_mov_b32 v231, v63
    ds_read_b64_tr_b16 v[56:57], v52 offset:40960
    ds_read_b64_tr_b16 v[58:59], v53 offset:40960
    ds_read_b64_tr_b16 v[60:61], v52 offset:45056
    ds_read_b64_tr_b16 v[62:63], v53 offset:45056
    s_waitcnt lgkmcnt(0)
    v_mov_b32 v232, v56
    v_mov_b32 v234, v57
    v_mov_b32 v233, v58
    v_mov_b32 v235, v59
    v_mov_b32 v236, v60
    v_mov_b32 v238, v61
    v_mov_b32 v237, v62
    v_mov_b32 v239, v63
    ds_read_b64_tr_b16 v[56:57], v52 offset:49152
    ds_read_b64_tr_b16 v[58:59], v53 offset:49152
    ds_read_b64_tr_b16 v[60:61], v52 offset:53248
    ds_read_b64_tr_b16 v[62:63], v53 offset:53248
    s_waitcnt lgkmcnt(0)
    v_mov_b32 v240, v56
    v_mov_b32 v242, v57
    v_mov_b32 v241, v58
    v_mov_b32 v243, v59
    v_mov_b32 v244, v60
    v_mov_b32 v246, v61
    v_mov_b32 v245, v62
    v_mov_b32 v247, v63
    ds_read_b64_tr_b16 v[56:57], v52 offset:57344
    ds_read_b64_tr_b16 v[58:59], v53 offset:57344
    ds_read_b64_tr_b16 v[60:61], v52 offset:61440
    ds_read_b64_tr_b16 v[62:63], v53 offset:61440
    s_waitcnt lgkmcnt(0)
    v_mov_b32 v248, v56
    v_mov_b32 v250, v57
    v_mov_b32 v249, v58
    v_mov_b32 v251, v59
    v_mov_b32 v252, v60
    v_mov_b32 v254, v61
    v_mov_b32 v253, v62
    v_mov_b32 v255, v63
    s_barrier
    s_load_dwordx2 s[42:43], s[0:1], 64
    s_lshl_b32 s37, s4, 17
    s_lshl_b32 s38, s5, 14
    s_add_u32 s37, s37, s38
    s_add_u32 s37, s37, 65536
    s_add_u32 s39, s38, 65536
    s_waitcnt lgkmcnt(0)
    s_add_u32 s42, s42, s37
    s_addc_u32 s43, s43, 0
    s_mov_b32 m0, s39
    s_add_u32 s39, s39, 1024
    global_load_lds_dwordx4 v64, s[42:43]
    s_add_u32 s42, s42, 1024
    s_addc_u32 s43, s43, 0
    s_mov_b32 m0, s39
    s_add_u32 s39, s39, 1024
    global_load_lds_dwordx4 v65, s[42:43]
    s_add_u32 s42, s42, 1024
    s_addc_u32 s43, s43, 0
    s_mov_b32 m0, s39
    s_add_u32 s39, s39, 1024
    global_load_lds_dwordx4 v66, s[42:43]
    s_add_u32 s42, s42, 1024
    s_addc_u32 s43, s43, 0
    s_mov_b32 m0, s39
    s_add_u32 s39, s39, 1024
    global_load_lds_dwordx4 v67, s[42:43]
    s_add_u32 s42, s42, 1024
    s_addc_u32 s43, s43, 0
    s_mov_b32 m0, s39
    s_add_u32 s39, s39, 1024
    global_load_lds_dwordx4 v68, s[42:43]
    s_add_u32 s42, s42, 1024
    s_addc_u32 s43, s43, 0
    s_mov_b32 m0, s39
    s_add_u32 s39, s39, 1024
    global_load_lds_dwordx4 v69, s[42:43]
    s_add_u32 s42, s42, 1024
    s_addc_u32 s43, s43, 0
    s_mov_b32 m0, s39
    s_add_u32 s39, s39, 1024
    global_load_lds_dwordx4 v70, s[42:43]
    s_add_u32 s42, s42, 1024
    s_addc_u32 s43, s43, 0
    s_mov_b32 m0, s39
    s_add_u32 s39, s39, 1024
    global_load_lds_dwordx4 v71, s[42:43]
    s_add_u32 s42, s42, 1024
    s_addc_u32 s43, s43, 0
    s_mov_b32 m0, s39
    s_add_u32 s39, s39, 1024
    global_load_lds_dwordx4 v64, s[42:43]
    s_add_u32 s42, s42, 1024
    s_addc_u32 s43, s43, 0
    s_mov_b32 m0, s39
    s_add_u32 s39, s39, 1024
    global_load_lds_dwordx4 v65, s[42:43]
    s_add_u32 s42, s42, 1024
    s_addc_u32 s43, s43, 0
    s_mov_b32 m0, s39
    s_add_u32 s39, s39, 1024
    global_load_lds_dwordx4 v66, s[42:43]
    s_add_u32 s42, s42, 1024
    s_addc_u32 s43, s43, 0
    s_mov_b32 m0, s39
    s_add_u32 s39, s39, 1024
    global_load_lds_dwordx4 v67, s[42:43]
    s_add_u32 s42, s42, 1024
    s_addc_u32 s43, s43, 0
    s_mov_b32 m0, s39
    s_add_u32 s39, s39, 1024
    global_load_lds_dwordx4 v68, s[42:43]
    s_add_u32 s42, s42, 1024
    s_addc_u32 s43, s43, 0
    s_mov_b32 m0, s39
    s_add_u32 s39, s39, 1024
    global_load_lds_dwordx4 v69, s[42:43]
    s_add_u32 s42, s42, 1024
    s_addc_u32 s43, s43, 0
    s_mov_b32 m0, s39
    s_add_u32 s39, s39, 1024
    global_load_lds_dwordx4 v70, s[42:43]
    s_add_u32 s42, s42, 1024
    s_addc_u32 s43, s43, 0
    s_mov_b32 m0, s39
    s_add_u32 s39, s39, 1024
    global_load_lds_dwordx4 v71, s[42:43]
    s_add_u32 s42, s42, 1024
    s_addc_u32 s43, s43, 0
    s_waitcnt vmcnt(16)
    s_barrier
    v_add_u32 v78, 0, v74
    v_xor_b32 v78, v78, v73
    v_lshl_add_u32 v78, v78, 4, v75
    v_add_u32 v78, 0, v78
    ds_read_b64_tr_b16 v[112:113], v78 offset:0
    v_add_u32 v78, 2, v74
    v_xor_b32 v78, v78, v73
    v_lshl_add_u32 v78, v78, 4, v75
    v_add_u32 v78, 0, v78
    ds_read_b64_tr_b16 v[114:115], v78 offset:0
    v_add_u32 v78, 0, v74
    v_xor_b32 v78, v78, v73
    v_lshl_add_u32 v78, v78, 4, v75
    v_add_u32 v78, 0, v78
    ds_read_b64_tr_b16 v[116:117], v78 offset:16384
    v_add_u32 v78, 2, v74
    v_xor_b32 v78, v78, v73
    v_lshl_add_u32 v78, v78, 4, v75
    v_add_u32 v78, 0, v78
    ds_read_b64_tr_b16 v[118:119], v78 offset:16384
    s_waitcnt lgkmcnt(0)
    v_mov_b32 v80, v112
    v_mov_b32 v82, v113
    v_mov_b32 v81, v114
    v_mov_b32 v83, v115
    v_mov_b32 v84, v116
    v_mov_b32 v86, v117
    v_mov_b32 v85, v118
    v_mov_b32 v87, v119
    v_add_u32 v78, 4, v74
    v_xor_b32 v78, v78, v73
    v_lshl_add_u32 v78, v78, 4, v75
    v_add_u32 v78, 0, v78
    ds_read_b64_tr_b16 v[112:113], v78 offset:0
    v_add_u32 v78, 6, v74
    v_xor_b32 v78, v78, v73
    v_lshl_add_u32 v78, v78, 4, v75
    v_add_u32 v78, 0, v78
    ds_read_b64_tr_b16 v[114:115], v78 offset:0
    v_add_u32 v78, 4, v74
    v_xor_b32 v78, v78, v73
    v_lshl_add_u32 v78, v78, 4, v75
    v_add_u32 v78, 0, v78
    ds_read_b64_tr_b16 v[116:117], v78 offset:16384
    v_add_u32 v78, 6, v74
    v_xor_b32 v78, v78, v73
    v_lshl_add_u32 v78, v78, 4, v75
    v_add_u32 v78, 0, v78
    ds_read_b64_tr_b16 v[118:119], v78 offset:16384
    s_waitcnt lgkmcnt(0)
    v_mov_b32 v88, v112
    v_mov_b32 v90, v113
    v_mov_b32 v89, v114
    v_mov_b32 v91, v115
    v_mov_b32 v92, v116
    v_mov_b32 v94, v117
    v_mov_b32 v93, v118
    v_mov_b32 v95, v119
    v_add_u32 v78, 8, v74
    v_xor_b32 v78, v78, v73
    v_lshl_add_u32 v78, v78, 4, v75
    v_add_u32 v78, 0, v78
    ds_read_b64_tr_b16 v[112:113], v78 offset:0
    v_add_u32 v78, 10, v74
    v_xor_b32 v78, v78, v73
    v_lshl_add_u32 v78, v78, 4, v75
    v_add_u32 v78, 0, v78
    ds_read_b64_tr_b16 v[114:115], v78 offset:0
    v_add_u32 v78, 8, v74
    v_xor_b32 v78, v78, v73
    v_lshl_add_u32 v78, v78, 4, v75
    v_add_u32 v78, 0, v78
    ds_read_b64_tr_b16 v[116:117], v78 offset:16384
    v_add_u32 v78, 10, v74
    v_xor_b32 v78, v78, v73
    v_lshl_add_u32 v78, v78, 4, v75
    v_add_u32 v78, 0, v78
    ds_read_b64_tr_b16 v[118:119], v78 offset:16384
    s_waitcnt lgkmcnt(0)
    v_mov_b32 v96, v112
    v_mov_b32 v98, v113
    v_mov_b32 v97, v114
    v_mov_b32 v99, v115
    v_mov_b32 v100, v116
    v_mov_b32 v102, v117
    v_mov_b32 v101, v118
    v_mov_b32 v103, v119
    v_add_u32 v78, 12, v74
    v_xor_b32 v78, v78, v73
    v_lshl_add_u32 v78, v78, 4, v75
    v_add_u32 v78, 0, v78
    ds_read_b64_tr_b16 v[112:113], v78 offset:0
    v_add_u32 v78, 14, v74
    v_xor_b32 v78, v78, v73
    v_lshl_add_u32 v78, v78, 4, v75
    v_add_u32 v78, 0, v78
    ds_read_b64_tr_b16 v[114:115], v78 offset:0
    v_add_u32 v78, 12, v74
    v_xor_b32 v78, v78, v73
    v_lshl_add_u32 v78, v78, 4, v75
    v_add_u32 v78, 0, v78
    ds_read_b64_tr_b16 v[116:117], v78 offset:16384
    v_add_u32 v78, 14, v74
    v_xor_b32 v78, v78, v73
    v_lshl_add_u32 v78, v78, 4, v75
    v_add_u32 v78, 0, v78
    ds_read_b64_tr_b16 v[118:119], v78 offset:16384
    s_waitcnt lgkmcnt(0)
    v_mov_b32 v104, v112
    v_mov_b32 v106, v113
    v_mov_b32 v105, v114
    v_mov_b32 v107, v115
    v_mov_b32 v108, v116
    v_mov_b32 v110, v117
    v_mov_b32 v109, v118
    v_mov_b32 v111, v119
    s_barrier
    v_add_u32 v78, 0, v77
    ds_write_b128 v78, v[80:83] offset:0
    ds_write_b128 v78, v[84:87] offset:1024
    ds_write_b128 v78, v[88:91] offset:2048
    ds_write_b128 v78, v[92:95] offset:3072
    ds_write_b128 v78, v[96:99] offset:4096
    ds_write_b128 v78, v[100:103] offset:5120
    ds_write_b128 v78, v[104:107] offset:6144
    ds_write_b128 v78, v[108:111] offset:7168
    s_waitcnt lgkmcnt(0)
    v_add_u32 v78, 0, v74
    v_xor_b32 v78, v78, v73
    v_lshl_add_u32 v78, v78, 4, v75
    v_add_u32 v78, 32768, v78
    ds_read_b64_tr_b16 v[112:113], v78 offset:0
    v_add_u32 v78, 2, v74
    v_xor_b32 v78, v78, v73
    v_lshl_add_u32 v78, v78, 4, v75
    v_add_u32 v78, 32768, v78
    ds_read_b64_tr_b16 v[114:115], v78 offset:0
    v_add_u32 v78, 0, v74
    v_xor_b32 v78, v78, v73
    v_lshl_add_u32 v78, v78, 4, v75
    v_add_u32 v78, 32768, v78
    ds_read_b64_tr_b16 v[116:117], v78 offset:16384
    v_add_u32 v78, 2, v74
    v_xor_b32 v78, v78, v73
    v_lshl_add_u32 v78, v78, 4, v75
    v_add_u32 v78, 32768, v78
    ds_read_b64_tr_b16 v[118:119], v78 offset:16384
    s_waitcnt lgkmcnt(0)
    v_mov_b32 v80, v112
    v_mov_b32 v82, v113
    v_mov_b32 v81, v114
    v_mov_b32 v83, v115
    v_mov_b32 v84, v116
    v_mov_b32 v86, v117
    v_mov_b32 v85, v118
    v_mov_b32 v87, v119
    v_add_u32 v78, 4, v74
    v_xor_b32 v78, v78, v73
    v_lshl_add_u32 v78, v78, 4, v75
    v_add_u32 v78, 32768, v78
    ds_read_b64_tr_b16 v[112:113], v78 offset:0
    v_add_u32 v78, 6, v74
    v_xor_b32 v78, v78, v73
    v_lshl_add_u32 v78, v78, 4, v75
    v_add_u32 v78, 32768, v78
    ds_read_b64_tr_b16 v[114:115], v78 offset:0
    v_add_u32 v78, 4, v74
    v_xor_b32 v78, v78, v73
    v_lshl_add_u32 v78, v78, 4, v75
    v_add_u32 v78, 32768, v78
    ds_read_b64_tr_b16 v[116:117], v78 offset:16384
    v_add_u32 v78, 6, v74
    v_xor_b32 v78, v78, v73
    v_lshl_add_u32 v78, v78, 4, v75
    v_add_u32 v78, 32768, v78
    ds_read_b64_tr_b16 v[118:119], v78 offset:16384
    s_waitcnt lgkmcnt(0)
    v_mov_b32 v88, v112
    v_mov_b32 v90, v113
    v_mov_b32 v89, v114
    v_mov_b32 v91, v115
    v_mov_b32 v92, v116
    v_mov_b32 v94, v117
    v_mov_b32 v93, v118
    v_mov_b32 v95, v119
    v_add_u32 v78, 8, v74
    v_xor_b32 v78, v78, v73
    v_lshl_add_u32 v78, v78, 4, v75
    v_add_u32 v78, 32768, v78
    ds_read_b64_tr_b16 v[112:113], v78 offset:0
    v_add_u32 v78, 10, v74
    v_xor_b32 v78, v78, v73
    v_lshl_add_u32 v78, v78, 4, v75
    v_add_u32 v78, 32768, v78
    ds_read_b64_tr_b16 v[114:115], v78 offset:0
    v_add_u32 v78, 8, v74
    v_xor_b32 v78, v78, v73
    v_lshl_add_u32 v78, v78, 4, v75
    v_add_u32 v78, 32768, v78
    ds_read_b64_tr_b16 v[116:117], v78 offset:16384
    v_add_u32 v78, 10, v74
    v_xor_b32 v78, v78, v73
    v_lshl_add_u32 v78, v78, 4, v75
    v_add_u32 v78, 32768, v78
    ds_read_b64_tr_b16 v[118:119], v78 offset:16384
    s_waitcnt lgkmcnt(0)
    v_mov_b32 v96, v112
    v_mov_b32 v98, v113
    v_mov_b32 v97, v114
    v_mov_b32 v99, v115
    v_mov_b32 v100, v116
    v_mov_b32 v102, v117
    v_mov_b32 v101, v118
    v_mov_b32 v103, v119
    v_add_u32 v78, 12, v74
    v_xor_b32 v78, v78, v73
    v_lshl_add_u32 v78, v78, 4, v75
    v_add_u32 v78, 32768, v78
    ds_read_b64_tr_b16 v[112:113], v78 offset:0
    v_add_u32 v78, 14, v74
    v_xor_b32 v78, v78, v73
    v_lshl_add_u32 v78, v78, 4, v75
    v_add_u32 v78, 32768, v78
    ds_read_b64_tr_b16 v[114:115], v78 offset:0
    v_add_u32 v78, 12, v74
    v_xor_b32 v78, v78, v73
    v_lshl_add_u32 v78, v78, 4, v75
    v_add_u32 v78, 32768, v78
    ds_read_b64_tr_b16 v[116:117], v78 offset:16384
    v_add_u32 v78, 14, v74
    v_xor_b32 v78, v78, v73
    v_lshl_add_u32 v78, v78, 4, v75
    v_add_u32 v78, 32768, v78
    ds_read_b64_tr_b16 v[118:119], v78 offset:16384
    s_waitcnt lgkmcnt(0)
    v_mov_b32 v104, v112
    v_mov_b32 v106, v113
    v_mov_b32 v105, v114
    v_mov_b32 v107, v115
    v_mov_b32 v108, v116
    v_mov_b32 v110, v117
    v_mov_b32 v109, v118
    v_mov_b32 v111, v119
    s_barrier
    v_add_u32 v78, 32768, v77
    ds_write_b128 v78, v[80:83] offset:0
    ds_write_b128 v78, v[84:87] offset:1024
    ds_write_b128 v78, v[88:91] offset:2048
    ds_write_b128 v78, v[92:95] offset:3072
    ds_write_b128 v78, v[96:99] offset:4096
    ds_write_b128 v78, v[100:103] offset:5120
    ds_write_b128 v78, v[104:107] offset:6144
    ds_write_b128 v78, v[108:111] offset:7168
    s_waitcnt lgkmcnt(0)
    s_waitcnt vmcnt(0)
    s_barrier
    v_add_u32 v78, 0, v74
    v_xor_b32 v78, v78, v73
    v_lshl_add_u32 v78, v78, 4, v75
    v_add_u32 v78, 65536, v78
    ds_read_b64_tr_b16 v[112:113], v78 offset:0
    v_add_u32 v78, 2, v74
    v_xor_b32 v78, v78, v73
    v_lshl_add_u32 v78, v78, 4, v75
    v_add_u32 v78, 65536, v78
    ds_read_b64_tr_b16 v[114:115], v78 offset:0
    v_add_u32 v78, 0, v74
    v_xor_b32 v78, v78, v73
    v_lshl_add_u32 v78, v78, 4, v75
    v_add_u32 v78, 65536, v78
    ds_read_b64_tr_b16 v[116:117], v78 offset:16384
    v_add_u32 v78, 2, v74
    v_xor_b32 v78, v78, v73
    v_lshl_add_u32 v78, v78, 4, v75
    v_add_u32 v78, 65536, v78
    ds_read_b64_tr_b16 v[118:119], v78 offset:16384
    s_waitcnt lgkmcnt(0)
    v_mov_b32 v80, v112
    v_mov_b32 v82, v113
    v_mov_b32 v81, v114
    v_mov_b32 v83, v115
    v_mov_b32 v84, v116
    v_mov_b32 v86, v117
    v_mov_b32 v85, v118
    v_mov_b32 v87, v119
    v_add_u32 v78, 4, v74
    v_xor_b32 v78, v78, v73
    v_lshl_add_u32 v78, v78, 4, v75
    v_add_u32 v78, 65536, v78
    ds_read_b64_tr_b16 v[112:113], v78 offset:0
    v_add_u32 v78, 6, v74
    v_xor_b32 v78, v78, v73
    v_lshl_add_u32 v78, v78, 4, v75
    v_add_u32 v78, 65536, v78
    ds_read_b64_tr_b16 v[114:115], v78 offset:0
    v_add_u32 v78, 4, v74
    v_xor_b32 v78, v78, v73
    v_lshl_add_u32 v78, v78, 4, v75
    v_add_u32 v78, 65536, v78
    ds_read_b64_tr_b16 v[116:117], v78 offset:16384
    v_add_u32 v78, 6, v74
    v_xor_b32 v78, v78, v73
    v_lshl_add_u32 v78, v78, 4, v75
    v_add_u32 v78, 65536, v78
    ds_read_b64_tr_b16 v[118:119], v78 offset:16384
    s_waitcnt lgkmcnt(0)
    v_mov_b32 v88, v112
    v_mov_b32 v90, v113
    v_mov_b32 v89, v114
    v_mov_b32 v91, v115
    v_mov_b32 v92, v116
    v_mov_b32 v94, v117
    v_mov_b32 v93, v118
    v_mov_b32 v95, v119
    v_add_u32 v78, 8, v74
    v_xor_b32 v78, v78, v73
    v_lshl_add_u32 v78, v78, 4, v75
    v_add_u32 v78, 65536, v78
    ds_read_b64_tr_b16 v[112:113], v78 offset:0
    v_add_u32 v78, 10, v74
    v_xor_b32 v78, v78, v73
    v_lshl_add_u32 v78, v78, 4, v75
    v_add_u32 v78, 65536, v78
    ds_read_b64_tr_b16 v[114:115], v78 offset:0
    v_add_u32 v78, 8, v74
    v_xor_b32 v78, v78, v73
    v_lshl_add_u32 v78, v78, 4, v75
    v_add_u32 v78, 65536, v78
    ds_read_b64_tr_b16 v[116:117], v78 offset:16384
    v_add_u32 v78, 10, v74
    v_xor_b32 v78, v78, v73
    v_lshl_add_u32 v78, v78, 4, v75
    v_add_u32 v78, 65536, v78
    ds_read_b64_tr_b16 v[118:119], v78 offset:16384
    s_waitcnt lgkmcnt(0)
    v_mov_b32 v96, v112
    v_mov_b32 v98, v113
    v_mov_b32 v97, v114
    v_mov_b32 v99, v115
    v_mov_b32 v100, v116
    v_mov_b32 v102, v117
    v_mov_b32 v101, v118
    v_mov_b32 v103, v119
    v_add_u32 v78, 12, v74
    v_xor_b32 v78, v78, v73
    v_lshl_add_u32 v78, v78, 4, v75
    v_add_u32 v78, 65536, v78
    ds_read_b64_tr_b16 v[112:113], v78 offset:0
    v_add_u32 v78, 14, v74
    v_xor_b32 v78, v78, v73
    v_lshl_add_u32 v78, v78, 4, v75
    v_add_u32 v78, 65536, v78
    ds_read_b64_tr_b16 v[114:115], v78 offset:0
    v_add_u32 v78, 12, v74
    v_xor_b32 v78, v78, v73
    v_lshl_add_u32 v78, v78, 4, v75
    v_add_u32 v78, 65536, v78
    ds_read_b64_tr_b16 v[116:117], v78 offset:16384
    v_add_u32 v78, 14, v74
    v_xor_b32 v78, v78, v73
    v_lshl_add_u32 v78, v78, 4, v75
    v_add_u32 v78, 65536, v78
    ds_read_b64_tr_b16 v[118:119], v78 offset:16384
    s_waitcnt lgkmcnt(0)
    v_mov_b32 v104, v112
    v_mov_b32 v106, v113
    v_mov_b32 v105, v114
    v_mov_b32 v107, v115
    v_mov_b32 v108, v116
    v_mov_b32 v110, v117
    v_mov_b32 v109, v118
    v_mov_b32 v111, v119
    s_barrier
    v_add_u32 v78, 65536, v77
    ds_write_b128 v78, v[80:83] offset:0
    ds_write_b128 v78, v[84:87] offset:1024
    ds_write_b128 v78, v[88:91] offset:2048
    ds_write_b128 v78, v[92:95] offset:3072
    ds_write_b128 v78, v[96:99] offset:4096
    ds_write_b128 v78, v[100:103] offset:5120
    ds_write_b128 v78, v[104:107] offset:6144
    ds_write_b128 v78, v[108:111] offset:7168
    s_waitcnt lgkmcnt(0)
    v_add_u32 v78, 0, v74
    v_xor_b32 v78, v78, v73
    v_lshl_add_u32 v78, v78, 4, v75
    v_add_u32 v78, 98304, v78
    ds_read_b64_tr_b16 v[112:113], v78 offset:0
    v_add_u32 v78, 2, v74
    v_xor_b32 v78, v78, v73
    v_lshl_add_u32 v78, v78, 4, v75
    v_add_u32 v78, 98304, v78
    ds_read_b64_tr_b16 v[114:115], v78 offset:0
    v_add_u32 v78, 0, v74
    v_xor_b32 v78, v78, v73
    v_lshl_add_u32 v78, v78, 4, v75
    v_add_u32 v78, 98304, v78
    ds_read_b64_tr_b16 v[116:117], v78 offset:16384
    v_add_u32 v78, 2, v74
    v_xor_b32 v78, v78, v73
    v_lshl_add_u32 v78, v78, 4, v75
    v_add_u32 v78, 98304, v78
    ds_read_b64_tr_b16 v[118:119], v78 offset:16384
    s_waitcnt lgkmcnt(0)
    v_mov_b32 v80, v112
    v_mov_b32 v82, v113
    v_mov_b32 v81, v114
    v_mov_b32 v83, v115
    v_mov_b32 v84, v116
    v_mov_b32 v86, v117
    v_mov_b32 v85, v118
    v_mov_b32 v87, v119
    v_add_u32 v78, 4, v74
    v_xor_b32 v78, v78, v73
    v_lshl_add_u32 v78, v78, 4, v75
    v_add_u32 v78, 98304, v78
    ds_read_b64_tr_b16 v[112:113], v78 offset:0
    v_add_u32 v78, 6, v74
    v_xor_b32 v78, v78, v73
    v_lshl_add_u32 v78, v78, 4, v75
    v_add_u32 v78, 98304, v78
    ds_read_b64_tr_b16 v[114:115], v78 offset:0
    v_add_u32 v78, 4, v74
    v_xor_b32 v78, v78, v73
    v_lshl_add_u32 v78, v78, 4, v75
    v_add_u32 v78, 98304, v78
    ds_read_b64_tr_b16 v[116:117], v78 offset:16384
    v_add_u32 v78, 6, v74
    v_xor_b32 v78, v78, v73
    v_lshl_add_u32 v78, v78, 4, v75
    v_add_u32 v78, 98304, v78
    ds_read_b64_tr_b16 v[118:119], v78 offset:16384
    s_waitcnt lgkmcnt(0)
    v_mov_b32 v88, v112
    v_mov_b32 v90, v113
    v_mov_b32 v89, v114
    v_mov_b32 v91, v115
    v_mov_b32 v92, v116
    v_mov_b32 v94, v117
    v_mov_b32 v93, v118
    v_mov_b32 v95, v119
    v_add_u32 v78, 8, v74
    v_xor_b32 v78, v78, v73
    v_lshl_add_u32 v78, v78, 4, v75
    v_add_u32 v78, 98304, v78
    ds_read_b64_tr_b16 v[112:113], v78 offset:0
    v_add_u32 v78, 10, v74
    v_xor_b32 v78, v78, v73
    v_lshl_add_u32 v78, v78, 4, v75
    v_add_u32 v78, 98304, v78
    ds_read_b64_tr_b16 v[114:115], v78 offset:0
    v_add_u32 v78, 8, v74
    v_xor_b32 v78, v78, v73
    v_lshl_add_u32 v78, v78, 4, v75
    v_add_u32 v78, 98304, v78
    ds_read_b64_tr_b16 v[116:117], v78 offset:16384
    v_add_u32 v78, 10, v74
    v_xor_b32 v78, v78, v73
    v_lshl_add_u32 v78, v78, 4, v75
    v_add_u32 v78, 98304, v78
    ds_read_b64_tr_b16 v[118:119], v78 offset:16384
    s_waitcnt lgkmcnt(0)
    v_mov_b32 v96, v112
    v_mov_b32 v98, v113
    v_mov_b32 v97, v114
    v_mov_b32 v99, v115
    v_mov_b32 v100, v116
    v_mov_b32 v102, v117
    v_mov_b32 v101, v118
    v_mov_b32 v103, v119
    v_add_u32 v78, 12, v74
    v_xor_b32 v78, v78, v73
    v_lshl_add_u32 v78, v78, 4, v75
    v_add_u32 v78, 98304, v78
    ds_read_b64_tr_b16 v[112:113], v78 offset:0
    v_add_u32 v78, 14, v74
    v_xor_b32 v78, v78, v73
    v_lshl_add_u32 v78, v78, 4, v75
    v_add_u32 v78, 98304, v78
    ds_read_b64_tr_b16 v[114:115], v78 offset:0
    v_add_u32 v78, 12, v74
    v_xor_b32 v78, v78, v73
    v_lshl_add_u32 v78, v78, 4, v75
    v_add_u32 v78, 98304, v78
    ds_read_b64_tr_b16 v[116:117], v78 offset:16384
    v_add_u32 v78, 14, v74
    v_xor_b32 v78, v78, v73
    v_lshl_add_u32 v78, v78, 4, v75
    v_add_u32 v78, 98304, v78
    ds_read_b64_tr_b16 v[118:119], v78 offset:16384
    s_waitcnt lgkmcnt(0)
    v_mov_b32 v104, v112
    v_mov_b32 v106, v113
    v_mov_b32 v105, v114
    v_mov_b32 v107, v115
    v_mov_b32 v108, v116
    v_mov_b32 v110, v117
    v_mov_b32 v109, v118
    v_mov_b32 v111, v119
    s_barrier
    v_add_u32 v78, 98304, v77
    ds_write_b128 v78, v[80:83] offset:0
    ds_write_b128 v78, v[84:87] offset:1024
    ds_write_b128 v78, v[88:91] offset:2048
    ds_write_b128 v78, v[92:95] offset:3072
    ds_write_b128 v78, v[96:99] offset:4096
    ds_write_b128 v78, v[100:103] offset:5120
    ds_write_b128 v78, v[104:107] offset:6144
    ds_write_b128 v78, v[108:111] offset:7168
    s_waitcnt lgkmcnt(0)
    s_barrier
    v_and_b32 v43, 7, v41
    v_lshrrev_b32 v44, 1, v42
    v_and_b32 v45, 1, v42
    s_mul_i32 s37, s5, 2112
    s_add_u32 s37, s37, 131072
    v_add_u32 v1, s37, v0
    v_mul_u32_u24 v48, 1056, v43
    v_lshl_add_u32 v48, v42, 4, v48
    v_add_u32 v2, 131072, v48
    v_mul_u32_u24 v48, 288, v43
    v_lshl_add_u32 v48, v42, 4, v48
    v_add_u32 v10, 131072, v48
    v_mul_u32_u24 v48, 288, v43
    v_lshl_add_u32 v48, v42, 3, v48
    s_lshl_b32 s37, s5, 6
    s_add_u32 s37, s37, 131072
    v_add_u32 v9, s37, v48
    s_lshl_b32 s37, s5, 5
    v_lshl_add_u32 v48, v44, 4, v41
    v_add_u32 v48, s37, v48
    v_lshrrev_b32 v49, 2, v41
    v_add_u32 v49, v49, v45
    v_and_b32 v49, 3, v49
    v_lshlrev_b32 v49, 3, v49
    v_lshl_add_u32 v49, v48, 5, v49
    v_add_u32 v3, 139520, v49
    v_lshlrev_b32 v49, 3, v45
    v_lshl_add_u32 v16, v48, 4, v49
    v_lshrrev_b32 v48, 2, v41
    v_lshl_add_u32 v48, v42, 3, v48
    v_add_u32 v48, 0, v48
    v_and_b32 v49, 3, v41
    v_lshl_add_u32 v49, v42, 1, v49
    v_add_u32 v49, 0, v49
    v_and_b32 v49, 3, v49
    v_lshlrev_b32 v49, 3, v49
    v_lshl_add_u32 v49, v48, 5, v49
    v_add_u32 v5, 139520, v49
    v_lshrrev_b32 v48, 2, v41
    v_lshl_add_u32 v48, v42, 3, v48
    v_add_u32 v48, 4, v48
    v_and_b32 v49, 3, v41
    v_lshl_add_u32 v49, v42, 1, v49
    v_add_u32 v49, 1, v49
    v_and_b32 v49, 3, v49
    v_lshlrev_b32 v49, 3, v49
    v_lshl_add_u32 v49, v48, 5, v49
    v_add_u32 v6, 139520, v49
    v_lshlrev_b32 v48, 9, v42
    v_lshl_add_u32 v48, v41, 4, v48
    v_add_u32 v7, 143616, v48
    s_lshl_b32 s37, s5, 11
    s_add_u32 s37, s37, 151808
    v_add_u32 v8, s37, v48
    s_lshl_b32 s37, s5, 13
    v_add_u32 v11, s37, v0
    v_add_u32 v15, 0x10000, v11
    v_lshlrev_b32 v48, 9, v44
    v_lshl_add_u32 v48, v45, 7, v48
    v_lshl_add_u32 v48, v43, 4, v48
    v_lshrrev_b32 v49, 3, v41
    v_lshl_add_u32 v48, v49, 8, v48
    s_lshl_b32 s37, s5, 16
    s_lshl_b32 s38, s4, 11
    s_add_u32 s37, s37, s38
    v_add_u32 v12, s37, v48
    s_lshr_b32 s37, s4, 3
    s_lshl_b32 s37, s37, 16
    s_and_b32 s38, s4, 7
    s_lshl_b32 s38, s38, 8
    s_add_u32 s37, s37, s38
    s_lshl_b32 s38, s5, 6
    s_add_u32 s37, s37, s38
    v_lshrrev_b32 v48, 2, v40
    v_lshlrev_b32 v48, 11, v48
    v_and_b32 v49, 3, v40
    v_lshl_add_u32 v48, v49, 4, v48
    v_add_u32 v13, s37, v48
    s_lshr_b32 s37, s5, 1
    s_lshl_b32 s37, s37, 12
    s_lshr_b32 s38, s4, 3
    s_lshl_b32 s38, s38, 8
    s_add_u32 s37, s37, s38
    s_lshr_b32 s38, s4, 2
    s_and_b32 s38, s38, 1
    s_lshl_b32 s38, s38, 7
    s_add_u32 s37, s37, s38
    s_and_b32 s38, s4, 3
    s_lshl_b32 s38, s38, 4
    s_add_u32 s37, s37, s38
    s_and_b32 s38, s5, 1
    s_lshl_b32 s38, s38, 3
    s_add_u32 s37, s37, s38
    v_lshrrev_b32 v50, 2, v41
    v_lshlrev_b32 v48, 10, v50
    v_lshl_add_u32 v48, v49, 1, v48
    v_lshl_add_u32 v48, v42, 6, v48
    v_add_u32 v14, s37, v48
    v_mov_b32 v18, 0x44444444
    v_mov_b32 v48, 0xeeeeeeee
    v_cmp_lt_u32 vcc, 7, v41
    s_nop 1
    v_cndmask_b32 v18, v18, v48, vcc
    v_mov_b32 v19, 0
    v_mov_b32 v48, 0xff800000
    v_cmp_gt_u32 vcc, 2, v42
    s_nop 1
    v_cndmask_b32 v19, v19, v48, vcc
    s_mul_i32 s38, s6, 589824
    s_add_u32 s38, s38, 65536
    s_lshl_b32 s37, s5, 11
    s_add_u32 s38, s38, s37
    s_add_u32 s10, s8, s38
    s_addc_u32 s11, s9, 0
    s_mul_i32 s38, s6, 589824
    s_add_u32 s38, s38, 65536
    s_mov_b32 s37, 8192
    s_add_u32 s38, s38, s37
    s_add_u32 s12, s8, s38
    s_addc_u32 s13, s9, 0
    s_mov_b32 s52, 8192
    s_mul_i32 s38, s6, 1048576
    s_add_u32 s38, s38, 2097152
    s_mov_b32 s37, 0
    s_add_u32 s38, s38, s37
    s_add_u32 s14, s8, s38
    s_addc_u32 s15, s9, 0
    s_mul_i32 s38, s6, 1048576
    s_add_u32 s38, s38, 2097152
    s_mov_b32 s37, 32768
    s_add_u32 s38, s38, s37
    s_add_u32 s16, s8, s38
    s_addc_u32 s17, s9, 0
    s_mul_i32 s38, s6, 16777216
    s_add_u32 s38, s38, 83886080
    s_lshl_b32 s37, s4, 13
    s_lshl_b32 s39, s5, 11
    s_add_u32 s37, s37, s39
    s_add_u32 s38, s38, s37
    s_add_u32 s18, s8, s38
    s_addc_u32 s19, s9, 0
    s_mul_i32 s38, s6, 16777216
    s_add_u32 s38, s38, 117440512
    s_lshl_b32 s37, s4, 13
    s_lshl_b32 s39, s5, 11
    s_add_u32 s37, s37, s39
    s_add_u32 s38, s38, s37
    s_add_u32 s20, s8, s38
    s_addc_u32 s21, s9, 0
    s_mul_i32 s38, s6, 4194304
    s_add_u32 s38, s38, 25165824
    s_lshl_b32 s37, s4, 11
    s_add_u32 s38, s38, s37
    s_add_u32 s22, s8, s38
    s_addc_u32 s23, s9, 0
    s_mul_i32 s38, s6, 4194304
    s_add_u32 s38, s38, 33554432
    s_lshl_b32 s37, s4, 11
    s_add_u32 s38, s38, s37
    s_add_u32 s24, s8, s38
    s_addc_u32 s25, s9, 0
    s_mul_i32 s38, s6, 4096
    s_add_u32 s38, s38, 4096
    s_lshl_b32 s37, s4, 7
    s_add_u32 s38, s38, s37
    s_add_u32 s26, s8, s38
    s_addc_u32 s27, s9, 0
    s_mul_i32 s38, s6, 2048
    s_add_u32 s38, s38, 0
    s_lshl_b32 s37, s4, 6
    s_add_u32 s38, s38, s37
    s_add_u32 s48, s8, s38
    s_addc_u32 s49, s9, 0
    s_mov_b32 s28, 0x00ff00ff
    s_mov_b32 s29, 0x00ff00ff
    s_mov_b32 s30, 0x55555555
    s_mov_b32 s31, 0
    s_mov_b32 s32, 0xff00ff00
    s_mov_b32 s33, 0xff00ff00
    s_mov_b32 s34, 0xf0f0f0f0
    s_mov_b32 s35, 0xf0f0f0f0
    s_mov_b32 s36, 0x3e0293ee
    s_mov_b32 s50, 0x00003f80
    s_mov_b32 s51, 0x3f800000
    s_lshl_b32 s46, s5, 11
    s_add_u32 s47, s46, 151808
    s_add_u32 s46, s46, 143616
    s_mov_b32 s7, 0
    s_mov_b32 s44, 0
    s_mov_b32 s45, 0
    s_load_dwordx2 s[42:43], s[0:1], 88
    v_and_b32 v32, 63, v0
    v_lshrrev_b32 v32, 4, v0
    v_and_b32 v33, 3, v32
    v_lshlrev_b32 v33, 6, v33
    v_bfe_u32 v34, v32, 2, 1
    v_lshl_add_u32 v33, v34, 2, v33
    s_mov_b32 s40, 0
    s_mov_b32 s7, 0
    s_waitcnt lgkmcnt(0)
Lmd_12:
    global_load_dword v34, v33, s[42:43] sc1
    s_add_u32 s40, s40, 1
    s_cmp_gt_u32 s40, 262144
    s_cbranch_scc1 Lmdto_14
    s_waitcnt vmcnt(0)
    v_readlane_b32 s38, v34, 0
    v_readlane_b32 s39, v34, 1
    s_nop 1
    s_cmp_eq_u32 s6, 0
    s_cselect_b32 s37, s38, s39
    s_cmp_ge_u32 s37, 32
    s_cbranch_scc1 Lmdf_13
    s_mov_b32 s37, 0
    v_readlane_b32 s38, v34, 0
    s_nop 1
    s_add_u32 s37, s37, s38
    v_readlane_b32 s38, v34, 1
    s_nop 1
    s_add_u32 s37, s37, s38
    v_readlane_b32 s38, v34, 2
    s_nop 1
    s_add_u32 s37, s37, s38
    v_readlane_b32 s38, v34, 3
    s_nop 1
    s_add_u32 s37, s37, s38
    v_readlane_b32 s38, v34, 4
    s_nop 1
    s_add_u32 s37, s37, s38
    v_readlane_b32 s38, v34, 5
    s_nop 1
    s_add_u32 s37, s37, s38
    v_readlane_b32 s38, v34, 6
    s_nop 1
    s_add_u32 s37, s37, s38
    v_readlane_b32 s38, v34, 7
    s_nop 1
    s_add_u32 s37, s37, s38
    s_cmp_lt_u32 s37, 256
    s_cbranch_scc1 Lmd_12
    s_branch L_R_slow
Lmdto_14:
    s_load_dwordx2 s[42:43], s[0:1], 88
    s_waitcnt lgkmcnt(0)
    s_mov_b64 exec, 1
    v_mov_b32 v32, 184
    v_mov_b32 v33, s7
    v_add_u32 v33, 0x10000, v33
    global_store_dword v32, v33, s[42:43] sc1
    s_waitcnt vmcnt(0)
    s_endpgm
Lmdf_13:
    s_load_dwordx2 s[42:43], s[0:1], 88
    s_mov_b32 s40, 0
    s_mov_b32 s7, 0
    v_mov_b32 v32, 248
    s_waitcnt lgkmcnt(0)
Lwi_18:
    global_load_dword v33, v32, s[42:43] sc1
    s_add_u32 s40, s40, 1
    s_cmp_gt_u32 s40, 262144
    s_cbranch_scc1 Lwito_19
    s_waitcnt vmcnt(0)
    v_cmp_gt_u32 vcc, 1, v33
    s_cbranch_vccnz Lwi_18
    s_branch Lwisk_20
Lwito_19:
    s_load_dwordx2 s[42:43], s[0:1], 88
    s_waitcnt lgkmcnt(0)
    s_mov_b64 exec, 1
    v_mov_b32 v32, 180
    v_mov_b32 v33, s7
    v_add_u32 v33, 0x10000, v33
    global_store_dword v32, v33, s[42:43] sc1
    s_waitcnt vmcnt(0)
    s_endpgm
Lwisk_20:
    v_mov_b32 v17, 1
    v_mov_b32 v4, 0
    s_mov_b32 s45, 0
    s_mov_b32 s44, 1
    s_mov_b64 exec, 3
    v_cmp_gt_u32 vcc, v17, v4
    s_cbranch_vccz Lfsok_22
    s_mov_b32 s40, 0
Lfs_21:
    s_mov_b64 exec, 15
    global_load_dword v4, v0, s[26:27] sc1
    s_add_u32 s40, s40, 1
    s_cmp_gt_u32 s40, 262144
    s_cbranch_scc1 Lto_15
    s_waitcnt vmcnt(0)
    s_mov_b64 exec, 3
    v_cmp_gt_u32 vcc, v17, v4
    s_cbranch_vccnz Lfs_21
Lfsok_22:
    s_mov_b64 exec, 3
    v_add_u32 v17, 1, v17
    v_min_u32 v17, 64, v17
    s_mov_b64 exec, -1
    s_mov_b32 m0, s46
    s_nop 0
    global_load_lds_dwordx4 v0, s[18:19] sc1
    global_load_lds_dwordx4 v0, s[18:19] offset:1024 sc1
    s_add_u32 s18, s18, 262144
    s_addc_u32 s19, s19, 0
    s_waitcnt vmcnt(0)
    s_barrier
Lstep_16:
    v_mov_b32 v20, 0
    v_mov_b32 v21, 0
    v_mov_b32 v22, 0
    v_mov_b32 v23, 0
    v_mov_b32 v24, 0
    v_mov_b32 v25, 0
    v_mov_b32 v26, 0
    v_mov_b32 v27, 0
    v_mov_b32 v28, 0
    v_mov_b32 v29, 0
    v_mov_b32 v30, 0
    v_mov_b32 v31, 0
    s_cmp_eq_u32 s45, 0
    s_cbranch_scc1 Lnk_23
    s_mov_b64 exec, 3
    v_cmp_gt_u32 vcc, v17, v4
    s_cbranch_vccz Lfsok_25
    s_mov_b32 s40, 0
Lfs_24:
    s_mov_b64 exec, 15
    global_load_dword v4, v0, s[26:27] sc1
    s_add_u32 s40, s40, 1
    s_cmp_gt_u32 s40, 262144
    s_cbranch_scc1 Lto_15
    s_waitcnt vmcnt(0)
    s_mov_b64 exec, 3
    v_cmp_gt_u32 vcc, v17, v4
    s_cbranch_vccnz Lfs_24
Lfsok_25:
    s_mov_b64 exec, 3
    v_add_u32 v17, 1, v17
    v_min_u32 v17, 64, v17
    s_mov_b64 exec, -1
    s_mov_b32 m0, s46
    s_nop 0
    global_load_lds_dwordx4 v0, s[18:19] sc1
    global_load_lds_dwordx4 v0, s[18:19] offset:1024 sc1
    s_add_u32 s18, s18, 262144
    s_addc_u32 s19, s19, 0
    s_waitcnt vmcnt(0)
    s_mov_b32 s45, 0
Lnk_23:
    s_mov_b64 exec, 12
    v_cmp_gt_u32 vcc, v17, v4
    s_cbranch_vccz Lfsok_27
    s_mov_b32 s40, 0
Lfs_26:
    s_mov_b64 exec, 15
    global_load_dword v4, v0, s[26:27] sc1
    s_add_u32 s40, s40, 1
    s_cmp_gt_u32 s40, 262144
    s_cbranch_scc1 Lto_15
    s_waitcnt vmcnt(0)
    s_mov_b64 exec, 12
    v_cmp_gt_u32 vcc, v17, v4
    s_cbranch_vccnz Lfs_26
Lfsok_27:
    s_mov_b64 exec, 12
    v_add_u32 v17, 1, v17
    v_min_u32 v17, 64, v17
    s_mov_b64 exec, -1
    s_mov_b64 exec, 3
    v_cmp_gt_u32 vcc, v17, v4
    s_mov_b64 exec, -1
    s_cmp_eq_u64 vcc, 0
    s_cselect_b32 s44, 1, 0
    s_mov_b32 m0, s47
    s_waitcnt vmcnt(0)
    s_mov_b32 s40, 0
LpollB_28:
    global_load_dwordx4 v[32:35], v0, s[10:11] sc1
    global_load_dwordx4 v[36:39], v0, s[10:11] offset:1024 sc1
    s_add_u32 s40, s40, 1
    s_cmp_gt_u32 s40, 262144
    s_cbranch_scc1 Lto_15
    s_waitcnt vmcnt(0)
    ds_write_b128 v1, v[32:35]
    ds_write_b128 v1, v[36:39] offset:1056
    v_max3_u32 v40, v32, v33, v34
    v_max3_u32 v41, v35, v36, v37
    v_max3_u32 v40, v40, v38, v39
    v_max_u32 v40, v40, v41
    v_cmp_eq_u32 vcc, -1, v40
    s_cbranch_vccnz LpollB_28
    s_cmp_lg_u32 s5, 0
    s_cbranch_scc1 Lskf_29
    v_mov_b32 v4, s7
    s_mov_b64 exec, 1
    global_store_dword v0, v4, s[48:49] sc1
    s_mov_b64 exec, -1
Lskf_29:
    global_load_lds_dwordx4 v0, s[20:21] sc1
    global_load_lds_dwordx4 v0, s[20:21] offset:1024 sc1
    s_waitcnt lgkmcnt(0)
    s_barrier
    ds_read_b128 v[32:35], v2 offset:0
    ds_read_b128 v[36:39], v2 offset:64
    ds_read_b128 v[40:43], v2 offset:128
    ds_read_b128 v[44:47], v2 offset:192
    ds_read_b128 v[48:51], v2 offset:256
    ds_read_b128 v[52:55], v2 offset:320
    ds_read_b128 v[56:59], v2 offset:384
    ds_read_b128 v[60:63], v2 offset:448
    s_waitcnt lgkmcnt(7)
    v_smfmac_f32_16x16x64_bf16 v[20:23], v[32:35], a[0:7], v18
    ds_read_b128 v[64:67], v2 offset:512
    v_smfmac_f32_16x16x64_bf16 v[24:27], v[32:35], a[128:135], v18
    s_waitcnt lgkmcnt(7)
    v_smfmac_f32_16x16x64_bf16 v[20:23], v[36:39], a[8:15], v18
    ds_read_b128 v[68:71], v2 offset:576
    v_smfmac_f32_16x16x64_bf16 v[24:27], v[36:39], a[136:143], v18
    s_waitcnt lgkmcnt(7)
    v_smfmac_f32_16x16x64_bf16 v[20:23], v[40:43], a[16:23], v18
    ds_read_b128 v[72:75], v2 offset:640
    v_smfmac_f32_16x16x64_bf16 v[24:27], v[40:43], a[144:151], v18
    s_waitcnt lgkmcnt(7)
    v_smfmac_f32_16x16x64_bf16 v[20:23], v[44:47], a[24:31], v18
    ds_read_b128 v[76:79], v2 offset:704
    v_smfmac_f32_16x16x64_bf16 v[24:27], v[44:47], a[152:159], v18
    s_waitcnt lgkmcnt(7)
    v_smfmac_f32_16x16x64_bf16 v[20:23], v[48:51], a[32:39], v18
    ds_read_b128 v[80:83], v2 offset:768
    v_smfmac_f32_16x16x64_bf16 v[24:27], v[48:51], a[160:167], v18
    s_waitcnt lgkmcnt(7)
    v_smfmac_f32_16x16x64_bf16 v[20:23], v[52:55], a[40:47], v18
    ds_read_b128 v[84:87], v2 offset:832
    v_smfmac_f32_16x16x64_bf16 v[24:27], v[52:55], a[168:175], v18
    s_waitcnt lgkmcnt(7)
    v_smfmac_f32_16x16x64_bf16 v[20:23], v[56:59], a[48:55], v18
    ds_read_b128 v[88:91], v2 offset:896
    v_smfmac_f32_16x16x64_bf16 v[24:27], v[56:59], a[176:183], v18
    s_waitcnt lgkmcnt(7)
    v_smfmac_f32_16x16x64_bf16 v[20:23], v[60:63], a[56:63], v18
    ds_read_b128 v[92:95], v2 offset:960
    v_smfmac_f32_16x16x64_bf16 v[24:27], v[60:63], a[184:191], v18
    s_waitcnt lgkmcnt(7)
    v_smfmac_f32_16x16x64_bf16 v[20:23], v[64:67], a[64:71], v18
    ds_read_b128 v[96:99], v7 offset:0
    v_smfmac_f32_16x16x64_bf16 v[24:27], v[64:67], a[192:199], v18
    s_mov_b64 exec, 15
    global_load_dword v4, v0, s[26:27] sc1
    s_mov_b64 exec, -1
    s_waitcnt lgkmcnt(7)
    v_smfmac_f32_16x16x64_bf16 v[20:23], v[68:71], a[72:79], v18
    ds_read_b128 v[100:103], v7 offset:2048
    v_smfmac_f32_16x16x64_bf16 v[24:27], v[68:71], a[200:207], v18
    s_add_u32 s20, s20, 262144
    s_addc_u32 s21, s21, 0
    s_waitcnt lgkmcnt(7)
    v_smfmac_f32_16x16x64_bf16 v[20:23], v[72:75], a[80:87], v18
    ds_read_b128 v[104:107], v7 offset:4096
    v_smfmac_f32_16x16x64_bf16 v[24:27], v[72:75], a[208:215], v18
    s_waitcnt lgkmcnt(7)
    v_smfmac_f32_16x16x64_bf16 v[20:23], v[76:79], a[88:95], v18
    ds_read_b128 v[108:111], v7 offset:6144
    v_smfmac_f32_16x16x64_bf16 v[24:27], v[76:79], a[216:223], v18
    s_waitcnt lgkmcnt(7)
    v_smfmac_f32_16x16x64_bf16 v[20:23], v[80:83], a[96:103], v18
    ds_read_b128 v[112:115], v7 offset:256
    v_smfmac_f32_16x16x64_bf16 v[24:27], v[80:83], a[224:231], v18
    s_waitcnt lgkmcnt(7)
    v_smfmac_f32_16x16x64_bf16 v[20:23], v[84:87], a[104:111], v18
    ds_read_b128 v[116:119], v7 offset:2304
    v_smfmac_f32_16x16x64_bf16 v[24:27], v[84:87], a[232:239], v18
    s_waitcnt lgkmcnt(7)
    v_smfmac_f32_16x16x64_bf16 v[20:23], v[88:91], a[112:119], v18
    ds_read_b128 v[120:123], v7 offset:4352
    v_smfmac_f32_16x16x64_bf16 v[24:27], v[88:91], a[240:247], v18
    s_waitcnt lgkmcnt(7)
    v_smfmac_f32_16x16x64_bf16 v[20:23], v[92:95], a[120:127], v18
    ds_read_b128 v[124:127], v7 offset:6400
    v_smfmac_f32_16x16x64_bf16 v[24:27], v[92:95], a[248:255], v18
    v_smfmac_f32_16x16x64_bf16 v[28:31], v[32:35], v[128:135], v18
    v_smfmac_f32_16x16x64_bf16 v[28:31], v[36:39], v[136:143], v18
    v_cvt_pk_bf16_f32 v20, v20, v21
    v_cvt_pk_bf16_f32 v21, v22, v23
    v_xor_b32 v22, 16, v3
    v_cvt_pk_bf16_f32 v24, v24, v25
    v_cvt_pk_bf16_f32 v25, v26, v27
    ds_write_b64 v3, v[20:21]
    ds_write_b64 v22, v[24:25]
    global_store_dwordx2 v16, v[24:25], s[22:23] sc1
    v_smfmac_f32_16x16x64_bf16 v[28:31], v[40:43], v[144:151], v18
    v_smfmac_f32_16x16x64_bf16 v[28:31], v[44:47], v[152:159], v18
    v_smfmac_f32_16x16x64_bf16 v[28:31], v[48:51], v[160:167], v18
    v_smfmac_f32_16x16x64_bf16 v[28:31], v[52:55], v[168:175], v18
    s_waitcnt lgkmcnt(0)
    s_barrier
    ds_read_b64_tr_b16 v[32:33], v5 offset:0
    ds_read_b64_tr_b16 v[34:35], v6 offset:0
    ds_read_b64_tr_b16 v[36:37], v5 offset:1024
    ds_read_b64_tr_b16 v[38:39], v6 offset:1024
    ds_read_b64_tr_b16 v[40:41], v5 offset:2048
    ds_read_b64_tr_b16 v[42:43], v6 offset:2048
    ds_read_b64_tr_b16 v[44:45], v5 offset:3072
    ds_read_b64_tr_b16 v[46:47], v6 offset:3072
    v_smfmac_f32_16x16x64_bf16 v[28:31], v[56:59], v[176:183], v18
    s_mov_b32 m0, s46
    s_nop 0
    global_load_lds_dwordx4 v0, s[18:19] sc1
    v_smfmac_f32_16x16x64_bf16 v[28:31], v[60:63], v[184:191], v18
    global_load_lds_dwordx4 v0, s[18:19] offset:1024 sc1
    v_smfmac_f32_16x16x64_bf16 v[28:31], v[64:67], v[192:199], v18
    s_cmp_eq_u32 s44, 0
    s_cbranch_scc1 Lks_31
    s_add_u32 s18, s18, 262144
    s_addc_u32 s19, s19, 0
    s_mov_b64 exec, 3
    v_add_u32 v17, 1, v17
    v_min_u32 v17, 64, v17
    s_mov_b64 exec, -1
    s_branch Lkd_32
Lks_31:
    s_mov_b32 s45, 1
Lkd_32:
    v_smfmac_f32_16x16x64_bf16 v[28:31], v[68:71], v[200:207], v18
    v_mov_b32 v64, 0x3f803f80
    v_mov_b32 v65, 0x3f803f80
    v_mov_b32 v66, 0x3f803f80
    v_mov_b32 v67, 0x3f803f80
    s_waitcnt lgkmcnt(6)
    v_mfma_f32_16x16x32_bf16 v[52:55], v[96:99], v[32:35], 0
    v_mfma_f32_16x16x32_bf16 v[56:59], v[112:115], v[32:35], 0
    v_mfma_f32_16x16x32_bf16 v[48:51], v[32:35], v[32:35], 0
    s_waitcnt lgkmcnt(4)
    v_mfma_f32_16x16x32_bf16 v[52:55], v[100:103], v[36:39], v[52:55]
    v_mfma_f32_16x16x32_bf16 v[56:59], v[116:119], v[36:39], v[56:59]
    v_mfma_f32_16x16x32_bf16 v[48:51], v[36:39], v[36:39], v[48:51]
    ds_read_b128 v[96:99], v11 offset:0
    ds_read_b128 v[100:103], v11 offset:1024
    ds_read_b128 v[112:115], v11 offset:2048
    ds_read_b128 v[116:119], v11 offset:3072
    s_waitcnt lgkmcnt(6)
    v_mfma_f32_16x16x32_bf16 v[52:55], v[104:107], v[40:43], v[52:55]
    v_mfma_f32_16x16x32_bf16 v[56:59], v[120:123], v[40:43], v[56:59]
    v_mfma_f32_16x16x32_bf16 v[48:51], v[40:43], v[40:43], v[48:51]
    s_waitcnt lgkmcnt(4)
    v_mfma_f32_16x16x32_bf16 v[52:55], v[108:111], v[44:47], v[52:55]
    v_mfma_f32_16x16x32_bf16 v[56:59], v[124:127], v[44:47], v[56:59]
    v_mfma_f32_16x16x32_bf16 v[48:51], v[44:47], v[44:47], v[48:51]
    v_smfmac_f32_16x16x64_bf16 v[28:31], v[72:75], v[208:215], v18
    v_smfmac_f32_16x16x64_bf16 v[28:31], v[76:79], v[216:223], v18
    v_max3_f32 v60, v52, v53, v54
    s_waitcnt vmcnt(4)
    v_max3_f32 v62, v55, v56, v57
    v_max3_f32 v61, v48, v49, v50
    v_max3_f32 v60, v60, v58, v59
    v_max_f32 v61, v61, v51
    ds_read_b128 v[20:23], v8 offset:0
    v_add_f32 v61, v61, v19
    v_max3_f32 v60, v60, v62, v61
    ds_read_b128 v[24:27], v8 offset:256
    v_mov_b32 v61, v60
    v_smfmac_f32_16x16x64_bf16 v[28:31], v[80:83], v[224:231], v18
    ds_read_b128 v[104:107], v11 offset:32768
    v_permlane32_swap_b32 v60, v61
    v_max_f32 v60, v60, v61
    v_mov_b32 v61, v60
    v_smfmac_f32_16x16x64_bf16 v[28:31], v[84:87], v[232:239], v18
    ds_read_b128 v[108:111], v11 offset:33792
    v_permlane16_swap_b32 v60, v61
    v_max_f32 v60, v60, v61
    v_mul_f32 v62, -v60, s36
    v_smfmac_f32_16x16x64_bf16 v[28:31], v[88:91], v[240:247], v18
    v_add_f32 v63, v62, v19
    v_fma_f32 v52, v52, s36, v62
    v_fma_f32 v53, v53, s36, v62
    v_fma_f32 v54, v54, s36, v62
    v_fma_f32 v55, v55, s36, v62
    v_smfmac_f32_16x16x64_bf16 v[28:31], v[92:95], v[248:255], v18
    v_exp_f32 v52, v52
    v_exp_f32 v53, v53
    v_exp_f32 v54, v54
    v_exp_f32 v55, v55
    v_fma_f32 v56, v56, s36, v62
    v_fma_f32 v57, v57, s36, v62
    v_fma_f32 v58, v58, s36, v62
    v_fma_f32 v59, v59, s36, v62
    v_exp_f32 v56, v56
    v_exp_f32 v57, v57
    v_exp_f32 v58, v58
    v_exp_f32 v59, v59
    v_fma_f32 v48, v48, s36, v63
    v_fma_f32 v49, v49, s36, v63
    v_fma_f32 v50, v50, s36, v63
    v_fma_f32 v51, v51, s36, v63
    v_cvt_pk_bf16_f32 v32, v52, v53
    v_cvt_pk_bf16_f32 v33, v54, v55
    v_exp_f32 v48, v48
    v_exp_f32 v49, v49
    v_exp_f32 v50, v50
    v_exp_f32 v51, v51
    v_cvt_pk_bf16_f32 v34, v56, v57
    v_cvt_pk_bf16_f32 v35, v58, v59
    v_cvt_pk_bf16_f32 v36, v48, v49
    v_cvt_pk_bf16_f32 v37, v50, v51
    s_waitcnt lgkmcnt(2)
    v_mfma_f32_16x16x32_bf16 v[68:71], v[64:67], v[32:35], 0
    v_cvt_pk_bf16_f32 v28, v28, v29
    v_mfma_f32_16x16x32_bf16 v[44:47], v[24:27], v[32:35], 0
    v_cvt_pk_bf16_f32 v29, v30, v31
    v_mfma_f32_16x16x32_bf16 v[40:43], v[20:23], v[32:35], 0
    v_mov_b32 v38, 0
    v_mov_b32 v39, 0
    v_mfma_f32_16x16x16_bf16 v[68:71], v[64:65], v[36:37], v[68:71]
    ds_read_b128 v[120:123], v11 offset:34816
    v_mfma_f32_16x16x16_bf16 v[44:47], v[28:29], v[36:37], v[44:47]
    v_permlane32_swap_b32 v36, v38
    v_permlane32_swap_b32 v37, v39
    ds_read_b128 v[124:127], v11 offset:35840
    ds_read_b128 v[72:75], v15 offset:0
    v_mfma_f32_16x16x16_bf16 v[40:43], v[28:29], v[38:39], v[40:43]
    ds_read_b128 v[76:79], v15 offset:1024
    v_rcp_f32 v60, v68
    ds_read_b128 v[80:83], v15 offset:2048
    ds_read_b128 v[84:87], v15 offset:3072
    ds_read_b128 v[88:91], v15 offset:32768
    ds_read_b128 v[92:95], v15 offset:33792
    s_nop 1
    v_pk_mul_f32 v[40:41], v[40:41], v[60:61] op_sel_hi:[1,0]
    v_pk_mul_f32 v[42:43], v[42:43], v[60:61] op_sel_hi:[1,0]
    v_pk_mul_f32 v[44:45], v[44:45], v[60:61] op_sel_hi:[1,0]
    v_pk_mul_f32 v[46:47], v[46:47], v[60:61] op_sel_hi:[1,0]
    v_cvt_pk_bf16_f32 v40, v40, v41
    v_cvt_pk_bf16_f32 v41, v42, v43
    v_cvt_pk_bf16_f32 v44, v44, v45
    v_cvt_pk_bf16_f32 v45, v46, v47
    s_mov_b64 exec, s[28:29]
    s_waitcnt lgkmcnt(8)
    ds_write_b64 v9, v[40:41]
    ds_write_b64 v9, v[44:45] offset:32
    s_mov_b64 exec, -1
    global_store_dwordx2 v16, v[28:29], s[24:25] sc1
    ds_read_b128 v[64:67], v15 offset:34816
    ds_read_b128 v[68:71], v15 offset:35840
    v_mov_b32 v32, 0
    v_mov_b32 v33, 0
    v_mov_b32 v34, 0
    v_mov_b32 v35, 0
    v_mov_b32 v36, 0
    v_mov_b32 v37, 0
    v_mov_b32 v38, 0
    v_mov_b32 v39, 0
    s_waitcnt lgkmcnt(2)
    s_barrier
    ds_read_b128 v[48:51], v10 offset:0
    ds_read_b128 v[52:55], v10 offset:64
    ds_read_b128 v[56:59], v10 offset:128
    ds_read_b128 v[60:63], v10 offset:192
    v_mov_b32 v40, 0
    v_mov_b32 v41, 0
    v_mov_b32 v42, 0
    v_mov_b32 v43, 0
    v_mov_b32 v44, 0
    v_mov_b32 v45, 0
    v_mov_b32 v46, 0
    v_mov_b32 v47, 0
    s_waitcnt lgkmcnt(3)
    v_smfmac_f32_16x16x64_bf16 v[32:35], v[48:51], v[96:103], v18
    ds_read_b128 v[96:99], v11 offset:4096
    ds_read_b128 v[100:103], v11 offset:5120
    v_smfmac_f32_16x16x64_bf16 v[36:39], v[48:51], v[112:119], v18
    ds_read_b128 v[112:115], v11 offset:6144
    ds_read_b128 v[116:119], v11 offset:7168
    s_waitcnt lgkmcnt(6)
    v_smfmac_f32_16x16x64_bf16 v[32:35], v[52:55], v[104:111], v18
    ds_read_b128 v[104:107], v11 offset:36864
    ds_read_b128 v[108:111], v11 offset:37888
    v_smfmac_f32_16x16x64_bf16 v[36:39], v[52:55], v[120:127], v18
    ds_read_b128 v[120:123], v11 offset:38912
    ds_read_b128 v[124:127], v11 offset:39936
    s_waitcnt lgkmcnt(9)
    v_smfmac_f32_16x16x64_bf16 v[32:35], v[56:59], v[72:79], v18
    ds_read_b128 v[72:75], v15 offset:4096
    ds_read_b128 v[76:79], v15 offset:5120
    v_smfmac_f32_16x16x64_bf16 v[36:39], v[56:59], v[80:87], v18
    ds_read_b128 v[80:83], v15 offset:6144
    ds_read_b128 v[84:87], v15 offset:7168
    s_waitcnt lgkmcnt(12)
    v_smfmac_f32_16x16x64_bf16 v[32:35], v[60:63], v[88:95], v18
    ds_read_b128 v[88:91], v15 offset:36864
    ds_read_b128 v[92:95], v15 offset:37888
    v_smfmac_f32_16x16x64_bf16 v[36:39], v[60:63], v[64:71], v18
    s_waitcnt lgkmcnt(13)
    ds_read_b128 v[64:67], v15 offset:38912
    ds_read_b128 v[68:71], v15 offset:39936
    s_waitcnt lgkmcnt(14)
    v_smfmac_f32_16x16x64_bf16 v[40:43], v[48:51], v[96:103], v18
    s_waitcnt lgkmcnt(12)
    v_smfmac_f32_16x16x64_bf16 v[44:47], v[48:51], v[112:119], v18
    s_waitcnt lgkmcnt(10)
    v_smfmac_f32_16x16x64_bf16 v[40:43], v[52:55], v[104:111], v18
    s_waitcnt lgkmcnt(8)
    v_smfmac_f32_16x16x64_bf16 v[44:47], v[52:55], v[120:127], v18
    v_cvt_pk_bf16_f32 v32, v32, v33
    v_cvt_pk_bf16_f32 v33, v34, v35
    v_cvt_pk_bf16_f32 v34, v36, v37
    v_cvt_pk_bf16_f32 v35, v38, v39
    v_and_b32 v32, -2, v32
    v_and_b32 v33, -2, v33
    v_and_b32 v34, -2, v34
    v_and_b32 v35, -2, v35
    global_store_dwordx4 v12, v[32:35], s[14:15] offset:0
    s_waitcnt lgkmcnt(6)
    v_smfmac_f32_16x16x64_bf16 v[40:43], v[56:59], v[72:79], v18
    s_waitcnt lgkmcnt(4)
    v_smfmac_f32_16x16x64_bf16 v[44:47], v[56:59], v[80:87], v18
    s_waitcnt lgkmcnt(2)
    v_smfmac_f32_16x16x64_bf16 v[40:43], v[60:63], v[88:95], v18
    s_waitcnt lgkmcnt(0)
    v_smfmac_f32_16x16x64_bf16 v[44:47], v[60:63], v[64:71], v18
    s_add_u32 s22, s22, 65536
    s_addc_u32 s23, s23, 0
    s_add_u32 s24, s24, 65536
    s_addc_u32 s25, s25, 0
    s_ashr_i32 s37, s52, 31
    s_nop 1
    v_cvt_pk_bf16_f32 v40, v40, v41
    v_cvt_pk_bf16_f32 v41, v42, v43
    v_cvt_pk_bf16_f32 v42, v44, v45
    v_cvt_pk_bf16_f32 v43, v46, v47
    v_and_b32 v40, -2, v40
    v_and_b32 v41, -2, v41
    v_and_b32 v42, -2, v42
    v_and_b32 v43, -2, v43
    global_store_dwordx4 v12, v[40:43], s[14:15] offset:1024
    s_add_u32 s10, s10, s52
    s_addc_u32 s11, s11, s37
    v_mov_b32 v96, 0
    v_mov_b32 v97, 0
    v_mov_b32 v98, 0
    v_mov_b32 v99, 0
    s_mov_b32 s42, 0x10001
    s_mov_b32 s43, 0x10001
    s_mov_b64 exec, s[42:43]
    v_mov_b32 v96, 0x00003f80
    s_lshl_b64 exec, exec, 1
    v_mov_b32 v96, 0x3f800000
    s_mov_b32 s42, 0x40004
    s_mov_b32 s43, 0x40004
    s_mov_b64 exec, s[42:43]
    v_mov_b32 v97, 0x00003f80
    s_lshl_b64 exec, exec, 1
    v_mov_b32 v97, 0x3f800000
    s_mov_b32 s42, 0x100010
    s_mov_b32 s43, 0x100010
    s_mov_b64 exec, s[42:43]
    v_mov_b32 v98, 0x00003f80
    s_lshl_b64 exec, exec, 1
    v_mov_b32 v98, 0x3f800000
    s_mov_b32 s42, 0x400040
    s_mov_b32 s43, 0x400040
    s_mov_b64 exec, s[42:43]
    v_mov_b32 v99, 0x00003f80
    s_lshl_b64 exec, exec, 1
    v_mov_b32 v99, 0x3f800000
    s_mov_b64 exec, -1
    s_waitcnt vmcnt(0)
    s_mov_b32 s40, 0
LpollA_33:
    global_load_dwordx4 v[48:51], v13, s[14:15] sc1
    global_load_dwordx4 v[52:55], v13, s[16:17] sc1
    s_add_u32 s40, s40, 1
    s_cmp_gt_u32 s40, 262144
    s_cbranch_scc1 Lto_15
    s_waitcnt vmcnt(0)
    v_or3_b32 v68, v48, v49, v50
    v_or3_b32 v69, v51, v52, v53
    v_or3_b32 v68, v68, v54, v55
    v_or_b32 v68, v68, v69
    v_and_b32 v68, 1, v68
    v_cmp_ne_u32 vcc, 0, v68
    s_cbranch_vccnz LpollA_33
    v_mfma_f32_16x16x32_bf16 v[56:59], v[96:99], v[48:51], 0
    v_mfma_f32_16x16x32_bf16 v[56:59], v[96:99], v[52:55], v[56:59]
    s_sub_u32 s52, 0, s52
    s_nop 6
    v_add_f32_dpp v56, v56, v56 row_ror:8 row_mask:0xf bank_mask:0xf
    v_add_f32_dpp v57, v57, v57 row_ror:8 row_mask:0xf bank_mask:0xf
    v_add_f32_dpp v58, v58, v58 row_ror:8 row_mask:0xf bank_mask:0xf
    v_add_f32_dpp v59, v59, v59 row_ror:8 row_mask:0xf bank_mask:0xf
    v_add_f32_dpp v56, v56, v56 row_ror:4 row_mask:0xf bank_mask:0xf
    v_add_f32_dpp v57, v57, v57 row_ror:4 row_mask:0xf bank_mask:0xf
    v_add_f32_dpp v58, v58, v58 row_ror:4 row_mask:0xf bank_mask:0xf
    v_add_f32_dpp v59, v59, v59 row_ror:4 row_mask:0xf bank_mask:0xf
    v_cndmask_b32 v56, v56, v57, s[34:35]
    v_cndmask_b32 v58, v58, v59, s[34:35]
    v_cndmask_b32 v56, v56, v58, s[32:33]
    s_nop 1
    v_mov_b32_dpp v57, v56 quad_perm:[1,0,3,2] row_mask:0xf bank_mask:0xf
    v_cvt_pk_bf16_f32 v56, v56, v57
    v_min_u32 v56, 0xfffffffe, v56
    s_mov_b64 exec, s[30:31]
    global_store_dword v14, v56, s[12:13]
    s_ashr_i32 s37, s52, 31
    s_add_u32 s12, s12, s52
    s_addc_u32 s13, s13, s37
    v_mov_b32 v57, -1
    global_store_dword v14, v57, s[12:13]
    s_mov_b64 exec, -1
    s_add_u32 s7, s7, 1
    v_mov_b32 v20, 0
    v_mov_b32 v21, 0
    v_mov_b32 v22, 0
    v_mov_b32 v23, 0
    v_mov_b32 v24, 0
    v_mov_b32 v25, 0
    v_mov_b32 v26, 0
    v_mov_b32 v27, 0
    v_mov_b32 v28, 0
    v_mov_b32 v29, 0
    v_mov_b32 v30, 0
    v_mov_b32 v31, 0
    s_cmp_eq_u32 s45, 0
    s_cbranch_scc1 Lnk_34
    s_mov_b64 exec, 3
    v_cmp_gt_u32 vcc, v17, v4
    s_cbranch_vccz Lfsok_36
    s_mov_b32 s40, 0
Lfs_35:
    s_mov_b64 exec, 15
    global_load_dword v4, v0, s[26:27] sc1
    s_add_u32 s40, s40, 1
    s_cmp_gt_u32 s40, 262144
    s_cbranch_scc1 Lto_15
    s_waitcnt vmcnt(0)
    s_mov_b64 exec, 3
    v_cmp_gt_u32 vcc, v17, v4
    s_cbranch_vccnz Lfs_35
Lfsok_36:
    s_mov_b64 exec, 3
    v_add_u32 v17, 1, v17
    v_min_u32 v17, 64, v17
    s_mov_b64 exec, -1
    s_mov_b32 m0, s46
    s_nop 0
    global_load_lds_dwordx4 v0, s[18:19] sc1
    global_load_lds_dwordx4 v0, s[18:19] offset:1024 sc1
    s_add_u32 s18, s18, 262144
    s_addc_u32 s19, s19, 0
    s_waitcnt vmcnt(0)
    s_mov_b32 s45, 0
Lnk_34:
    s_mov_b64 exec, 12
    v_cmp_gt_u32 vcc, v17, v4
    s_cbranch_vccz Lfsok_38
    s_mov_b32 s40, 0
Lfs_37:
    s_mov_b64 exec, 15
    global_load_dword v4, v0, s[26:27] sc1
    s_add_u32 s40, s40, 1
    s_cmp_gt_u32 s40, 262144
    s_cbranch_scc1 Lto_15
    s_waitcnt vmcnt(0)
    s_mov_b64 exec, 12
    v_cmp_gt_u32 vcc, v17, v4
    s_cbranch_vccnz Lfs_37
Lfsok_38:
    s_mov_b64 exec, 12
    v_add_u32 v17, 1, v17
    v_min_u32 v17, 64, v17
    s_mov_b64 exec, -1
    s_mov_b64 exec, 3
    v_cmp_gt_u32 vcc, v17, v4
    s_mov_b64 exec, -1
    s_cmp_eq_u64 vcc, 0
    s_cselect_b32 s44, 1, 0
    s_mov_b32 m0, s47
    s_waitcnt vmcnt(0)
    s_mov_b32 s40, 0
LpollB_39:
    global_load_dwordx4 v[32:35], v0, s[10:11] sc1
    global_load_dwordx4 v[36:39], v0, s[10:11] offset:1024 sc1
    s_add_u32 s40, s40, 1
    s_cmp_gt_u32 s40, 262144
    s_cbranch_scc1 Lto_15
    s_waitcnt vmcnt(0)
    ds_write_b128 v1, v[32:35]
    ds_write_b128 v1, v[36:39] offset:1056
    v_max3_u32 v40, v32, v33, v34
    v_max3_u32 v41, v35, v36, v37
    v_max3_u32 v40, v40, v38, v39
    v_max_u32 v40, v40, v41
    v_cmp_eq_u32 vcc, -1, v40
    s_cbranch_vccnz LpollB_39
    s_cmp_lg_u32 s5, 0
    s_cbranch_scc1 Lskf_40
    v_mov_b32 v4, s7
    s_mov_b64 exec, 1
    global_store_dword v0, v4, s[48:49] sc1
    s_mov_b64 exec, -1
Lskf_40:
    global_load_lds_dwordx4 v0, s[20:21] sc1
    global_load_lds_dwordx4 v0, s[20:21] offset:1024 sc1
    s_waitcnt lgkmcnt(0)
    s_barrier
    ds_read_b128 v[32:35], v2 offset:0
    ds_read_b128 v[36:39], v2 offset:64
    ds_read_b128 v[40:43], v2 offset:128
    ds_read_b128 v[44:47], v2 offset:192
    ds_read_b128 v[48:51], v2 offset:256
    ds_read_b128 v[52:55], v2 offset:320
    ds_read_b128 v[56:59], v2 offset:384
    ds_read_b128 v[60:63], v2 offset:448
    s_waitcnt lgkmcnt(7)
    v_smfmac_f32_16x16x64_bf16 v[20:23], v[32:35], a[0:7], v18
    ds_read_b128 v[64:67], v2 offset:512
    v_smfmac_f32_16x16x64_bf16 v[24:27], v[32:35], a[128:135], v18
    s_waitcnt lgkmcnt(7)
    v_smfmac_f32_16x16x64_bf16 v[20:23], v[36:39], a[8:15], v18
    ds_read_b128 v[68:71], v2 offset:576
    v_smfmac_f32_16x16x64_bf16 v[24:27], v[36:39], a[136:143], v18
    s_waitcnt lgkmcnt(7)
    v_smfmac_f32_16x16x64_bf16 v[20:23], v[40:43], a[16:23], v18
    ds_read_b128 v[72:75], v2 offset:640
    v_smfmac_f32_16x16x64_bf16 v[24:27], v[40:43], a[144:151], v18
    s_waitcnt lgkmcnt(7)
    v_smfmac_f32_16x16x64_bf16 v[20:23], v[44:47], a[24:31], v18
    ds_read_b128 v[76:79], v2 offset:704
    v_smfmac_f32_16x16x64_bf16 v[24:27], v[44:47], a[152:159], v18
    s_waitcnt lgkmcnt(7)
    v_smfmac_f32_16x16x64_bf16 v[20:23], v[48:51], a[32:39], v18
    ds_read_b128 v[80:83], v2 offset:768
    v_smfmac_f32_16x16x64_bf16 v[24:27], v[48:51], a[160:167], v18
    s_waitcnt lgkmcnt(7)
    v_smfmac_f32_16x16x64_bf16 v[20:23], v[52:55], a[40:47], v18
    ds_read_b128 v[84:87], v2 offset:832
    v_smfmac_f32_16x16x64_bf16 v[24:27], v[52:55], a[168:175], v18
    s_waitcnt lgkmcnt(7)
    v_smfmac_f32_16x16x64_bf16 v[20:23], v[56:59], a[48:55], v18
    ds_read_b128 v[88:91], v2 offset:896
    v_smfmac_f32_16x16x64_bf16 v[24:27], v[56:59], a[176:183], v18
    s_waitcnt lgkmcnt(7)
    v_smfmac_f32_16x16x64_bf16 v[20:23], v[60:63], a[56:63], v18
    ds_read_b128 v[92:95], v2 offset:960
    v_smfmac_f32_16x16x64_bf16 v[24:27], v[60:63], a[184:191], v18
    s_waitcnt lgkmcnt(7)
    v_smfmac_f32_16x16x64_bf16 v[20:23], v[64:67], a[64:71], v18
    ds_read_b128 v[96:99], v7 offset:0
    v_smfmac_f32_16x16x64_bf16 v[24:27], v[64:67], a[192:199], v18
    s_mov_b64 exec, 15
    global_load_dword v4, v0, s[26:27] sc1
    s_mov_b64 exec, -1
    s_waitcnt lgkmcnt(7)
    v_smfmac_f32_16x16x64_bf16 v[20:23], v[68:71], a[72:79], v18
    ds_read_b128 v[100:103], v7 offset:2048
    v_smfmac_f32_16x16x64_bf16 v[24:27], v[68:71], a[200:207], v18
    s_add_u32 s20, s20, 262144
    s_addc_u32 s21, s21, 0
    s_waitcnt lgkmcnt(7)
    v_smfmac_f32_16x16x64_bf16 v[20:23], v[72:75], a[80:87], v18
    ds_read_b128 v[104:107], v7 offset:4096
    v_smfmac_f32_16x16x64_bf16 v[24:27], v[72:75], a[208:215], v18
    s_waitcnt lgkmcnt(7)
    v_smfmac_f32_16x16x64_bf16 v[20:23], v[76:79], a[88:95], v18
    ds_read_b128 v[108:111], v7 offset:6144
    v_smfmac_f32_16x16x64_bf16 v[24:27], v[76:79], a[216:223], v18
    s_waitcnt lgkmcnt(7)
    v_smfmac_f32_16x16x64_bf16 v[20:23], v[80:83], a[96:103], v18
    ds_read_b128 v[112:115], v7 offset:256
    v_smfmac_f32_16x16x64_bf16 v[24:27], v[80:83], a[224:231], v18
    s_waitcnt lgkmcnt(7)
    v_smfmac_f32_16x16x64_bf16 v[20:23], v[84:87], a[104:111], v18
    ds_read_b128 v[116:119], v7 offset:2304
    v_smfmac_f32_16x16x64_bf16 v[24:27], v[84:87], a[232:239], v18
    s_waitcnt lgkmcnt(7)
    v_smfmac_f32_16x16x64_bf16 v[20:23], v[88:91], a[112:119], v18
    ds_read_b128 v[120:123], v7 offset:4352
    v_smfmac_f32_16x16x64_bf16 v[24:27], v[88:91], a[240:247], v18
    s_waitcnt lgkmcnt(7)
    v_smfmac_f32_16x16x64_bf16 v[20:23], v[92:95], a[120:127], v18
    ds_read_b128 v[124:127], v7 offset:6400
    v_smfmac_f32_16x16x64_bf16 v[24:27], v[92:95], a[248:255], v18
    v_smfmac_f32_16x16x64_bf16 v[28:31], v[32:35], v[128:135], v18
    v_smfmac_f32_16x16x64_bf16 v[28:31], v[36:39], v[136:143], v18
    v_cvt_pk_bf16_f32 v20, v20, v21
    v_cvt_pk_bf16_f32 v21, v22, v23
    v_xor_b32 v22, 16, v3
    v_cvt_pk_bf16_f32 v24, v24, v25
    v_cvt_pk_bf16_f32 v25, v26, v27
    ds_write_b64 v3, v[20:21]
    ds_write_b64 v22, v[24:25]
    global_store_dwordx2 v16, v[24:25], s[22:23] sc1
    v_smfmac_f32_16x16x64_bf16 v[28:31], v[40:43], v[144:151], v18
    v_smfmac_f32_16x16x64_bf16 v[28:31], v[44:47], v[152:159], v18
    v_smfmac_f32_16x16x64_bf16 v[28:31], v[48:51], v[160:167], v18
    v_smfmac_f32_16x16x64_bf16 v[28:31], v[52:55], v[168:175], v18
    s_waitcnt lgkmcnt(0)
    s_barrier
    ds_read_b64_tr_b16 v[32:33], v5 offset:0
    ds_read_b64_tr_b16 v[34:35], v6 offset:0
    ds_read_b64_tr_b16 v[36:37], v5 offset:1024
    ds_read_b64_tr_b16 v[38:39], v6 offset:1024
    ds_read_b64_tr_b16 v[40:41], v5 offset:2048
    ds_read_b64_tr_b16 v[42:43], v6 offset:2048
    ds_read_b64_tr_b16 v[44:45], v5 offset:3072
    ds_read_b64_tr_b16 v[46:47], v6 offset:3072
    v_smfmac_f32_16x16x64_bf16 v[28:31], v[56:59], v[176:183], v18
    s_mov_b32 m0, s46
    s_nop 0
    global_load_lds_dwordx4 v0, s[18:19] sc1
    v_smfmac_f32_16x16x64_bf16 v[28:31], v[60:63], v[184:191], v18
    global_load_lds_dwordx4 v0, s[18:19] offset:1024 sc1
    v_smfmac_f32_16x16x64_bf16 v[28:31], v[64:67], v[192:199], v18
    s_cmp_eq_u32 s44, 0
    s_cbranch_scc1 Lks_42
    s_add_u32 s18, s18, 262144
    s_addc_u32 s19, s19, 0
    s_mov_b64 exec, 3
    v_add_u32 v17, 1, v17
    v_min_u32 v17, 64, v17
    s_mov_b64 exec, -1
    s_branch Lkd_43
Lks_42:
    s_mov_b32 s45, 1
Lkd_43:
    v_smfmac_f32_16x16x64_bf16 v[28:31], v[68:71], v[200:207], v18
    v_mov_b32 v64, 0x3f803f80
    v_mov_b32 v65, 0x3f803f80
    v_mov_b32 v66, 0x3f803f80
    v_mov_b32 v67, 0x3f803f80
    s_waitcnt lgkmcnt(6)
    v_mfma_f32_16x16x32_bf16 v[52:55], v[96:99], v[32:35], 0
    v_mfma_f32_16x16x32_bf16 v[56:59], v[112:115], v[32:35], 0
    v_mfma_f32_16x16x32_bf16 v[48:51], v[32:35], v[32:35], 0
    s_waitcnt lgkmcnt(4)
    v_mfma_f32_16x16x32_bf16 v[52:55], v[100:103], v[36:39], v[52:55]
    v_mfma_f32_16x16x32_bf16 v[56:59], v[116:119], v[36:39], v[56:59]
    v_mfma_f32_16x16x32_bf16 v[48:51], v[36:39], v[36:39], v[48:51]
    ds_read_b128 v[96:99], v11 offset:0
    ds_read_b128 v[100:103], v11 offset:1024
    ds_read_b128 v[112:115], v11 offset:2048
    ds_read_b128 v[116:119], v11 offset:3072
    s_waitcnt lgkmcnt(6)
    v_mfma_f32_16x16x32_bf16 v[52:55], v[104:107], v[40:43], v[52:55]
    v_mfma_f32_16x16x32_bf16 v[56:59], v[120:123], v[40:43], v[56:59]
    v_mfma_f32_16x16x32_bf16 v[48:51], v[40:43], v[40:43], v[48:51]
    s_waitcnt lgkmcnt(4)
    v_mfma_f32_16x16x32_bf16 v[52:55], v[108:111], v[44:47], v[52:55]
    v_mfma_f32_16x16x32_bf16 v[56:59], v[124:127], v[44:47], v[56:59]
    v_mfma_f32_16x16x32_bf16 v[48:51], v[44:47], v[44:47], v[48:51]
    v_smfmac_f32_16x16x64_bf16 v[28:31], v[72:75], v[208:215], v18
    v_smfmac_f32_16x16x64_bf16 v[28:31], v[76:79], v[216:223], v18
    v_max3_f32 v60, v52, v53, v54
    s_waitcnt vmcnt(4)
    v_max3_f32 v62, v55, v56, v57
    v_max3_f32 v61, v48, v49, v50
    v_max3_f32 v60, v60, v58, v59
    v_max_f32 v61, v61, v51
    ds_read_b128 v[20:23], v8 offset:0
    v_add_f32 v61, v61, v19
    v_max3_f32 v60, v60, v62, v61
    ds_read_b128 v[24:27], v8 offset:256
    v_mov_b32 v61, v60
    v_smfmac_f32_16x16x64_bf16 v[28:31], v[80:83], v[224:231], v18
    ds_read_b128 v[104:107], v11 offset:32768
    v_permlane32_swap_b32 v60, v61
    v_max_f32 v60, v60, v61
    v_mov_b32 v61, v60
    v_smfmac_f32_16x16x64_bf16 v[28:31], v[84:87], v[232:239], v18
    ds_read_b128 v[108:111], v11 offset:33792
    v_permlane16_swap_b32 v60, v61
    v_max_f32 v60, v60, v61
    v_mul_f32 v62, -v60, s36
    v_smfmac_f32_16x16x64_bf16 v[28:31], v[88:91], v[240:247], v18
    v_add_f32 v63, v62, v19
    v_fma_f32 v52, v52, s36, v62
    v_fma_f32 v53, v53, s36, v62
    v_fma_f32 v54, v54, s36, v62
    v_fma_f32 v55, v55, s36, v62
    v_smfmac_f32_16x16x64_bf16 v[28:31], v[92:95], v[248:255], v18
    v_exp_f32 v52, v52
    v_exp_f32 v53, v53
    v_exp_f32 v54, v54
    v_exp_f32 v55, v55
    v_fma_f32 v56, v56, s36, v62
    v_fma_f32 v57, v57, s36, v62
    v_fma_f32 v58, v58, s36, v62
    v_fma_f32 v59, v59, s36, v62
    v_exp_f32 v56, v56
    v_exp_f32 v57, v57
    v_exp_f32 v58, v58
    v_exp_f32 v59, v59
    v_fma_f32 v48, v48, s36, v63
    v_fma_f32 v49, v49, s36, v63
    v_fma_f32 v50, v50, s36, v63
    v_fma_f32 v51, v51, s36, v63
    v_cvt_pk_bf16_f32 v32, v52, v53
    v_cvt_pk_bf16_f32 v33, v54, v55
    v_exp_f32 v48, v48
    v_exp_f32 v49, v49
    v_exp_f32 v50, v50
    v_exp_f32 v51, v51
    v_cvt_pk_bf16_f32 v34, v56, v57
    v_cvt_pk_bf16_f32 v35, v58, v59
    v_cvt_pk_bf16_f32 v36, v48, v49
    v_cvt_pk_bf16_f32 v37, v50, v51
    s_waitcnt lgkmcnt(2)
    v_mfma_f32_16x16x32_bf16 v[68:71], v[64:67], v[32:35], 0
    v_cvt_pk_bf16_f32 v28, v28, v29
    v_mfma_f32_16x16x32_bf16 v[44:47], v[24:27], v[32:35], 0
    v_cvt_pk_bf16_f32 v29, v30, v31
    v_mfma_f32_16x16x32_bf16 v[40:43], v[20:23], v[32:35], 0
    v_mov_b32 v38, 0
    v_mov_b32 v39, 0
    v_mfma_f32_16x16x16_bf16 v[68:71], v[64:65], v[36:37], v[68:71]
    ds_read_b128 v[120:123], v11 offset:34816
    v_mfma_f32_16x16x16_bf16 v[44:47], v[28:29], v[36:37], v[44:47]
    v_permlane32_swap_b32 v36, v38
    v_permlane32_swap_b32 v37, v39
    ds_read_b128 v[124:127], v11 offset:35840
    ds_read_b128 v[72:75], v15 offset:0
    v_mfma_f32_16x16x16_bf16 v[40:43], v[28:29], v[38:39], v[40:43]
    ds_read_b128 v[76:79], v15 offset:1024
    v_rcp_f32 v60, v68
    ds_read_b128 v[80:83], v15 offset:2048
    ds_read_b128 v[84:87], v15 offset:3072
    ds_read_b128 v[88:91], v15 offset:32768
    ds_read_b128 v[92:95], v15 offset:33792
    s_nop 1
    v_pk_mul_f32 v[40:41], v[40:41], v[60:61] op_sel_hi:[1,0]
    v_pk_mul_f32 v[42:43], v[42:43], v[60:61] op_sel_hi:[1,0]
    v_pk_mul_f32 v[44:45], v[44:45], v[60:61] op_sel_hi:[1,0]
    v_pk_mul_f32 v[46:47], v[46:47], v[60:61] op_sel_hi:[1,0]
    v_cvt_pk_bf16_f32 v40, v40, v41
    v_cvt_pk_bf16_f32 v41, v42, v43
    v_cvt_pk_bf16_f32 v44, v44, v45
    v_cvt_pk_bf16_f32 v45, v46, v47
    s_mov_b64 exec, s[28:29]
    s_waitcnt lgkmcnt(8)
    ds_write_b64 v9, v[40:41]
    ds_write_b64 v9, v[44:45] offset:32
    s_mov_b64 exec, -1
    global_store_dwordx2 v16, v[28:29], s[24:25] sc1
    s_cmp_eq_u32 s7, 63
    s_cbranch_scc1 Lfin_17
    ds_read_b128 v[64:67], v15 offset:34816
    ds_read_b128 v[68:71], v15 offset:35840
    v_mov_b32 v32, 0
    v_mov_b32 v33, 0
    v_mov_b32 v34, 0
    v_mov_b32 v35, 0
    v_mov_b32 v36, 0
    v_mov_b32 v37, 0
    v_mov_b32 v38, 0
    v_mov_b32 v39, 0
    s_waitcnt lgkmcnt(2)
    s_barrier
    ds_read_b128 v[48:51], v10 offset:0
    ds_read_b128 v[52:55], v10 offset:64
    ds_read_b128 v[56:59], v10 offset:128
    ds_read_b128 v[60:63], v10 offset:192
    v_mov_b32 v40, 0
    v_mov_b32 v41, 0
    v_mov_b32 v42, 0
    v_mov_b32 v43, 0
    v_mov_b32 v44, 0
    v_mov_b32 v45, 0
    v_mov_b32 v46, 0
    v_mov_b32 v47, 0
    s_waitcnt lgkmcnt(3)
    v_smfmac_f32_16x16x64_bf16 v[32:35], v[48:51], v[96:103], v18
    ds_read_b128 v[96:99], v11 offset:4096
    ds_read_b128 v[100:103], v11 offset:5120
    v_smfmac_f32_16x16x64_bf16 v[36:39], v[48:51], v[112:119], v18
    ds_read_b128 v[112:115], v11 offset:6144
    ds_read_b128 v[116:119], v11 offset:7168
    s_waitcnt lgkmcnt(6)
    v_smfmac_f32_16x16x64_bf16 v[32:35], v[52:55], v[104:111], v18
    ds_read_b128 v[104:107], v11 offset:36864
    ds_read_b128 v[108:111], v11 offset:37888
    v_smfmac_f32_16x16x64_bf16 v[36:39], v[52:55], v[120:127], v18
    ds_read_b128 v[120:123], v11 offset:38912
    ds_read_b128 v[124:127], v11 offset:39936
    s_waitcnt lgkmcnt(9)
    v_smfmac_f32_16x16x64_bf16 v[32:35], v[56:59], v[72:79], v18
    ds_read_b128 v[72:75], v15 offset:4096
    ds_read_b128 v[76:79], v15 offset:5120
    v_smfmac_f32_16x16x64_bf16 v[36:39], v[56:59], v[80:87], v18
    ds_read_b128 v[80:83], v15 offset:6144
    ds_read_b128 v[84:87], v15 offset:7168
    s_waitcnt lgkmcnt(12)
    v_smfmac_f32_16x16x64_bf16 v[32:35], v[60:63], v[88:95], v18
    ds_read_b128 v[88:91], v15 offset:36864
    ds_read_b128 v[92:95], v15 offset:37888
    v_smfmac_f32_16x16x64_bf16 v[36:39], v[60:63], v[64:71], v18
    s_waitcnt lgkmcnt(13)
    ds_read_b128 v[64:67], v15 offset:38912
    ds_read_b128 v[68:71], v15 offset:39936
    s_waitcnt lgkmcnt(14)
    v_smfmac_f32_16x16x64_bf16 v[40:43], v[48:51], v[96:103], v18
    s_waitcnt lgkmcnt(12)
    v_smfmac_f32_16x16x64_bf16 v[44:47], v[48:51], v[112:119], v18
    s_waitcnt lgkmcnt(10)
    v_smfmac_f32_16x16x64_bf16 v[40:43], v[52:55], v[104:111], v18
    s_waitcnt lgkmcnt(8)
    v_smfmac_f32_16x16x64_bf16 v[44:47], v[52:55], v[120:127], v18
    v_cvt_pk_bf16_f32 v32, v32, v33
    v_cvt_pk_bf16_f32 v33, v34, v35
    v_cvt_pk_bf16_f32 v34, v36, v37
    v_cvt_pk_bf16_f32 v35, v38, v39
    v_or_b32 v32, 1, v32
    v_or_b32 v33, 1, v33
    v_or_b32 v34, 1, v34
    v_or_b32 v35, 1, v35
    global_store_dwordx4 v12, v[32:35], s[14:15] offset:0
    s_waitcnt lgkmcnt(6)
    v_smfmac_f32_16x16x64_bf16 v[40:43], v[56:59], v[72:79], v18
    s_waitcnt lgkmcnt(4)
    v_smfmac_f32_16x16x64_bf16 v[44:47], v[56:59], v[80:87], v18
    s_waitcnt lgkmcnt(2)
    v_smfmac_f32_16x16x64_bf16 v[40:43], v[60:63], v[88:95], v18
    s_waitcnt lgkmcnt(0)
    v_smfmac_f32_16x16x64_bf16 v[44:47], v[60:63], v[64:71], v18
    s_add_u32 s22, s22, 65536
    s_addc_u32 s23, s23, 0
    s_add_u32 s24, s24, 65536
    s_addc_u32 s25, s25, 0
    s_ashr_i32 s37, s52, 31
    s_nop 1
    v_cvt_pk_bf16_f32 v40, v40, v41
    v_cvt_pk_bf16_f32 v41, v42, v43
    v_cvt_pk_bf16_f32 v42, v44, v45
    v_cvt_pk_bf16_f32 v43, v46, v47
    v_or_b32 v40, 1, v40
    v_or_b32 v41, 1, v41
    v_or_b32 v42, 1, v42
    v_or_b32 v43, 1, v43
    global_store_dwordx4 v12, v[40:43], s[14:15] offset:1024
    s_add_u32 s10, s10, s52
    s_addc_u32 s11, s11, s37
    v_mov_b32 v96, 0
    v_mov_b32 v97, 0
    v_mov_b32 v98, 0
    v_mov_b32 v99, 0
    s_mov_b32 s42, 0x10001
    s_mov_b32 s43, 0x10001
    s_mov_b64 exec, s[42:43]
    v_mov_b32 v96, 0x00003f80
    s_lshl_b64 exec, exec, 1
    v_mov_b32 v96, 0x3f800000
    s_mov_b32 s42, 0x40004
    s_mov_b32 s43, 0x40004
    s_mov_b64 exec, s[42:43]
    v_mov_b32 v97, 0x00003f80
    s_lshl_b64 exec, exec, 1
    v_mov_b32 v97, 0x3f800000
    s_mov_b32 s42, 0x100010
    s_mov_b32 s43, 0x100010
    s_mov_b64 exec, s[42:43]
    v_mov_b32 v98, 0x00003f80
    s_lshl_b64 exec, exec, 1
    v_mov_b32 v98, 0x3f800000
    s_mov_b32 s42, 0x400040
    s_mov_b32 s43, 0x400040
    s_mov_b64 exec, s[42:43]
    v_mov_b32 v99, 0x00003f80
    s_lshl_b64 exec, exec, 1
    v_mov_b32 v99, 0x3f800000
    s_mov_b64 exec, -1
    s_waitcnt vmcnt(0)
    s_mov_b32 s40, 0
LpollA_44:
    global_load_dwordx4 v[48:51], v13, s[14:15] sc1
    global_load_dwordx4 v[52:55], v13, s[16:17] sc1
    s_add_u32 s40, s40, 1
    s_cmp_gt_u32 s40, 262144
    s_cbranch_scc1 Lto_15
    s_waitcnt vmcnt(0)
    v_bitop3_b32 v68, v48, v49, v50 bitop3:0x80
    v_bitop3_b32 v69, v51, v52, v53 bitop3:0x80
    v_bitop3_b32 v68, v68, v54, v55 bitop3:0x80
    v_and_b32 v68, v68, v69
    v_and_b32 v68, 1, v68
    v_cmp_ne_u32 vcc, 1, v68
    s_cbranch_vccnz LpollA_44
    v_mfma_f32_16x16x32_bf16 v[56:59], v[96:99], v[48:51], 0
    v_mfma_f32_16x16x32_bf16 v[56:59], v[96:99], v[52:55], v[56:59]
    s_sub_u32 s52, 0, s52
    s_nop 6
    v_add_f32_dpp v56, v56, v56 row_ror:8 row_mask:0xf bank_mask:0xf
    v_add_f32_dpp v57, v57, v57 row_ror:8 row_mask:0xf bank_mask:0xf
    v_add_f32_dpp v58, v58, v58 row_ror:8 row_mask:0xf bank_mask:0xf
    v_add_f32_dpp v59, v59, v59 row_ror:8 row_mask:0xf bank_mask:0xf
    v_add_f32_dpp v56, v56, v56 row_ror:4 row_mask:0xf bank_mask:0xf
    v_add_f32_dpp v57, v57, v57 row_ror:4 row_mask:0xf bank_mask:0xf
    v_add_f32_dpp v58, v58, v58 row_ror:4 row_mask:0xf bank_mask:0xf
    v_add_f32_dpp v59, v59, v59 row_ror:4 row_mask:0xf bank_mask:0xf
    v_cndmask_b32 v56, v56, v57, s[34:35]
    v_cndmask_b32 v58, v58, v59, s[34:35]
    v_cndmask_b32 v56, v56, v58, s[32:33]
    s_nop 1
    v_mov_b32_dpp v57, v56 quad_perm:[1,0,3,2] row_mask:0xf bank_mask:0xf
    v_cvt_pk_bf16_f32 v56, v56, v57
    v_min_u32 v56, 0xfffffffe, v56
    s_mov_b64 exec, s[30:31]
    global_store_dword v14, v56, s[12:13]
    s_ashr_i32 s37, s52, 31
    s_add_u32 s12, s12, s52
    s_addc_u32 s13, s13, s37
    v_mov_b32 v57, -1
    global_store_dword v14, v57, s[12:13]
    s_mov_b64 exec, -1
    s_add_u32 s7, s7, 1
    s_cmp_lt_u32 s7, 64
    s_cbranch_scc1 Lstep_16
Lfin_17:
    s_mov_b32 s7, 64
    s_waitcnt vmcnt(0) lgkmcnt(0)
    s_barrier
    v_mov_b32 v95, s7
    s_mov_b64 exec, 1
    global_store_dword v0, v95, s[48:49] sc1
    s_waitcnt vmcnt(0)
    s_endpgm
Lto_15:
    s_load_dwordx2 s[42:43], s[0:1], 88
    s_waitcnt lgkmcnt(0)
    s_mov_b64 exec, 1
    v_mov_b32 v32, 136
    v_mov_b32 v33, s7
    v_add_u32 v33, 0x10000, v33
    global_store_dword v32, v33, s[42:43] sc1
    s_waitcnt vmcnt(0)
    s_endpgm
L_R_slow:
    s_load_dwordx2 s[42:43], s[0:1], 88
    s_mov_b32 s40, 0
    s_mov_b32 s7, 0
    v_mov_b32 v32, 248
    s_waitcnt lgkmcnt(0)
Lwi_48:
    global_load_dword v33, v32, s[42:43] sc1
    s_add_u32 s40, s40, 1
    s_cmp_gt_u32 s40, 262144
    s_cbranch_scc1 Lwito_49
    s_waitcnt vmcnt(0)
    v_cmp_gt_u32 vcc, 1, v33
    s_cbranch_vccnz Lwi_48
    s_branch Lwisk_50
Lwito_49:
    s_load_dwordx2 s[42:43], s[0:1], 88
    s_waitcnt lgkmcnt(0)
    s_mov_b64 exec, 1
    v_mov_b32 v32, 180
    v_mov_b32 v33, s7
    v_add_u32 v33, 0x10000, v33
    global_store_dword v32, v33, s[42:43] sc1
    s_waitcnt vmcnt(0)
    s_endpgm
Lwisk_50:
    v_mov_b32 v17, 1
    v_mov_b32 v4, 0
    s_mov_b32 s45, 0
    s_mov_b32 s44, 1
    s_mov_b64 exec, 3
    v_cmp_gt_u32 vcc, v17, v4
    s_cbranch_vccz Lfsok_52
    s_mov_b32 s40, 0
Lfs_51:
    s_mov_b64 exec, 15
    global_load_dword v4, v0, s[26:27] sc1
    s_add_u32 s40, s40, 1
    s_cmp_gt_u32 s40, 262144
    s_cbranch_scc1 Lto_45
    s_waitcnt vmcnt(0)
    s_mov_b64 exec, 3
    v_cmp_gt_u32 vcc, v17, v4
    s_cbranch_vccnz Lfs_51
Lfsok_52:
    s_mov_b64 exec, 3
    v_add_u32 v17, 1, v17
    v_min_u32 v17, 64, v17
    s_mov_b64 exec, -1
    s_mov_b32 m0, s46
    s_nop 0
    global_load_lds_dwordx4 v0, s[18:19] sc1
    global_load_lds_dwordx4 v0, s[18:19] offset:1024 sc1
    s_add_u32 s18, s18, 262144
    s_addc_u32 s19, s19, 0
    s_waitcnt vmcnt(0)
    s_barrier
Lstep_46:
    v_mov_b32 v20, 0
    v_mov_b32 v21, 0
    v_mov_b32 v22, 0
    v_mov_b32 v23, 0
    v_mov_b32 v24, 0
    v_mov_b32 v25, 0
    v_mov_b32 v26, 0
    v_mov_b32 v27, 0
    v_mov_b32 v28, 0
    v_mov_b32 v29, 0
    v_mov_b32 v30, 0
    v_mov_b32 v31, 0
    s_cmp_eq_u32 s45, 0
    s_cbranch_scc1 Lnk_53
    s_mov_b64 exec, 3
    v_cmp_gt_u32 vcc, v17, v4
    s_cbranch_vccz Lfsok_55
    s_mov_b32 s40, 0
Lfs_54:
    s_mov_b64 exec, 15
    global_load_dword v4, v0, s[26:27] sc1
    s_add_u32 s40, s40, 1
    s_cmp_gt_u32 s40, 262144
    s_cbranch_scc1 Lto_45
    s_waitcnt vmcnt(0)
    s_mov_b64 exec, 3
    v_cmp_gt_u32 vcc, v17, v4
    s_cbranch_vccnz Lfs_54
Lfsok_55:
    s_mov_b64 exec, 3
    v_add_u32 v17, 1, v17
    v_min_u32 v17, 64, v17
    s_mov_b64 exec, -1
    s_mov_b32 m0, s46
    s_nop 0
    global_load_lds_dwordx4 v0, s[18:19] sc1
    global_load_lds_dwordx4 v0, s[18:19] offset:1024 sc1
    s_add_u32 s18, s18, 262144
    s_addc_u32 s19, s19, 0
    s_waitcnt vmcnt(0)
    s_mov_b32 s45, 0
Lnk_53:
    s_mov_b64 exec, 12
    v_cmp_gt_u32 vcc, v17, v4
    s_cbranch_vccz Lfsok_57
    s_mov_b32 s40, 0
Lfs_56:
    s_mov_b64 exec, 15
    global_load_dword v4, v0, s[26:27] sc1
    s_add_u32 s40, s40, 1
    s_cmp_gt_u32 s40, 262144
    s_cbranch_scc1 Lto_45
    s_waitcnt vmcnt(0)
    s_mov_b64 exec, 12
    v_cmp_gt_u32 vcc, v17, v4
    s_cbranch_vccnz Lfs_56
Lfsok_57:
    s_mov_b64 exec, 12
    v_add_u32 v17, 1, v17
    v_min_u32 v17, 64, v17
    s_mov_b64 exec, -1
    s_mov_b64 exec, 3
    v_cmp_gt_u32 vcc, v17, v4
    s_mov_b64 exec, -1
    s_cmp_eq_u64 vcc, 0
    s_cselect_b32 s44, 1, 0
    s_mov_b32 m0, s47
    s_waitcnt vmcnt(0)
    s_mov_b32 s40, 0
LpollB_58:
    global_load_dwordx4 v[32:35], v0, s[10:11] sc1
    global_load_dwordx4 v[36:39], v0, s[10:11] offset:1024 sc1
    s_add_u32 s40, s40, 1
    s_cmp_gt_u32 s40, 262144
    s_cbranch_scc1 Lto_45
    s_waitcnt vmcnt(0)
    ds_write_b128 v1, v[32:35]
    ds_write_b128 v1, v[36:39] offset:1056
    v_max3_u32 v40, v32, v33, v34
    v_max3_u32 v41, v35, v36, v37
    v_max3_u32 v40, v40, v38, v39
    v_max_u32 v40, v40, v41
    v_cmp_eq_u32 vcc, -1, v40
    s_cbranch_vccnz LpollB_58
    s_cmp_lg_u32 s5, 0
    s_cbranch_scc1 Lskf_59
    v_mov_b32 v4, s7
    s_mov_b64 exec, 1
    global_store_dword v0, v4, s[48:49] sc1
    s_mov_b64 exec, -1
Lskf_59:
    global_load_lds_dwordx4 v0, s[20:21] sc1
    global_load_lds_dwordx4 v0, s[20:21] offset:1024 sc1
    s_waitcnt lgkmcnt(0)
    s_barrier
    ds_read_b128 v[32:35], v2 offset:0
    ds_read_b128 v[36:39], v2 offset:64
    ds_read_b128 v[40:43], v2 offset:128
    ds_read_b128 v[44:47], v2 offset:192
    ds_read_b128 v[48:51], v2 offset:256
    ds_read_b128 v[52:55], v2 offset:320
    ds_read_b128 v[56:59], v2 offset:384
    ds_read_b128 v[60:63], v2 offset:448
    s_waitcnt lgkmcnt(7)
    v_smfmac_f32_16x16x64_bf16 v[20:23], v[32:35], a[0:7], v18
    ds_read_b128 v[64:67], v2 offset:512
    v_smfmac_f32_16x16x64_bf16 v[24:27], v[32:35], a[128:135], v18
    s_waitcnt lgkmcnt(7)
    v_smfmac_f32_16x16x64_bf16 v[20:23], v[36:39], a[8:15], v18
    ds_read_b128 v[68:71], v2 offset:576
    v_smfmac_f32_16x16x64_bf16 v[24:27], v[36:39], a[136:143], v18
    s_waitcnt lgkmcnt(7)
    v_smfmac_f32_16x16x64_bf16 v[20:23], v[40:43], a[16:23], v18
    ds_read_b128 v[72:75], v2 offset:640
    v_smfmac_f32_16x16x64_bf16 v[24:27], v[40:43], a[144:151], v18
    s_waitcnt lgkmcnt(7)
    v_smfmac_f32_16x16x64_bf16 v[20:23], v[44:47], a[24:31], v18
    ds_read_b128 v[76:79], v2 offset:704
    v_smfmac_f32_16x16x64_bf16 v[24:27], v[44:47], a[152:159], v18
    s_waitcnt lgkmcnt(7)
    v_smfmac_f32_16x16x64_bf16 v[20:23], v[48:51], a[32:39], v18
    ds_read_b128 v[80:83], v2 offset:768
    v_smfmac_f32_16x16x64_bf16 v[24:27], v[48:51], a[160:167], v18
    s_waitcnt lgkmcnt(7)
    v_smfmac_f32_16x16x64_bf16 v[20:23], v[52:55], a[40:47], v18
    ds_read_b128 v[84:87], v2 offset:832
    v_smfmac_f32_16x16x64_bf16 v[24:27], v[52:55], a[168:175], v18
    s_waitcnt lgkmcnt(7)
    v_smfmac_f32_16x16x64_bf16 v[20:23], v[56:59], a[48:55], v18
    ds_read_b128 v[88:91], v2 offset:896
    v_smfmac_f32_16x16x64_bf16 v[24:27], v[56:59], a[176:183], v18
    s_waitcnt lgkmcnt(7)
    v_smfmac_f32_16x16x64_bf16 v[20:23], v[60:63], a[56:63], v18
    ds_read_b128 v[92:95], v2 offset:960
    v_smfmac_f32_16x16x64_bf16 v[24:27], v[60:63], a[184:191], v18
    s_waitcnt lgkmcnt(7)
    v_smfmac_f32_16x16x64_bf16 v[20:23], v[64:67], a[64:71], v18
    ds_read_b128 v[96:99], v7 offset:0
    v_smfmac_f32_16x16x64_bf16 v[24:27], v[64:67], a[192:199], v18
    s_mov_b64 exec, 15
    global_load_dword v4, v0, s[26:27] sc1
    s_mov_b64 exec, -1
    s_waitcnt lgkmcnt(7)
    v_smfmac_f32_16x16x64_bf16 v[20:23], v[68:71], a[72:79], v18
    ds_read_b128 v[100:103], v7 offset:2048
    v_smfmac_f32_16x16x64_bf16 v[24:27], v[68:71], a[200:207], v18
    s_add_u32 s20, s20, 262144
    s_addc_u32 s21, s21, 0
    s_waitcnt lgkmcnt(7)
    v_smfmac_f32_16x16x64_bf16 v[20:23], v[72:75], a[80:87], v18
    ds_read_b128 v[104:107], v7 offset:4096
    v_smfmac_f32_16x16x64_bf16 v[24:27], v[72:75], a[208:215], v18
    s_waitcnt lgkmcnt(7)
    v_smfmac_f32_16x16x64_bf16 v[20:23], v[76:79], a[88:95], v18
    ds_read_b128 v[108:111], v7 offset:6144
    v_smfmac_f32_16x16x64_bf16 v[24:27], v[76:79], a[216:223], v18
    s_waitcnt lgkmcnt(7)
    v_smfmac_f32_16x16x64_bf16 v[20:23], v[80:83], a[96:103], v18
    ds_read_b128 v[112:115], v7 offset:256
    v_smfmac_f32_16x16x64_bf16 v[24:27], v[80:83], a[224:231], v18
    s_waitcnt lgkmcnt(7)
    v_smfmac_f32_16x16x64_bf16 v[20:23], v[84:87], a[104:111], v18
    ds_read_b128 v[116:119], v7 offset:2304
    v_smfmac_f32_16x16x64_bf16 v[24:27], v[84:87], a[232:239], v18
    s_waitcnt lgkmcnt(7)
    v_smfmac_f32_16x16x64_bf16 v[20:23], v[88:91], a[112:119], v18
    ds_read_b128 v[120:123], v7 offset:4352
    v_smfmac_f32_16x16x64_bf16 v[24:27], v[88:91], a[240:247], v18
    s_waitcnt lgkmcnt(7)
    v_smfmac_f32_16x16x64_bf16 v[20:23], v[92:95], a[120:127], v18
    ds_read_b128 v[124:127], v7 offset:6400
    v_smfmac_f32_16x16x64_bf16 v[24:27], v[92:95], a[248:255], v18
    v_smfmac_f32_16x16x64_bf16 v[28:31], v[32:35], v[128:135], v18
    v_smfmac_f32_16x16x64_bf16 v[28:31], v[36:39], v[136:143], v18
    v_cvt_pk_bf16_f32 v20, v20, v21
    v_cvt_pk_bf16_f32 v21, v22, v23
    v_xor_b32 v22, 16, v3
    v_cvt_pk_bf16_f32 v24, v24, v25
    v_cvt_pk_bf16_f32 v25, v26, v27
    ds_write_b64 v3, v[20:21]
    ds_write_b64 v22, v[24:25]
    global_store_dwordx2 v16, v[24:25], s[22:23] sc1
    v_smfmac_f32_16x16x64_bf16 v[28:31], v[40:43], v[144:151], v18
    v_smfmac_f32_16x16x64_bf16 v[28:31], v[44:47], v[152:159], v18
    v_smfmac_f32_16x16x64_bf16 v[28:31], v[48:51], v[160:167], v18
    v_smfmac_f32_16x16x64_bf16 v[28:31], v[52:55], v[168:175], v18
    s_waitcnt lgkmcnt(0)
    s_barrier
    ds_read_b64_tr_b16 v[32:33], v5 offset:0
    ds_read_b64_tr_b16 v[34:35], v6 offset:0
    ds_read_b64_tr_b16 v[36:37], v5 offset:1024
    ds_read_b64_tr_b16 v[38:39], v6 offset:1024
    ds_read_b64_tr_b16 v[40:41], v5 offset:2048
    ds_read_b64_tr_b16 v[42:43], v6 offset:2048
    ds_read_b64_tr_b16 v[44:45], v5 offset:3072
    ds_read_b64_tr_b16 v[46:47], v6 offset:3072
    v_smfmac_f32_16x16x64_bf16 v[28:31], v[56:59], v[176:183], v18
    s_mov_b32 m0, s46
    s_nop 0
    global_load_lds_dwordx4 v0, s[18:19] sc1
    v_smfmac_f32_16x16x64_bf16 v[28:31], v[60:63], v[184:191], v18
    global_load_lds_dwordx4 v0, s[18:19] offset:1024 sc1
    v_smfmac_f32_16x16x64_bf16 v[28:31], v[64:67], v[192:199], v18
    s_cmp_eq_u32 s44, 0
    s_cbranch_scc1 Lks_61
    s_add_u32 s18, s18, 262144
    s_addc_u32 s19, s19, 0
    s_mov_b64 exec, 3
    v_add_u32 v17, 1, v17
    v_min_u32 v17, 64, v17
    s_mov_b64 exec, -1
    s_branch Lkd_62
Lks_61:
    s_mov_b32 s45, 1
Lkd_62:
    v_smfmac_f32_16x16x64_bf16 v[28:31], v[68:71], v[200:207], v18
    v_mov_b32 v64, 0x3f803f80
    v_mov_b32 v65, 0x3f803f80
    v_mov_b32 v66, 0x3f803f80
    v_mov_b32 v67, 0x3f803f80
    s_waitcnt lgkmcnt(6)
    v_mfma_f32_16x16x32_bf16 v[52:55], v[96:99], v[32:35], 0
    v_mfma_f32_16x16x32_bf16 v[56:59], v[112:115], v[32:35], 0
    v_mfma_f32_16x16x32_bf16 v[48:51], v[32:35], v[32:35], 0
    s_waitcnt lgkmcnt(4)
    v_mfma_f32_16x16x32_bf16 v[52:55], v[100:103], v[36:39], v[52:55]
    v_mfma_f32_16x16x32_bf16 v[56:59], v[116:119], v[36:39], v[56:59]
    v_mfma_f32_16x16x32_bf16 v[48:51], v[36:39], v[36:39], v[48:51]
    ds_read_b128 v[96:99], v11 offset:0
    ds_read_b128 v[100:103], v11 offset:1024
    ds_read_b128 v[112:115], v11 offset:2048
    ds_read_b128 v[116:119], v11 offset:3072
    s_waitcnt lgkmcnt(6)
    v_mfma_f32_16x16x32_bf16 v[52:55], v[104:107], v[40:43], v[52:55]
    v_mfma_f32_16x16x32_bf16 v[56:59], v[120:123], v[40:43], v[56:59]
    v_mfma_f32_16x16x32_bf16 v[48:51], v[40:43], v[40:43], v[48:51]
    s_waitcnt lgkmcnt(4)
    v_mfma_f32_16x16x32_bf16 v[52:55], v[108:111], v[44:47], v[52:55]
    v_mfma_f32_16x16x32_bf16 v[56:59], v[124:127], v[44:47], v[56:59]
    v_mfma_f32_16x16x32_bf16 v[48:51], v[44:47], v[44:47], v[48:51]
    v_smfmac_f32_16x16x64_bf16 v[28:31], v[72:75], v[208:215], v18
    v_smfmac_f32_16x16x64_bf16 v[28:31], v[76:79], v[216:223], v18
    v_max3_f32 v60, v52, v53, v54
    s_waitcnt vmcnt(4)
    v_max3_f32 v62, v55, v56, v57
    v_max3_f32 v61, v48, v49, v50
    v_max3_f32 v60, v60, v58, v59
    v_max_f32 v61, v61, v51
    ds_read_b128 v[20:23], v8 offset:0
    v_add_f32 v61, v61, v19
    v_max3_f32 v60, v60, v62, v61
    ds_read_b128 v[24:27], v8 offset:256
    v_mov_b32 v61, v60
    v_smfmac_f32_16x16x64_bf16 v[28:31], v[80:83], v[224:231], v18
    ds_read_b128 v[104:107], v11 offset:32768
    v_permlane32_swap_b32 v60, v61
    v_max_f32 v60, v60, v61
    v_mov_b32 v61, v60
    v_smfmac_f32_16x16x64_bf16 v[28:31], v[84:87], v[232:239], v18
    ds_read_b128 v[108:111], v11 offset:33792
    v_permlane16_swap_b32 v60, v61
    v_max_f32 v60, v60, v61
    v_mul_f32 v62, -v60, s36
    v_smfmac_f32_16x16x64_bf16 v[28:31], v[88:91], v[240:247], v18
    v_add_f32 v63, v62, v19
    v_fma_f32 v52, v52, s36, v62
    v_fma_f32 v53, v53, s36, v62
    v_fma_f32 v54, v54, s36, v62
    v_fma_f32 v55, v55, s36, v62
    v_smfmac_f32_16x16x64_bf16 v[28:31], v[92:95], v[248:255], v18
    v_exp_f32 v52, v52
    v_exp_f32 v53, v53
    v_exp_f32 v54, v54
    v_exp_f32 v55, v55
    v_fma_f32 v56, v56, s36, v62
    v_fma_f32 v57, v57, s36, v62
    v_fma_f32 v58, v58, s36, v62
    v_fma_f32 v59, v59, s36, v62
    v_exp_f32 v56, v56
    v_exp_f32 v57, v57
    v_exp_f32 v58, v58
    v_exp_f32 v59, v59
    v_fma_f32 v48, v48, s36, v63
    v_fma_f32 v49, v49, s36, v63
    v_fma_f32 v50, v50, s36, v63
    v_fma_f32 v51, v51, s36, v63
    v_cvt_pk_bf16_f32 v32, v52, v53
    v_cvt_pk_bf16_f32 v33, v54, v55
    v_exp_f32 v48, v48
    v_exp_f32 v49, v49
    v_exp_f32 v50, v50
    v_exp_f32 v51, v51
    v_cvt_pk_bf16_f32 v34, v56, v57
    v_cvt_pk_bf16_f32 v35, v58, v59
    v_cvt_pk_bf16_f32 v36, v48, v49
    v_cvt_pk_bf16_f32 v37, v50, v51
    s_waitcnt lgkmcnt(2)
    v_mfma_f32_16x16x32_bf16 v[68:71], v[64:67], v[32:35], 0
    v_cvt_pk_bf16_f32 v28, v28, v29
    v_mfma_f32_16x16x32_bf16 v[44:47], v[24:27], v[32:35], 0
    v_cvt_pk_bf16_f32 v29, v30, v31
    v_mfma_f32_16x16x32_bf16 v[40:43], v[20:23], v[32:35], 0
    v_mov_b32 v38, 0
    v_mov_b32 v39, 0
    v_mfma_f32_16x16x16_bf16 v[68:71], v[64:65], v[36:37], v[68:71]
    ds_read_b128 v[120:123], v11 offset:34816
    v_mfma_f32_16x16x16_bf16 v[44:47], v[28:29], v[36:37], v[44:47]
    v_permlane32_swap_b32 v36, v38
    v_permlane32_swap_b32 v37, v39
    ds_read_b128 v[124:127], v11 offset:35840
    ds_read_b128 v[72:75], v15 offset:0
    v_mfma_f32_16x16x16_bf16 v[40:43], v[28:29], v[38:39], v[40:43]
    ds_read_b128 v[76:79], v15 offset:1024
    v_rcp_f32 v60, v68
    ds_read_b128 v[80:83], v15 offset:2048
    ds_read_b128 v[84:87], v15 offset:3072
    ds_read_b128 v[88:91], v15 offset:32768
    ds_read_b128 v[92:95], v15 offset:33792
    s_nop 1
    v_pk_mul_f32 v[40:41], v[40:41], v[60:61] op_sel_hi:[1,0]
    v_pk_mul_f32 v[42:43], v[42:43], v[60:61] op_sel_hi:[1,0]
    v_pk_mul_f32 v[44:45], v[44:45], v[60:61] op_sel_hi:[1,0]
    v_pk_mul_f32 v[46:47], v[46:47], v[60:61] op_sel_hi:[1,0]
    v_cvt_pk_bf16_f32 v40, v40, v41
    v_cvt_pk_bf16_f32 v41, v42, v43
    v_cvt_pk_bf16_f32 v44, v44, v45
    v_cvt_pk_bf16_f32 v45, v46, v47
    s_mov_b64 exec, s[28:29]
    s_waitcnt lgkmcnt(8)
    ds_write_b64 v9, v[40:41]
    ds_write_b64 v9, v[44:45] offset:32
    s_mov_b64 exec, -1
    global_store_dwordx2 v16, v[28:29], s[24:25] sc1
    ds_read_b128 v[64:67], v15 offset:34816
    ds_read_b128 v[68:71], v15 offset:35840
    v_mov_b32 v32, 0
    v_mov_b32 v33, 0
    v_mov_b32 v34, 0
    v_mov_b32 v35, 0
    v_mov_b32 v36, 0
    v_mov_b32 v37, 0
    v_mov_b32 v38, 0
    v_mov_b32 v39, 0
    s_waitcnt lgkmcnt(2)
    s_barrier
    ds_read_b128 v[48:51], v10 offset:0
    ds_read_b128 v[52:55], v10 offset:64
    ds_read_b128 v[56:59], v10 offset:128
    ds_read_b128 v[60:63], v10 offset:192
    v_mov_b32 v40, 0
    v_mov_b32 v41, 0
    v_mov_b32 v42, 0
    v_mov_b32 v43, 0
    v_mov_b32 v44, 0
    v_mov_b32 v45, 0
    v_mov_b32 v46, 0
    v_mov_b32 v47, 0
    s_waitcnt lgkmcnt(3)
    v_smfmac_f32_16x16x64_bf16 v[32:35], v[48:51], v[96:103], v18
    ds_read_b128 v[96:99], v11 offset:4096
    ds_read_b128 v[100:103], v11 offset:5120
    v_smfmac_f32_16x16x64_bf16 v[36:39], v[48:51], v[112:119], v18
    ds_read_b128 v[112:115], v11 offset:6144
    ds_read_b128 v[116:119], v11 offset:7168
    s_waitcnt lgkmcnt(6)
    v_smfmac_f32_16x16x64_bf16 v[32:35], v[52:55], v[104:111], v18
    ds_read_b128 v[104:107], v11 offset:36864
    ds_read_b128 v[108:111], v11 offset:37888
    v_smfmac_f32_16x16x64_bf16 v[36:39], v[52:55], v[120:127], v18
    ds_read_b128 v[120:123], v11 offset:38912
    ds_read_b128 v[124:127], v11 offset:39936
    s_waitcnt lgkmcnt(9)
    v_smfmac_f32_16x16x64_bf16 v[32:35], v[56:59], v[72:79], v18
    ds_read_b128 v[72:75], v15 offset:4096
    ds_read_b128 v[76:79], v15 offset:5120
    v_smfmac_f32_16x16x64_bf16 v[36:39], v[56:59], v[80:87], v18
    ds_read_b128 v[80:83], v15 offset:6144
    ds_read_b128 v[84:87], v15 offset:7168
    s_waitcnt lgkmcnt(12)
    v_smfmac_f32_16x16x64_bf16 v[32:35], v[60:63], v[88:95], v18
    ds_read_b128 v[88:91], v15 offset:36864
    ds_read_b128 v[92:95], v15 offset:37888
    v_smfmac_f32_16x16x64_bf16 v[36:39], v[60:63], v[64:71], v18
    s_waitcnt lgkmcnt(13)
    ds_read_b128 v[64:67], v15 offset:38912
    ds_read_b128 v[68:71], v15 offset:39936
    s_waitcnt lgkmcnt(14)
    v_smfmac_f32_16x16x64_bf16 v[40:43], v[48:51], v[96:103], v18
    s_waitcnt lgkmcnt(12)
    v_smfmac_f32_16x16x64_bf16 v[44:47], v[48:51], v[112:119], v18
    s_waitcnt lgkmcnt(10)
    v_smfmac_f32_16x16x64_bf16 v[40:43], v[52:55], v[104:111], v18
    s_waitcnt lgkmcnt(8)
    v_smfmac_f32_16x16x64_bf16 v[44:47], v[52:55], v[120:127], v18
    v_cvt_pk_bf16_f32 v32, v32, v33
    v_cvt_pk_bf16_f32 v33, v34, v35
    v_cvt_pk_bf16_f32 v34, v36, v37
    v_cvt_pk_bf16_f32 v35, v38, v39
    v_and_b32 v32, -2, v32
    v_and_b32 v33, -2, v33
    v_and_b32 v34, -2, v34
    v_and_b32 v35, -2, v35
    global_store_dwordx4 v12, v[32:35], s[14:15] offset:0 sc1
    s_waitcnt lgkmcnt(6)
    v_smfmac_f32_16x16x64_bf16 v[40:43], v[56:59], v[72:79], v18
    s_waitcnt lgkmcnt(4)
    v_smfmac_f32_16x16x64_bf16 v[44:47], v[56:59], v[80:87], v18
    s_waitcnt lgkmcnt(2)
    v_smfmac_f32_16x16x64_bf16 v[40:43], v[60:63], v[88:95], v18
    s_waitcnt lgkmcnt(0)
    v_smfmac_f32_16x16x64_bf16 v[44:47], v[60:63], v[64:71], v18
    s_add_u32 s22, s22, 65536
    s_addc_u32 s23, s23, 0
    s_add_u32 s24, s24, 65536
    s_addc_u32 s25, s25, 0
    s_ashr_i32 s37, s52, 31
    s_nop 1
    v_cvt_pk_bf16_f32 v40, v40, v41
    v_cvt_pk_bf16_f32 v41, v42, v43
    v_cvt_pk_bf16_f32 v42, v44, v45
    v_cvt_pk_bf16_f32 v43, v46, v47
    v_and_b32 v40, -2, v40
    v_and_b32 v41, -2, v41
    v_and_b32 v42, -2, v42
    v_and_b32 v43, -2, v43
    global_store_dwordx4 v12, v[40:43], s[14:15] offset:1024 sc1
    s_add_u32 s10, s10, s52
    s_addc_u32 s11, s11, s37
    v_mov_b32 v96, 0
    v_mov_b32 v97, 0
    v_mov_b32 v98, 0
    v_mov_b32 v99, 0
    s_mov_b32 s42, 0x10001
    s_mov_b32 s43, 0x10001
    s_mov_b64 exec, s[42:43]
    v_mov_b32 v96, 0x00003f80
    s_lshl_b64 exec, exec, 1
    v_mov_b32 v96, 0x3f800000
    s_mov_b32 s42, 0x40004
    s_mov_b32 s43, 0x40004
    s_mov_b64 exec, s[42:43]
    v_mov_b32 v97, 0x00003f80
    s_lshl_b64 exec, exec, 1
    v_mov_b32 v97, 0x3f800000
    s_mov_b32 s42, 0x100010
    s_mov_b32 s43, 0x100010
    s_mov_b64 exec, s[42:43]
    v_mov_b32 v98, 0x00003f80
    s_lshl_b64 exec, exec, 1
    v_mov_b32 v98, 0x3f800000
    s_mov_b32 s42, 0x400040
    s_mov_b32 s43, 0x400040
    s_mov_b64 exec, s[42:43]
    v_mov_b32 v99, 0x00003f80
    s_lshl_b64 exec, exec, 1
    v_mov_b32 v99, 0x3f800000
    s_mov_b64 exec, -1
    s_waitcnt vmcnt(0)
    s_mov_b32 s40, 0
LpollA_63:
    global_load_dwordx4 v[48:51], v13, s[14:15] sc1
    global_load_dwordx4 v[52:55], v13, s[16:17] sc1
    s_add_u32 s40, s40, 1
    s_cmp_gt_u32 s40, 262144
    s_cbranch_scc1 Lto_45
    s_waitcnt vmcnt(0)
    v_or3_b32 v68, v48, v49, v50
    v_or3_b32 v69, v51, v52, v53
    v_or3_b32 v68, v68, v54, v55
    v_or_b32 v68, v68, v69
    v_and_b32 v68, 1, v68
    v_cmp_ne_u32 vcc, 0, v68
    s_cbranch_vccnz LpollA_63
    v_mfma_f32_16x16x32_bf16 v[56:59], v[96:99], v[48:51], 0
    v_mfma_f32_16x16x32_bf16 v[56:59], v[96:99], v[52:55], v[56:59]
    s_sub_u32 s52, 0, s52
    s_nop 6
    v_add_f32_dpp v56, v56, v56 row_ror:8 row_mask:0xf bank_mask:0xf
    v_add_f32_dpp v57, v57, v57 row_ror:8 row_mask:0xf bank_mask:0xf
    v_add_f32_dpp v58, v58, v58 row_ror:8 row_mask:0xf bank_mask:0xf
    v_add_f32_dpp v59, v59, v59 row_ror:8 row_mask:0xf bank_mask:0xf
    v_add_f32_dpp v56, v56, v56 row_ror:4 row_mask:0xf bank_mask:0xf
    v_add_f32_dpp v57, v57, v57 row_ror:4 row_mask:0xf bank_mask:0xf
    v_add_f32_dpp v58, v58, v58 row_ror:4 row_mask:0xf bank_mask:0xf
    v_add_f32_dpp v59, v59, v59 row_ror:4 row_mask:0xf bank_mask:0xf
    v_cndmask_b32 v56, v56, v57, s[34:35]
    v_cndmask_b32 v58, v58, v59, s[34:35]
    v_cndmask_b32 v56, v56, v58, s[32:33]
    s_nop 1
    v_mov_b32_dpp v57, v56 quad_perm:[1,0,3,2] row_mask:0xf bank_mask:0xf
    v_cvt_pk_bf16_f32 v56, v56, v57
    v_min_u32 v56, 0xfffffffe, v56
    s_mov_b64 exec, s[30:31]
    global_store_dword v14, v56, s[12:13] sc1
    s_ashr_i32 s37, s52, 31
    s_add_u32 s12, s12, s52
    s_addc_u32 s13, s13, s37
    v_mov_b32 v57, -1
    global_store_dword v14, v57, s[12:13] sc1
    s_mov_b64 exec, -1
    s_add_u32 s7, s7, 1
    v_mov_b32 v20, 0
    v_mov_b32 v21, 0
    v_mov_b32 v22, 0
    v_mov_b32 v23, 0
    v_mov_b32 v24, 0
    v_mov_b32 v25, 0
    v_mov_b32 v26, 0
    v_mov_b32 v27, 0
    v_mov_b32 v28, 0
    v_mov_b32 v29, 0
    v_mov_b32 v30, 0
    v_mov_b32 v31, 0
    s_cmp_eq_u32 s45, 0
    s_cbranch_scc1 Lnk_64
    s_mov_b64 exec, 3
    v_cmp_gt_u32 vcc, v17, v4
    s_cbranch_vccz Lfsok_66
    s_mov_b32 s40, 0
Lfs_65:
    s_mov_b64 exec, 15
    global_load_dword v4, v0, s[26:27] sc1
    s_add_u32 s40, s40, 1
    s_cmp_gt_u32 s40, 262144
    s_cbranch_scc1 Lto_45
    s_waitcnt vmcnt(0)
    s_mov_b64 exec, 3
    v_cmp_gt_u32 vcc, v17, v4
    s_cbranch_vccnz Lfs_65
Lfsok_66:
    s_mov_b64 exec, 3
    v_add_u32 v17, 1, v17
    v_min_u32 v17, 64, v17
    s_mov_b64 exec, -1
    s_mov_b32 m0, s46
    s_nop 0
    global_load_lds_dwordx4 v0, s[18:19] sc1
    global_load_lds_dwordx4 v0, s[18:19] offset:1024 sc1
    s_add_u32 s18, s18, 262144
    s_addc_u32 s19, s19, 0
    s_waitcnt vmcnt(0)
    s_mov_b32 s45, 0
Lnk_64:
    s_mov_b64 exec, 12
    v_cmp_gt_u32 vcc, v17, v4
    s_cbranch_vccz Lfsok_68
    s_mov_b32 s40, 0
Lfs_67:
    s_mov_b64 exec, 15
    global_load_dword v4, v0, s[26:27] sc1
    s_add_u32 s40, s40, 1
    s_cmp_gt_u32 s40, 262144
    s_cbranch_scc1 Lto_45
    s_waitcnt vmcnt(0)
    s_mov_b64 exec, 12
    v_cmp_gt_u32 vcc, v17, v4
    s_cbranch_vccnz Lfs_67
Lfsok_68:
    s_mov_b64 exec, 12
    v_add_u32 v17, 1, v17
    v_min_u32 v17, 64, v17
    s_mov_b64 exec, -1
    s_mov_b64 exec, 3
    v_cmp_gt_u32 vcc, v17, v4
    s_mov_b64 exec, -1
    s_cmp_eq_u64 vcc, 0
    s_cselect_b32 s44, 1, 0
    s_mov_b32 m0, s47
    s_waitcnt vmcnt(0)
    s_mov_b32 s40, 0
LpollB_69:
    global_load_dwordx4 v[32:35], v0, s[10:11] sc1
    global_load_dwordx4 v[36:39], v0, s[10:11] offset:1024 sc1
    s_add_u32 s40, s40, 1
    s_cmp_gt_u32 s40, 262144
    s_cbranch_scc1 Lto_45
    s_waitcnt vmcnt(0)
    ds_write_b128 v1, v[32:35]
    ds_write_b128 v1, v[36:39] offset:1056
    v_max3_u32 v40, v32, v33, v34
    v_max3_u32 v41, v35, v36, v37
    v_max3_u32 v40, v40, v38, v39
    v_max_u32 v40, v40, v41
    v_cmp_eq_u32 vcc, -1, v40
    s_cbranch_vccnz LpollB_69
    s_cmp_lg_u32 s5, 0
    s_cbranch_scc1 Lskf_70
    v_mov_b32 v4, s7
    s_mov_b64 exec, 1
    global_store_dword v0, v4, s[48:49] sc1
    s_mov_b64 exec, -1
Lskf_70:
    global_load_lds_dwordx4 v0, s[20:21] sc1
    global_load_lds_dwordx4 v0, s[20:21] offset:1024 sc1
    s_waitcnt lgkmcnt(0)
    s_barrier
    ds_read_b128 v[32:35], v2 offset:0
    ds_read_b128 v[36:39], v2 offset:64
    ds_read_b128 v[40:43], v2 offset:128
    ds_read_b128 v[44:47], v2 offset:192
    ds_read_b128 v[48:51], v2 offset:256
    ds_read_b128 v[52:55], v2 offset:320
    ds_read_b128 v[56:59], v2 offset:384
    ds_read_b128 v[60:63], v2 offset:448
    s_waitcnt lgkmcnt(7)
    v_smfmac_f32_16x16x64_bf16 v[20:23], v[32:35], a[0:7], v18
    ds_read_b128 v[64:67], v2 offset:512
    v_smfmac_f32_16x16x64_bf16 v[24:27], v[32:35], a[128:135], v18
    s_waitcnt lgkmcnt(7)
    v_smfmac_f32_16x16x64_bf16 v[20:23], v[36:39], a[8:15], v18
    ds_read_b128 v[68:71], v2 offset:576
    v_smfmac_f32_16x16x64_bf16 v[24:27], v[36:39], a[136:143], v18
    s_waitcnt lgkmcnt(7)
    v_smfmac_f32_16x16x64_bf16 v[20:23], v[40:43], a[16:23], v18
    ds_read_b128 v[72:75], v2 offset:640
    v_smfmac_f32_16x16x64_bf16 v[24:27], v[40:43], a[144:151], v18
    s_waitcnt lgkmcnt(7)
    v_smfmac_f32_16x16x64_bf16 v[20:23], v[44:47], a[24:31], v18
    ds_read_b128 v[76:79], v2 offset:704
    v_smfmac_f32_16x16x64_bf16 v[24:27], v[44:47], a[152:159], v18
    s_waitcnt lgkmcnt(7)
    v_smfmac_f32_16x16x64_bf16 v[20:23], v[48:51], a[32:39], v18
    ds_read_b128 v[80:83], v2 offset:768
    v_smfmac_f32_16x16x64_bf16 v[24:27], v[48:51], a[160:167], v18
    s_waitcnt lgkmcnt(7)
    v_smfmac_f32_16x16x64_bf16 v[20:23], v[52:55], a[40:47], v18
    ds_read_b128 v[84:87], v2 offset:832
    v_smfmac_f32_16x16x64_bf16 v[24:27], v[52:55], a[168:175], v18
    s_waitcnt lgkmcnt(7)
    v_smfmac_f32_16x16x64_bf16 v[20:23], v[56:59], a[48:55], v18
    ds_read_b128 v[88:91], v2 offset:896
    v_smfmac_f32_16x16x64_bf16 v[24:27], v[56:59], a[176:183], v18
    s_waitcnt lgkmcnt(7)
    v_smfmac_f32_16x16x64_bf16 v[20:23], v[60:63], a[56:63], v18
    ds_read_b128 v[92:95], v2 offset:960
    v_smfmac_f32_16x16x64_bf16 v[24:27], v[60:63], a[184:191], v18
    s_waitcnt lgkmcnt(7)
    v_smfmac_f32_16x16x64_bf16 v[20:23], v[64:67], a[64:71], v18
    ds_read_b128 v[96:99], v7 offset:0
    v_smfmac_f32_16x16x64_bf16 v[24:27], v[64:67], a[192:199], v18
    s_mov_b64 exec, 15
    global_load_dword v4, v0, s[26:27] sc1
    s_mov_b64 exec, -1
    s_waitcnt lgkmcnt(7)
    v_smfmac_f32_16x16x64_bf16 v[20:23], v[68:71], a[72:79], v18
    ds_read_b128 v[100:103], v7 offset:2048
    v_smfmac_f32_16x16x64_bf16 v[24:27], v[68:71], a[200:207], v18
    s_add_u32 s20, s20, 262144
    s_addc_u32 s21, s21, 0
    s_waitcnt lgkmcnt(7)
    v_smfmac_f32_16x16x64_bf16 v[20:23], v[72:75], a[80:87], v18
    ds_read_b128 v[104:107], v7 offset:4096
    v_smfmac_f32_16x16x64_bf16 v[24:27], v[72:75], a[208:215], v18
    s_waitcnt lgkmcnt(7)
    v_smfmac_f32_16x16x64_bf16 v[20:23], v[76:79], a[88:95], v18
    ds_read_b128 v[108:111], v7 offset:6144
    v_smfmac_f32_16x16x64_bf16 v[24:27], v[76:79], a[216:223], v18
    s_waitcnt lgkmcnt(7)
    v_smfmac_f32_16x16x64_bf16 v[20:23], v[80:83], a[96:103], v18
    ds_read_b128 v[112:115], v7 offset:256
    v_smfmac_f32_16x16x64_bf16 v[24:27], v[80:83], a[224:231], v18
    s_waitcnt lgkmcnt(7)
    v_smfmac_f32_16x16x64_bf16 v[20:23], v[84:87], a[104:111], v18
    ds_read_b128 v[116:119], v7 offset:2304
    v_smfmac_f32_16x16x64_bf16 v[24:27], v[84:87], a[232:239], v18
    s_waitcnt lgkmcnt(7)
    v_smfmac_f32_16x16x64_bf16 v[20:23], v[88:91], a[112:119], v18
    ds_read_b128 v[120:123], v7 offset:4352
    v_smfmac_f32_16x16x64_bf16 v[24:27], v[88:91], a[240:247], v18
    s_waitcnt lgkmcnt(7)
    v_smfmac_f32_16x16x64_bf16 v[20:23], v[92:95], a[120:127], v18
    ds_read_b128 v[124:127], v7 offset:6400
    v_smfmac_f32_16x16x64_bf16 v[24:27], v[92:95], a[248:255], v18
    v_smfmac_f32_16x16x64_bf16 v[28:31], v[32:35], v[128:135], v18
    v_smfmac_f32_16x16x64_bf16 v[28:31], v[36:39], v[136:143], v18
    v_cvt_pk_bf16_f32 v20, v20, v21
    v_cvt_pk_bf16_f32 v21, v22, v23
    v_xor_b32 v22, 16, v3
    v_cvt_pk_bf16_f32 v24, v24, v25
    v_cvt_pk_bf16_f32 v25, v26, v27
    ds_write_b64 v3, v[20:21]
    ds_write_b64 v22, v[24:25]
    global_store_dwordx2 v16, v[24:25], s[22:23] sc1
    v_smfmac_f32_16x16x64_bf16 v[28:31], v[40:43], v[144:151], v18
    v_smfmac_f32_16x16x64_bf16 v[28:31], v[44:47], v[152:159], v18
    v_smfmac_f32_16x16x64_bf16 v[28:31], v[48:51], v[160:167], v18
    v_smfmac_f32_16x16x64_bf16 v[28:31], v[52:55], v[168:175], v18
    s_waitcnt lgkmcnt(0)
    s_barrier
    ds_read_b64_tr_b16 v[32:33], v5 offset:0
    ds_read_b64_tr_b16 v[34:35], v6 offset:0
    ds_read_b64_tr_b16 v[36:37], v5 offset:1024
    ds_read_b64_tr_b16 v[38:39], v6 offset:1024
    ds_read_b64_tr_b16 v[40:41], v5 offset:2048
    ds_read_b64_tr_b16 v[42:43], v6 offset:2048
    ds_read_b64_tr_b16 v[44:45], v5 offset:3072
    ds_read_b64_tr_b16 v[46:47], v6 offset:3072
    v_smfmac_f32_16x16x64_bf16 v[28:31], v[56:59], v[176:183], v18
    s_mov_b32 m0, s46
    s_nop 0
    global_load_lds_dwordx4 v0, s[18:19] sc1
    v_smfmac_f32_16x16x64_bf16 v[28:31], v[60:63], v[184:191], v18
    global_load_lds_dwordx4 v0, s[18:19] offset:1024 sc1
    v_smfmac_f32_16x16x64_bf16 v[28:31], v[64:67], v[192:199], v18
    s_cmp_eq_u32 s44, 0
    s_cbranch_scc1 Lks_72
    s_add_u32 s18, s18, 262144
    s_addc_u32 s19, s19, 0
    s_mov_b64 exec, 3
    v_add_u32 v17, 1, v17
    v_min_u32 v17, 64, v17
    s_mov_b64 exec, -1
    s_branch Lkd_73
Lks_72:
    s_mov_b32 s45, 1
Lkd_73:
    v_smfmac_f32_16x16x64_bf16 v[28:31], v[68:71], v[200:207], v18
    v_mov_b32 v64, 0x3f803f80
    v_mov_b32 v65, 0x3f803f80
    v_mov_b32 v66, 0x3f803f80
    v_mov_b32 v67, 0x3f803f80
    s_waitcnt lgkmcnt(6)
    v_mfma_f32_16x16x32_bf16 v[52:55], v[96:99], v[32:35], 0
    v_mfma_f32_16x16x32_bf16 v[56:59], v[112:115], v[32:35], 0
    v_mfma_f32_16x16x32_bf16 v[48:51], v[32:35], v[32:35], 0
    s_waitcnt lgkmcnt(4)
    v_mfma_f32_16x16x32_bf16 v[52:55], v[100:103], v[36:39], v[52:55]
    v_mfma_f32_16x16x32_bf16 v[56:59], v[116:119], v[36:39], v[56:59]
    v_mfma_f32_16x16x32_bf16 v[48:51], v[36:39], v[36:39], v[48:51]
    ds_read_b128 v[96:99], v11 offset:0
    ds_read_b128 v[100:103], v11 offset:1024
    ds_read_b128 v[112:115], v11 offset:2048
    ds_read_b128 v[116:119], v11 offset:3072
    s_waitcnt lgkmcnt(6)
    v_mfma_f32_16x16x32_bf16 v[52:55], v[104:107], v[40:43], v[52:55]
    v_mfma_f32_16x16x32_bf16 v[56:59], v[120:123], v[40:43], v[56:59]
    v_mfma_f32_16x16x32_bf16 v[48:51], v[40:43], v[40:43], v[48:51]
    s_waitcnt lgkmcnt(4)
    v_mfma_f32_16x16x32_bf16 v[52:55], v[108:111], v[44:47], v[52:55]
    v_mfma_f32_16x16x32_bf16 v[56:59], v[124:127], v[44:47], v[56:59]
    v_mfma_f32_16x16x32_bf16 v[48:51], v[44:47], v[44:47], v[48:51]
    v_smfmac_f32_16x16x64_bf16 v[28:31], v[72:75], v[208:215], v18
    v_smfmac_f32_16x16x64_bf16 v[28:31], v[76:79], v[216:223], v18
    v_max3_f32 v60, v52, v53, v54
    s_waitcnt vmcnt(4)
    v_max3_f32 v62, v55, v56, v57
    v_max3_f32 v61, v48, v49, v50
    v_max3_f32 v60, v60, v58, v59
    v_max_f32 v61, v61, v51
    ds_read_b128 v[20:23], v8 offset:0
    v_add_f32 v61, v61, v19
    v_max3_f32 v60, v60, v62, v61
    ds_read_b128 v[24:27], v8 offset:256
    v_mov_b32 v61, v60
    v_smfmac_f32_16x16x64_bf16 v[28:31], v[80:83], v[224:231], v18
    ds_read_b128 v[104:107], v11 offset:32768
    v_permlane32_swap_b32 v60, v61
    v_max_f32 v60, v60, v61
    v_mov_b32 v61, v60
    v_smfmac_f32_16x16x64_bf16 v[28:31], v[84:87], v[232:239], v18
    ds_read_b128 v[108:111], v11 offset:33792
    v_permlane16_swap_b32 v60, v61
    v_max_f32 v60, v60, v61
    v_mul_f32 v62, -v60, s36
    v_smfmac_f32_16x16x64_bf16 v[28:31], v[88:91], v[240:247], v18
    v_add_f32 v63, v62, v19
    v_fma_f32 v52, v52, s36, v62
    v_fma_f32 v53, v53, s36, v62
    v_fma_f32 v54, v54, s36, v62
    v_fma_f32 v55, v55, s36, v62
    v_smfmac_f32_16x16x64_bf16 v[28:31], v[92:95], v[248:255], v18
    v_exp_f32 v52, v52
    v_exp_f32 v53, v53
    v_exp_f32 v54, v54
    v_exp_f32 v55, v55
    v_fma_f32 v56, v56, s36, v62
    v_fma_f32 v57, v57, s36, v62
    v_fma_f32 v58, v58, s36, v62
    v_fma_f32 v59, v59, s36, v62
    v_exp_f32 v56, v56
    v_exp_f32 v57, v57
    v_exp_f32 v58, v58
    v_exp_f32 v59, v59
    v_fma_f32 v48, v48, s36, v63
    v_fma_f32 v49, v49, s36, v63
    v_fma_f32 v50, v50, s36, v63
    v_fma_f32 v51, v51, s36, v63
    v_cvt_pk_bf16_f32 v32, v52, v53
    v_cvt_pk_bf16_f32 v33, v54, v55
    v_exp_f32 v48, v48
    v_exp_f32 v49, v49
    v_exp_f32 v50, v50
    v_exp_f32 v51, v51
    v_cvt_pk_bf16_f32 v34, v56, v57
    v_cvt_pk_bf16_f32 v35, v58, v59
    v_cvt_pk_bf16_f32 v36, v48, v49
    v_cvt_pk_bf16_f32 v37, v50, v51
    s_waitcnt lgkmcnt(2)
    v_mfma_f32_16x16x32_bf16 v[68:71], v[64:67], v[32:35], 0
    v_cvt_pk_bf16_f32 v28, v28, v29
    v_mfma_f32_16x16x32_bf16 v[44:47], v[24:27], v[32:35], 0
    v_cvt_pk_bf16_f32 v29, v30, v31
    v_mfma_f32_16x16x32_bf16 v[40:43], v[20:23], v[32:35], 0
    v_mov_b32 v38, 0
    v_mov_b32 v39, 0
    v_mfma_f32_16x16x16_bf16 v[68:71], v[64:65], v[36:37], v[68:71]
    ds_read_b128 v[120:123], v11 offset:34816
    v_mfma_f32_16x16x16_bf16 v[44:47], v[28:29], v[36:37], v[44:47]
    v_permlane32_swap_b32 v36, v38
    v_permlane32_swap_b32 v37, v39
    ds_read_b128 v[124:127], v11 offset:35840
    ds_read_b128 v[72:75], v15 offset:0
    v_mfma_f32_16x16x16_bf16 v[40:43], v[28:29], v[38:39], v[40:43]
    ds_read_b128 v[76:79], v15 offset:1024
    v_rcp_f32 v60, v68
    ds_read_b128 v[80:83], v15 offset:2048
    ds_read_b128 v[84:87], v15 offset:3072
    ds_read_b128 v[88:91], v15 offset:32768
    ds_read_b128 v[92:95], v15 offset:33792
    s_nop 1
    v_pk_mul_f32 v[40:41], v[40:41], v[60:61] op_sel_hi:[1,0]
    v_pk_mul_f32 v[42:43], v[42:43], v[60:61] op_sel_hi:[1,0]
    v_pk_mul_f32 v[44:45], v[44:45], v[60:61] op_sel_hi:[1,0]
    v_pk_mul_f32 v[46:47], v[46:47], v[60:61] op_sel_hi:[1,0]
    v_cvt_pk_bf16_f32 v40, v40, v41
    v_cvt_pk_bf16_f32 v41, v42, v43
    v_cvt_pk_bf16_f32 v44, v44, v45
    v_cvt_pk_bf16_f32 v45, v46, v47
    s_mov_b64 exec, s[28:29]
    s_waitcnt lgkmcnt(8)
    ds_write_b64 v9, v[40:41]
    ds_write_b64 v9, v[44:45] offset:32
    s_mov_b64 exec, -1
    global_store_dwordx2 v16, v[28:29], s[24:25] sc1
    s_cmp_eq_u32 s7, 63
    s_cbranch_scc1 Lfin_47
    ds_read_b128 v[64:67], v15 offset:34816
    ds_read_b128 v[68:71], v15 offset:35840
    v_mov_b32 v32, 0
    v_mov_b32 v33, 0
    v_mov_b32 v34, 0
    v_mov_b32 v35, 0
    v_mov_b32 v36, 0
    v_mov_b32 v37, 0
    v_mov_b32 v38, 0
    v_mov_b32 v39, 0
    s_waitcnt lgkmcnt(2)
    s_barrier
    ds_read_b128 v[48:51], v10 offset:0
    ds_read_b128 v[52:55], v10 offset:64
    ds_read_b128 v[56:59], v10 offset:128
    ds_read_b128 v[60:63], v10 offset:192
    v_mov_b32 v40, 0
    v_mov_b32 v41, 0
    v_mov_b32 v42, 0
    v_mov_b32 v43, 0
    v_mov_b32 v44, 0
    v_mov_b32 v45, 0
    v_mov_b32 v46, 0
    v_mov_b32 v47, 0
    s_waitcnt lgkmcnt(3)
    v_smfmac_f32_16x16x64_bf16 v[32:35], v[48:51], v[96:103], v18
    ds_read_b128 v[96:99], v11 offset:4096
    ds_read_b128 v[100:103], v11 offset:5120
    v_smfmac_f32_16x16x64_bf16 v[36:39], v[48:51], v[112:119], v18
    ds_read_b128 v[112:115], v11 offset:6144
    ds_read_b128 v[116:119], v11 offset:7168
    s_waitcnt lgkmcnt(6)
    v_smfmac_f32_16x16x64_bf16 v[32:35], v[52:55], v[104:111], v18
    ds_read_b128 v[104:107], v11 offset:36864
    ds_read_b128 v[108:111], v11 offset:37888
    v_smfmac_f32_16x16x64_bf16 v[36:39], v[52:55], v[120:127], v18
    ds_read_b128 v[120:123], v11 offset:38912
    ds_read_b128 v[124:127], v11 offset:39936
    s_waitcnt lgkmcnt(9)
    v_smfmac_f32_16x16x64_bf16 v[32:35], v[56:59], v[72:79], v18
    ds_read_b128 v[72:75], v15 offset:4096
    ds_read_b128 v[76:79], v15 offset:5120
    v_smfmac_f32_16x16x64_bf16 v[36:39], v[56:59], v[80:87], v18
    ds_read_b128 v[80:83], v15 offset:6144
    ds_read_b128 v[84:87], v15 offset:7168
    s_waitcnt lgkmcnt(12)
    v_smfmac_f32_16x16x64_bf16 v[32:35], v[60:63], v[88:95], v18
    ds_read_b128 v[88:91], v15 offset:36864
    ds_read_b128 v[92:95], v15 offset:37888
    v_smfmac_f32_16x16x64_bf16 v[36:39], v[60:63], v[64:71], v18
    s_waitcnt lgkmcnt(13)
    ds_read_b128 v[64:67], v15 offset:38912
    ds_read_b128 v[68:71], v15 offset:39936
    s_waitcnt lgkmcnt(14)
    v_smfmac_f32_16x16x64_bf16 v[40:43], v[48:51], v[96:103], v18
    s_waitcnt lgkmcnt(12)
    v_smfmac_f32_16x16x64_bf16 v[44:47], v[48:51], v[112:119], v18
    s_waitcnt lgkmcnt(10)
    v_smfmac_f32_16x16x64_bf16 v[40:43], v[52:55], v[104:111], v18
    s_waitcnt lgkmcnt(8)
    v_smfmac_f32_16x16x64_bf16 v[44:47], v[52:55], v[120:127], v18
    v_cvt_pk_bf16_f32 v32, v32, v33
    v_cvt_pk_bf16_f32 v33, v34, v35
    v_cvt_pk_bf16_f32 v34, v36, v37
    v_cvt_pk_bf16_f32 v35, v38, v39
    v_or_b32 v32, 1, v32
    v_or_b32 v33, 1, v33
    v_or_b32 v34, 1, v34
    v_or_b32 v35, 1, v35
    global_store_dwordx4 v12, v[32:35], s[14:15] offset:0 sc1
    s_waitcnt lgkmcnt(6)
    v_smfmac_f32_16x16x64_bf16 v[40:43], v[56:59], v[72:79], v18
    s_waitcnt lgkmcnt(4)
    v_smfmac_f32_16x16x64_bf16 v[44:47], v[56:59], v[80:87], v18
    s_waitcnt lgkmcnt(2)
    v_smfmac_f32_16x16x64_bf16 v[40:43], v[60:63], v[88:95], v18
    s_waitcnt lgkmcnt(0)
    v_smfmac_f32_16x16x64_bf16 v[44:47], v[60:63], v[64:71], v18
    s_add_u32 s22, s22, 65536
    s_addc_u32 s23, s23, 0
    s_add_u32 s24, s24, 65536
    s_addc_u32 s25, s25, 0
    s_ashr_i32 s37, s52, 31
    s_nop 1
    v_cvt_pk_bf16_f32 v40, v40, v41
    v_cvt_pk_bf16_f32 v41, v42, v43
    v_cvt_pk_bf16_f32 v42, v44, v45
    v_cvt_pk_bf16_f32 v43, v46, v47
    v_or_b32 v40, 1, v40
    v_or_b32 v41, 1, v41
    v_or_b32 v42, 1, v42
    v_or_b32 v43, 1, v43
    global_store_dwordx4 v12, v[40:43], s[14:15] offset:1024 sc1
    s_add_u32 s10, s10, s52
    s_addc_u32 s11, s11, s37
    v_mov_b32 v96, 0
    v_mov_b32 v97, 0
    v_mov_b32 v98, 0
    v_mov_b32 v99, 0
    s_mov_b32 s42, 0x10001
    s_mov_b32 s43, 0x10001
    s_mov_b64 exec, s[42:43]
    v_mov_b32 v96, 0x00003f80
    s_lshl_b64 exec, exec, 1
    v_mov_b32 v96, 0x3f800000
    s_mov_b32 s42, 0x40004
    s_mov_b32 s43, 0x40004
    s_mov_b64 exec, s[42:43]
    v_mov_b32 v97, 0x00003f80
    s_lshl_b64 exec, exec, 1
    v_mov_b32 v97, 0x3f800000
    s_mov_b32 s42, 0x100010
    s_mov_b32 s43, 0x100010
    s_mov_b64 exec, s[42:43]
    v_mov_b32 v98, 0x00003f80
    s_lshl_b64 exec, exec, 1
    v_mov_b32 v98, 0x3f800000
    s_mov_b32 s42, 0x400040
    s_mov_b32 s43, 0x400040
    s_mov_b64 exec, s[42:43]
    v_mov_b32 v99, 0x00003f80
    s_lshl_b64 exec, exec, 1
    v_mov_b32 v99, 0x3f800000
    s_mov_b64 exec, -1
    s_waitcnt vmcnt(0)
    s_mov_b32 s40, 0
LpollA_74:
    global_load_dwordx4 v[48:51], v13, s[14:15] sc1
    global_load_dwordx4 v[52:55], v13, s[16:17] sc1
    s_add_u32 s40, s40, 1
    s_cmp_gt_u32 s40, 262144
    s_cbranch_scc1 Lto_45
    s_waitcnt vmcnt(0)
    v_bitop3_b32 v68, v48, v49, v50 bitop3:0x80
    v_bitop3_b32 v69, v51, v52, v53 bitop3:0x80
    v_bitop3_b32 v68, v68, v54, v55 bitop3:0x80
    v_and_b32 v68, v68, v69
    v_and_b32 v68, 1, v68
    v_cmp_ne_u32 vcc, 1, v68
    s_cbranch_vccnz LpollA_74
    v_mfma_f32_16x16x32_bf16 v[56:59], v[96:99], v[48:51], 0
    v_mfma_f32_16x16x32_bf16 v[56:59], v[96:99], v[52:55], v[56:59]
    s_sub_u32 s52, 0, s52
    s_nop 6
    v_add_f32_dpp v56, v56, v56 row_ror:8 row_mask:0xf bank_mask:0xf
    v_add_f32_dpp v57, v57, v57 row_ror:8 row_mask:0xf bank_mask:0xf
    v_add_f32_dpp v58, v58, v58 row_ror:8 row_mask:0xf bank_mask:0xf
    v_add_f32_dpp v59, v59, v59 row_ror:8 row_mask:0xf bank_mask:0xf
    v_add_f32_dpp v56, v56, v56 row_ror:4 row_mask:0xf bank_mask:0xf
    v_add_f32_dpp v57, v57, v57 row_ror:4 row_mask:0xf bank_mask:0xf
    v_add_f32_dpp v58, v58, v58 row_ror:4 row_mask:0xf bank_mask:0xf
    v_add_f32_dpp v59, v59, v59 row_ror:4 row_mask:0xf bank_mask:0xf
    v_cndmask_b32 v56, v56, v57, s[34:35]
    v_cndmask_b32 v58, v58, v59, s[34:35]
    v_cndmask_b32 v56, v56, v58, s[32:33]
    s_nop 1
    v_mov_b32_dpp v57, v56 quad_perm:[1,0,3,2] row_mask:0xf bank_mask:0xf
    v_cvt_pk_bf16_f32 v56, v56, v57
    v_min_u32 v56, 0xfffffffe, v56
    s_mov_b64 exec, s[30:31]
    global_store_dword v14, v56, s[12:13] sc1
    s_ashr_i32 s37, s52, 31
    s_add_u32 s12, s12, s52
    s_addc_u32 s13, s13, s37
    v_mov_b32 v57, -1
    global_store_dword v14, v57, s[12:13] sc1
    s_mov_b64 exec, -1
    s_add_u32 s7, s7, 1
    s_cmp_lt_u32 s7, 64
    s_cbranch_scc1 Lstep_46
Lfin_47:
    s_mov_b32 s7, 64
    s_waitcnt vmcnt(0) lgkmcnt(0)
    s_barrier
    v_mov_b32 v95, s7
    s_mov_b64 exec, 1
    global_store_dword v0, v95, s[48:49] sc1
    s_waitcnt vmcnt(0)
    s_endpgm
Lto_45:
    s_load_dwordx2 s[42:43], s[0:1], 88
    s_waitcnt lgkmcnt(0)
    s_mov_b64 exec, 1
    v_mov_b32 v32, 140
    v_mov_b32 v33, s7
    v_add_u32 v33, 0x10000, v33
    global_store_dword v32, v33, s[42:43] sc1
    s_waitcnt vmcnt(0)
    s_endpgm
ROLE_T3q:
    s_lshr_b32 s34, s4, 4
    s_and_b32 s17, s4, 15
    s_lshl_b32 s17, s17, 1
    s_lshr_b32 s18, s5, 1
    s_add_u32 s33, s17, s18
    v_and_b32 v40, 63, v0
    v_and_b32 v41, 31, v40
    v_lshrrev_b32 v42, 5, v40
    v_and_b32 v43, 15, v40
    v_lshrrev_b32 v44, 4, v40
    s_cmp_lg_u32 s6, 0
    s_cbranch_scc1 Lwsg_77
    s_branch Lws_75
Lwsg_77:
    s_load_dwordx2 s[30:31], s[0:1], 88
    s_mov_b32 s14, 1
    s_mov_b32 s7, 0
    v_mov_b32 v2, 248
    s_waitcnt lgkmcnt(0)
    s_mov_b32 s16, 0
Lp_80:
    global_load_dword v3, v2, s[30:31] sc1
    s_add_u32 s16, s16, 1
    s_cmp_gt_u32 s16, 262144
    s_cbranch_scc1 Lwito_78
    s_waitcnt vmcnt(0)
    v_cmp_gt_u32 vcc, s14, v3
    s_cbranch_vccnz Lp_80
    s_branch Lwisk_79
Lwito_78:
    s_load_dwordx2 s[30:31], s[0:1], 88
    s_waitcnt lgkmcnt(0)
    s_mov_b64 exec, 1
    v_mov_b32 v2, 176
    v_mov_b32 v3, s7
    v_add_u32 v3, 0x10000, v3
    global_store_dword v2, v3, s[30:31] sc1
    s_waitcnt vmcnt(0)
    s_endpgm
Lwisk_79:
    v_mov_b32 v2, 0
    s_mov_b32 s12, s8
    s_mov_b32 s13, s9
    s_mov_b32 s14, 1
    s_mov_b32 s7, 0
    s_mov_b32 s16, 0
Lp_81:
    global_load_dword v3, v2, s[12:13] sc1
    s_add_u32 s16, s16, 1
    s_cmp_gt_u32 s16, 262144
    s_cbranch_scc1 Lwsto_76
    s_waitcnt vmcnt(0)
    v_cmp_gt_u32 vcc, s14, v3
    s_cbranch_vccnz Lp_81
    s_branch Lws_75
Lwsto_76:
    s_load_dwordx2 s[30:31], s[0:1], 88
    s_waitcnt lgkmcnt(0)
    s_mov_b64 exec, 1
    v_mov_b32 v2, 168
    v_mov_b32 v3, s7
    v_add_u32 v3, 0x10000, v3
    global_store_dword v2, v3, s[30:31] sc1
    s_waitcnt vmcnt(0)
    s_endpgm
Lws_75:
    s_cmp_lg_u32 s34, 0
    s_cbranch_scc1 Lq_82
    v_lshrrev_b32 v45, 3, v40
    v_mul_u32_u24 v45, 8192, v45
    v_and_b32 v46, 7, v40
    v_lshl_add_u32 v45, v46, 4, v45
    v_lshrrev_b32 v46, 2, v43
    v_lshl_add_u32 v46, v42, 3, v46
    v_lshlrev_b32 v46, 7, v46
    v_and_b32 v47, 1, v44
    v_lshl_add_u32 v46, v47, 5, v46
    v_and_b32 v47, 3, v43
    v_lshl_add_u32 v46, v47, 3, v46
    s_lshl_b32 s18, s5, 15
    v_add_u32 v46, s18, v46
    s_load_dwordx2 s[30:31], s[0:1], 40
    s_lshl_b32 s17, s33, 8
    s_and_b32 s18, s5, 1
    s_lshl_b32 s18, s18, 7
    s_add_u32 s17, s17, s18
    s_add_u32 s17, s17, 0
    s_lshl_b32 s19, s5, 15
    s_waitcnt lgkmcnt(0)
    s_add_u32 s30, s30, s17
    s_addc_u32 s31, s31, 0
    s_mov_b32 m0, s19
    s_add_u32 s19, s19, 1024
    global_load_lds_dwordx4 v45, s[30:31]
    s_add_u32 s30, s30, 65536
    s_addc_u32 s31, s31, 0
    s_mov_b32 m0, s19
    s_add_u32 s19, s19, 1024
    global_load_lds_dwordx4 v45, s[30:31]
    s_add_u32 s30, s30, 65536
    s_addc_u32 s31, s31, 0
    s_mov_b32 m0, s19
    s_add_u32 s19, s19, 1024
    global_load_lds_dwordx4 v45, s[30:31]
    s_add_u32 s30, s30, 65536
    s_addc_u32 s31, s31, 0
    s_mov_b32 m0, s19
    s_add_u32 s19, s19, 1024
    global_load_lds_dwordx4 v45, s[30:31]
    s_add_u32 s30, s30, 65536
    s_addc_u32 s31, s31, 0
    s_mov_b32 m0, s19
    s_add_u32 s19, s19, 1024
    global_load_lds_dwordx4 v45, s[30:31]
    s_add_u32 s30, s30, 65536
    s_addc_u32 s31, s31, 0
    s_mov_b32 m0, s19
    s_add_u32 s19, s19, 1024
    global_load_lds_dwordx4 v45, s[30:31]
    s_add_u32 s30, s30, 65536
    s_addc_u32 s31, s31, 0
    s_mov_b32 m0, s19
    s_add_u32 s19, s19, 1024
    global_load_lds_dwordx4 v45, s[30:31]
    s_add_u32 s30, s30, 65536
    s_addc_u32 s31, s31, 0
    s_mov_b32 m0, s19
    s_add_u32 s19, s19, 1024
    global_load_lds_dwordx4 v45, s[30:31]
    s_add_u32 s30, s30, 65536
    s_addc_u32 s31, s31, 0
    s_mov_b32 m0, s19
    s_add_u32 s19, s19, 1024
    global_load_lds_dwordx4 v45, s[30:31]
    s_add_u32 s30, s30, 65536
    s_addc_u32 s31, s31, 0
    s_mov_b32 m0, s19
    s_add_u32 s19, s19, 1024
    global_load_lds_dwordx4 v45, s[30:31]
    s_add_u32 s30, s30, 65536
    s_addc_u32 s31, s31, 0
    s_mov_b32 m0, s19
    s_add_u32 s19, s19, 1024
    global_load_lds_dwordx4 v45, s[30:31]
    s_add_u32 s30, s30, 65536
    s_addc_u32 s31, s31, 0
    s_mov_b32 m0, s19
    s_add_u32 s19, s19, 1024
    global_load_lds_dwordx4 v45, s[30:31]
    s_add_u32 s30, s30, 65536
    s_addc_u32 s31, s31, 0
    s_mov_b32 m0, s19
    s_add_u32 s19, s19, 1024
    global_load_lds_dwordx4 v45, s[30:31]
    s_add_u32 s30, s30, 65536
    s_addc_u32 s31, s31, 0
    s_mov_b32 m0, s19
    s_add_u32 s19, s19, 1024
    global_load_lds_dwordx4 v45, s[30:31]
    s_add_u32 s30, s30, 65536
    s_addc_u32 s31, s31, 0
    s_mov_b32 m0, s19
    s_add_u32 s19, s19, 1024
    global_load_lds_dwordx4 v45, s[30:31]
    s_add_u32 s30, s30, 65536
    s_addc_u32 s31, s31, 0
    s_mov_b32 m0, s19
    s_add_u32 s19, s19, 1024
    global_load_lds_dwordx4 v45, s[30:31]
    s_add_u32 s30, s30, 65536
    s_addc_u32 s31, s31, 0
    s_mov_b32 m0, s19
    s_add_u32 s19, s19, 1024
    global_load_lds_dwordx4 v45, s[30:31]
    s_add_u32 s30, s30, 65536
    s_addc_u32 s31, s31, 0
    s_mov_b32 m0, s19
    s_add_u32 s19, s19, 1024
    global_load_lds_dwordx4 v45, s[30:31]
    s_add_u32 s30, s30, 65536
    s_addc_u32 s31, s31, 0
    s_mov_b32 m0, s19
    s_add_u32 s19, s19, 1024
    global_load_lds_dwordx4 v45, s[30:31]
    s_add_u32 s30, s30, 65536
    s_addc_u32 s31, s31, 0
    s_mov_b32 m0, s19
    s_add_u32 s19, s19, 1024
    global_load_lds_dwordx4 v45, s[30:31]
    s_add_u32 s30, s30, 65536
    s_addc_u32 s31, s31, 0
    s_mov_b32 m0, s19
    s_add_u32 s19, s19, 1024
    global_load_lds_dwordx4 v45, s[30:31]
    s_add_u32 s30, s30, 65536
    s_addc_u32 s31, s31, 0
    s_mov_b32 m0, s19
    s_add_u32 s19, s19, 1024
    global_load_lds_dwordx4 v45, s[30:31]
    s_add_u32 s30, s30, 65536
    s_addc_u32 s31, s31, 0
    s_mov_b32 m0, s19
    s_add_u32 s19, s19, 1024
    global_load_lds_dwordx4 v45, s[30:31]
    s_add_u32 s30, s30, 65536
    s_addc_u32 s31, s31, 0
    s_mov_b32 m0, s19
    s_add_u32 s19, s19, 1024
    global_load_lds_dwordx4 v45, s[30:31]
    s_add_u32 s30, s30, 65536
    s_addc_u32 s31, s31, 0
    s_mov_b32 m0, s19
    s_add_u32 s19, s19, 1024
    global_load_lds_dwordx4 v45, s[30:31]
    s_add_u32 s30, s30, 65536
    s_addc_u32 s31, s31, 0
    s_mov_b32 m0, s19
    s_add_u32 s19, s19, 1024
    global_load_lds_dwordx4 v45, s[30:31]
    s_add_u32 s30, s30, 65536
    s_addc_u32 s31, s31, 0
    s_mov_b32 m0, s19
    s_add_u32 s19, s19, 1024
    global_load_lds_dwordx4 v45, s[30:31]
    s_add_u32 s30, s30, 65536
    s_addc_u32 s31, s31, 0
    s_mov_b32 m0, s19
    s_add_u32 s19, s19, 1024
    global_load_lds_dwordx4 v45, s[30:31]
    s_add_u32 s30, s30, 65536
    s_addc_u32 s31, s31, 0
    s_mov_b32 m0, s19
    s_add_u32 s19, s19, 1024
    global_load_lds_dwordx4 v45, s[30:31]
    s_add_u32 s30, s30, 65536
    s_addc_u32 s31, s31, 0
    s_mov_b32 m0, s19
    s_add_u32 s19, s19, 1024
    global_load_lds_dwordx4 v45, s[30:31]
    s_add_u32 s30, s30, 65536
    s_addc_u32 s31, s31, 0
    s_mov_b32 m0, s19
    s_add_u32 s19, s19, 1024
    global_load_lds_dwordx4 v45, s[30:31]
    s_add_u32 s30, s30, 65536
    s_addc_u32 s31, s31, 0
    s_mov_b32 m0, s19
    s_add_u32 s19, s19, 1024
    global_load_lds_dwordx4 v45, s[30:31]
    s_add_u32 s30, s30, 65536
    s_addc_u32 s31, s31, 0
    s_waitcnt vmcnt(0)
    ds_read_b64_tr_b16 a[0:1], v46 offset:0
    ds_read_b64_tr_b16 a[2:3], v46 offset:512
    ds_read_b64_tr_b16 a[128:129], v46 offset:64
    ds_read_b64_tr_b16 a[130:131], v46 offset:576
    ds_read_b64_tr_b16 a[4:5], v46 offset:2048
    ds_read_b64_tr_b16 a[6:7], v46 offset:2560
    ds_read_b64_tr_b16 a[132:133], v46 offset:2112
    ds_read_b64_tr_b16 a[134:135], v46 offset:2624
    s_waitcnt lgkmcnt(0)
    ds_read_b64_tr_b16 a[8:9], v46 offset:4096
    ds_read_b64_tr_b16 a[10:11], v46 offset:4608
    ds_read_b64_tr_b16 a[136:137], v46 offset:4160
    ds_read_b64_tr_b16 a[138:139], v46 offset:4672
    ds_read_b64_tr_b16 a[12:13], v46 offset:6144
    ds_read_b64_tr_b16 a[14:15], v46 offset:6656
    ds_read_b64_tr_b16 a[140:141], v46 offset:6208
    ds_read_b64_tr_b16 a[142:143], v46 offset:6720
    s_waitcnt lgkmcnt(0)
    ds_read_b64_tr_b16 a[16:17], v46 offset:8192
    ds_read_b64_tr_b16 a[18:19], v46 offset:8704
    ds_read_b64_tr_b16 a[144:145], v46 offset:8256
    ds_read_b64_tr_b16 a[146:147], v46 offset:8768
    ds_read_b64_tr_b16 a[20:21], v46 offset:10240
    ds_read_b64_tr_b16 a[22:23], v46 offset:10752
    ds_read_b64_tr_b16 a[148:149], v46 offset:10304
    ds_read_b64_tr_b16 a[150:151], v46 offset:10816
    s_waitcnt lgkmcnt(0)
    ds_read_b64_tr_b16 a[24:25], v46 offset:12288
    ds_read_b64_tr_b16 a[26:27], v46 offset:12800
    ds_read_b64_tr_b16 a[152:153], v46 offset:12352
    ds_read_b64_tr_b16 a[154:155], v46 offset:12864
    ds_read_b64_tr_b16 a[28:29], v46 offset:14336
    ds_read_b64_tr_b16 a[30:31], v46 offset:14848
    ds_read_b64_tr_b16 a[156:157], v46 offset:14400
    ds_read_b64_tr_b16 a[158:159], v46 offset:14912
    s_waitcnt lgkmcnt(0)
    ds_read_b64_tr_b16 a[32:33], v46 offset:16384
    ds_read_b64_tr_b16 a[34:35], v46 offset:16896
    ds_read_b64_tr_b16 a[160:161], v46 offset:16448
    ds_read_b64_tr_b16 a[162:163], v46 offset:16960
    ds_read_b64_tr_b16 a[36:37], v46 offset:18432
    ds_read_b64_tr_b16 a[38:39], v46 offset:18944
    ds_read_b64_tr_b16 a[164:165], v46 offset:18496
    ds_read_b64_tr_b16 a[166:167], v46 offset:19008
    s_waitcnt lgkmcnt(0)
    ds_read_b64_tr_b16 a[40:41], v46 offset:20480
    ds_read_b64_tr_b16 a[42:43], v46 offset:20992
    ds_read_b64_tr_b16 a[168:169], v46 offset:20544
    ds_read_b64_tr_b16 a[170:171], v46 offset:21056
    ds_read_b64_tr_b16 a[44:45], v46 offset:22528
    ds_read_b64_tr_b16 a[46:47], v46 offset:23040
    ds_read_b64_tr_b16 a[172:173], v46 offset:22592
    ds_read_b64_tr_b16 a[174:175], v46 offset:23104
    s_waitcnt lgkmcnt(0)
    ds_read_b64_tr_b16 a[48:49], v46 offset:24576
    ds_read_b64_tr_b16 a[50:51], v46 offset:25088
    ds_read_b64_tr_b16 a[176:177], v46 offset:24640
    ds_read_b64_tr_b16 a[178:179], v46 offset:25152
    ds_read_b64_tr_b16 a[52:53], v46 offset:26624
    ds_read_b64_tr_b16 a[54:55], v46 offset:27136
    ds_read_b64_tr_b16 a[180:181], v46 offset:26688
    ds_read_b64_tr_b16 a[182:183], v46 offset:27200
    s_waitcnt lgkmcnt(0)
    ds_read_b64_tr_b16 a[56:57], v46 offset:28672
    ds_read_b64_tr_b16 a[58:59], v46 offset:29184
    ds_read_b64_tr_b16 a[184:185], v46 offset:28736
    ds_read_b64_tr_b16 a[186:187], v46 offset:29248
    ds_read_b64_tr_b16 a[60:61], v46 offset:30720
    ds_read_b64_tr_b16 a[62:63], v46 offset:31232
    ds_read_b64_tr_b16 a[188:189], v46 offset:30784
    ds_read_b64_tr_b16 a[190:191], v46 offset:31296
    s_waitcnt lgkmcnt(0)
    s_waitcnt lgkmcnt(0)
    s_load_dwordx2 s[30:31], s[0:1], 40
    s_lshl_b32 s17, s33, 8
    s_and_b32 s18, s5, 1
    s_lshl_b32 s18, s18, 7
    s_add_u32 s17, s17, s18
    s_add_u32 s17, s17, 2097152
    s_lshl_b32 s19, s5, 15
    s_waitcnt lgkmcnt(0)
    s_add_u32 s30, s30, s17
    s_addc_u32 s31, s31, 0
    s_mov_b32 m0, s19
    s_add_u32 s19, s19, 1024
    global_load_lds_dwordx4 v45, s[30:31]
    s_add_u32 s30, s30, 65536
    s_addc_u32 s31, s31, 0
    s_mov_b32 m0, s19
    s_add_u32 s19, s19, 1024
    global_load_lds_dwordx4 v45, s[30:31]
    s_add_u32 s30, s30, 65536
    s_addc_u32 s31, s31, 0
    s_mov_b32 m0, s19
    s_add_u32 s19, s19, 1024
    global_load_lds_dwordx4 v45, s[30:31]
    s_add_u32 s30, s30, 65536
    s_addc_u32 s31, s31, 0
    s_mov_b32 m0, s19
    s_add_u32 s19, s19, 1024
    global_load_lds_dwordx4 v45, s[30:31]
    s_add_u32 s30, s30, 65536
    s_addc_u32 s31, s31, 0
    s_mov_b32 m0, s19
    s_add_u32 s19, s19, 1024
    global_load_lds_dwordx4 v45, s[30:31]
    s_add_u32 s30, s30, 65536
    s_addc_u32 s31, s31, 0
    s_mov_b32 m0, s19
    s_add_u32 s19, s19, 1024
    global_load_lds_dwordx4 v45, s[30:31]
    s_add_u32 s30, s30, 65536
    s_addc_u32 s31, s31, 0
    s_mov_b32 m0, s19
    s_add_u32 s19, s19, 1024
    global_load_lds_dwordx4 v45, s[30:31]
    s_add_u32 s30, s30, 65536
    s_addc_u32 s31, s31, 0
    s_mov_b32 m0, s19
    s_add_u32 s19, s19, 1024
    global_load_lds_dwordx4 v45, s[30:31]
    s_add_u32 s30, s30, 65536
    s_addc_u32 s31, s31, 0
    s_mov_b32 m0, s19
    s_add_u32 s19, s19, 1024
    global_load_lds_dwordx4 v45, s[30:31]
    s_add_u32 s30, s30, 65536
    s_addc_u32 s31, s31, 0
    s_mov_b32 m0, s19
    s_add_u32 s19, s19, 1024
    global_load_lds_dwordx4 v45, s[30:31]
    s_add_u32 s30, s30, 65536
    s_addc_u32 s31, s31, 0
    s_mov_b32 m0, s19
    s_add_u32 s19, s19, 1024
    global_load_lds_dwordx4 v45, s[30:31]
    s_add_u32 s30, s30, 65536
    s_addc_u32 s31, s31, 0
    s_mov_b32 m0, s19
    s_add_u32 s19, s19, 1024
    global_load_lds_dwordx4 v45, s[30:31]
    s_add_u32 s30, s30, 65536
    s_addc_u32 s31, s31, 0
    s_mov_b32 m0, s19
    s_add_u32 s19, s19, 1024
    global_load_lds_dwordx4 v45, s[30:31]
    s_add_u32 s30, s30, 65536
    s_addc_u32 s31, s31, 0
    s_mov_b32 m0, s19
    s_add_u32 s19, s19, 1024
    global_load_lds_dwordx4 v45, s[30:31]
    s_add_u32 s30, s30, 65536
    s_addc_u32 s31, s31, 0
    s_mov_b32 m0, s19
    s_add_u32 s19, s19, 1024
    global_load_lds_dwordx4 v45, s[30:31]
    s_add_u32 s30, s30, 65536
    s_addc_u32 s31, s31, 0
    s_mov_b32 m0, s19
    s_add_u32 s19, s19, 1024
    global_load_lds_dwordx4 v45, s[30:31]
    s_add_u32 s30, s30, 65536
    s_addc_u32 s31, s31, 0
    s_mov_b32 m0, s19
    s_add_u32 s19, s19, 1024
    global_load_lds_dwordx4 v45, s[30:31]
    s_add_u32 s30, s30, 65536
    s_addc_u32 s31, s31, 0
    s_mov_b32 m0, s19
    s_add_u32 s19, s19, 1024
    global_load_lds_dwordx4 v45, s[30:31]
    s_add_u32 s30, s30, 65536
    s_addc_u32 s31, s31, 0
    s_mov_b32 m0, s19
    s_add_u32 s19, s19, 1024
    global_load_lds_dwordx4 v45, s[30:31]
    s_add_u32 s30, s30, 65536
    s_addc_u32 s31, s31, 0
    s_mov_b32 m0, s19
    s_add_u32 s19, s19, 1024
    global_load_lds_dwordx4 v45, s[30:31]
    s_add_u32 s30, s30, 65536
    s_addc_u32 s31, s31, 0
    s_mov_b32 m0, s19
    s_add_u32 s19, s19, 1024
    global_load_lds_dwordx4 v45, s[30:31]
    s_add_u32 s30, s30, 65536
    s_addc_u32 s31, s31, 0
    s_mov_b32 m0, s19
    s_add_u32 s19, s19, 1024
    global_load_lds_dwordx4 v45, s[30:31]
    s_add_u32 s30, s30, 65536
    s_addc_u32 s31, s31, 0
    s_mov_b32 m0, s19
    s_add_u32 s19, s19, 1024
    global_load_lds_dwordx4 v45, s[30:31]
    s_add_u32 s30, s30, 65536
    s_addc_u32 s31, s31, 0
    s_mov_b32 m0, s19
    s_add_u32 s19, s19, 1024
    global_load_lds_dwordx4 v45, s[30:31]
    s_add_u32 s30, s30, 65536
    s_addc_u32 s31, s31, 0
    s_mov_b32 m0, s19
    s_add_u32 s19, s19, 1024
    global_load_lds_dwordx4 v45, s[30:31]
    s_add_u32 s30, s30, 65536
    s_addc_u32 s31, s31, 0
    s_mov_b32 m0, s19
    s_add_u32 s19, s19, 1024
    global_load_lds_dwordx4 v45, s[30:31]
    s_add_u32 s30, s30, 65536
    s_addc_u32 s31, s31, 0
    s_mov_b32 m0, s19
    s_add_u32 s19, s19, 1024
    global_load_lds_dwordx4 v45, s[30:31]
    s_add_u32 s30, s30, 65536
    s_addc_u32 s31, s31, 0
    s_mov_b32 m0, s19
    s_add_u32 s19, s19, 1024
    global_load_lds_dwordx4 v45, s[30:31]
    s_add_u32 s30, s30, 65536
    s_addc_u32 s31, s31, 0
    s_mov_b32 m0, s19
    s_add_u32 s19, s19, 1024
    global_load_lds_dwordx4 v45, s[30:31]
    s_add_u32 s30, s30, 65536
    s_addc_u32 s31, s31, 0
    s_mov_b32 m0, s19
    s_add_u32 s19, s19, 1024
    global_load_lds_dwordx4 v45, s[30:31]
    s_add_u32 s30, s30, 65536
    s_addc_u32 s31, s31, 0
    s_mov_b32 m0, s19
    s_add_u32 s19, s19, 1024
    global_load_lds_dwordx4 v45, s[30:31]
    s_add_u32 s30, s30, 65536
    s_addc_u32 s31, s31, 0
    s_mov_b32 m0, s19
    s_add_u32 s19, s19, 1024
    global_load_lds_dwordx4 v45, s[30:31]
    s_add_u32 s30, s30, 65536
    s_addc_u32 s31, s31, 0
    s_waitcnt vmcnt(0)
    ds_read_b64_tr_b16 a[64:65], v46 offset:0
    ds_read_b64_tr_b16 a[66:67], v46 offset:512
    ds_read_b64_tr_b16 a[192:193], v46 offset:64
    ds_read_b64_tr_b16 a[194:195], v46 offset:576
    ds_read_b64_tr_b16 a[68:69], v46 offset:2048
    ds_read_b64_tr_b16 a[70:71], v46 offset:2560
    ds_read_b64_tr_b16 a[196:197], v46 offset:2112
    ds_read_b64_tr_b16 a[198:199], v46 offset:2624
    s_waitcnt lgkmcnt(0)
    ds_read_b64_tr_b16 a[72:73], v46 offset:4096
    ds_read_b64_tr_b16 a[74:75], v46 offset:4608
    ds_read_b64_tr_b16 a[200:201], v46 offset:4160
    ds_read_b64_tr_b16 a[202:203], v46 offset:4672
    ds_read_b64_tr_b16 a[76:77], v46 offset:6144
    ds_read_b64_tr_b16 a[78:79], v46 offset:6656
    ds_read_b64_tr_b16 a[204:205], v46 offset:6208
    ds_read_b64_tr_b16 a[206:207], v46 offset:6720
    s_waitcnt lgkmcnt(0)
    ds_read_b64_tr_b16 a[80:81], v46 offset:8192
    ds_read_b64_tr_b16 a[82:83], v46 offset:8704
    ds_read_b64_tr_b16 a[208:209], v46 offset:8256
    ds_read_b64_tr_b16 a[210:211], v46 offset:8768
    ds_read_b64_tr_b16 a[84:85], v46 offset:10240
    ds_read_b64_tr_b16 a[86:87], v46 offset:10752
    ds_read_b64_tr_b16 a[212:213], v46 offset:10304
    ds_read_b64_tr_b16 a[214:215], v46 offset:10816
    s_waitcnt lgkmcnt(0)
    ds_read_b64_tr_b16 a[88:89], v46 offset:12288
    ds_read_b64_tr_b16 a[90:91], v46 offset:12800
    ds_read_b64_tr_b16 a[216:217], v46 offset:12352
    ds_read_b64_tr_b16 a[218:219], v46 offset:12864
    ds_read_b64_tr_b16 a[92:93], v46 offset:14336
    ds_read_b64_tr_b16 a[94:95], v46 offset:14848
    ds_read_b64_tr_b16 a[220:221], v46 offset:14400
    ds_read_b64_tr_b16 a[222:223], v46 offset:14912
    s_waitcnt lgkmcnt(0)
    ds_read_b64_tr_b16 a[96:97], v46 offset:16384
    ds_read_b64_tr_b16 a[98:99], v46 offset:16896
    ds_read_b64_tr_b16 a[224:225], v46 offset:16448
    ds_read_b64_tr_b16 a[226:227], v46 offset:16960
    ds_read_b64_tr_b16 a[100:101], v46 offset:18432
    ds_read_b64_tr_b16 a[102:103], v46 offset:18944
    ds_read_b64_tr_b16 a[228:229], v46 offset:18496
    ds_read_b64_tr_b16 a[230:231], v46 offset:19008
    s_waitcnt lgkmcnt(0)
    ds_read_b64_tr_b16 a[104:105], v46 offset:20480
    ds_read_b64_tr_b16 a[106:107], v46 offset:20992
    ds_read_b64_tr_b16 a[232:233], v46 offset:20544
    ds_read_b64_tr_b16 a[234:235], v46 offset:21056
    ds_read_b64_tr_b16 a[108:109], v46 offset:22528
    ds_read_b64_tr_b16 a[110:111], v46 offset:23040
    ds_read_b64_tr_b16 a[236:237], v46 offset:22592
    ds_read_b64_tr_b16 a[238:239], v46 offset:23104
    s_waitcnt lgkmcnt(0)
    ds_read_b64_tr_b16 a[112:113], v46 offset:24576
    ds_read_b64_tr_b16 a[114:115], v46 offset:25088
    ds_read_b64_tr_b16 a[240:241], v46 offset:24640
    ds_read_b64_tr_b16 a[242:243], v46 offset:25152
    ds_read_b64_tr_b16 a[116:117], v46 offset:26624
    ds_read_b64_tr_b16 a[118:119], v46 offset:27136
    ds_read_b64_tr_b16 a[244:245], v46 offset:26688
    ds_read_b64_tr_b16 a[246:247], v46 offset:27200
    s_waitcnt lgkmcnt(0)
    ds_read_b64_tr_b16 a[120:121], v46 offset:28672
    ds_read_b64_tr_b16 a[122:123], v46 offset:29184
    ds_read_b64_tr_b16 a[248:249], v46 offset:28736
    ds_read_b64_tr_b16 a[250:251], v46 offset:29248
    ds_read_b64_tr_b16 a[124:125], v46 offset:30720
    ds_read_b64_tr_b16 a[126:127], v46 offset:31232
    ds_read_b64_tr_b16 a[252:253], v46 offset:30784
    ds_read_b64_tr_b16 a[254:255], v46 offset:31296
    s_waitcnt lgkmcnt(0)
    s_waitcnt lgkmcnt(0)
    s_branch Le_83
Lq_82:
    v_lshrrev_b32 v45, 3, v40
    v_mul_u32_u24 v45, 8192, v45
    v_and_b32 v46, 7, v40
    v_lshl_add_u32 v45, v46, 4, v45
    v_lshrrev_b32 v46, 2, v43
    v_lshl_add_u32 v46, v42, 3, v46
    v_lshlrev_b32 v46, 7, v46
    v_and_b32 v47, 1, v44
    v_lshl_add_u32 v46, v47, 5, v46
    v_and_b32 v47, 3, v43
    v_lshl_add_u32 v46, v47, 3, v46
    s_lshl_b32 s18, s5, 15
    v_add_u32 v46, s18, v46
    s_load_dwordx2 s[30:31], s[0:1], 48
    s_lshl_b32 s17, s33, 8
    s_and_b32 s18, s5, 1
    s_lshl_b32 s18, s18, 7
    s_add_u32 s17, s17, s18
    s_add_u32 s17, s17, 0
    s_lshl_b32 s19, s5, 15
    s_waitcnt lgkmcnt(0)
    s_add_u32 s30, s30, s17
    s_addc_u32 s31, s31, 0
    s_mov_b32 m0, s19
    s_add_u32 s19, s19, 1024
    global_load_lds_dwordx4 v45, s[30:31]
    s_add_u32 s30, s30, 65536
    s_addc_u32 s31, s31, 0
    s_mov_b32 m0, s19
    s_add_u32 s19, s19, 1024
    global_load_lds_dwordx4 v45, s[30:31]
    s_add_u32 s30, s30, 65536
    s_addc_u32 s31, s31, 0
    s_mov_b32 m0, s19
    s_add_u32 s19, s19, 1024
    global_load_lds_dwordx4 v45, s[30:31]
    s_add_u32 s30, s30, 65536
    s_addc_u32 s31, s31, 0
    s_mov_b32 m0, s19
    s_add_u32 s19, s19, 1024
    global_load_lds_dwordx4 v45, s[30:31]
    s_add_u32 s30, s30, 65536
    s_addc_u32 s31, s31, 0
    s_mov_b32 m0, s19
    s_add_u32 s19, s19, 1024
    global_load_lds_dwordx4 v45, s[30:31]
    s_add_u32 s30, s30, 65536
    s_addc_u32 s31, s31, 0
    s_mov_b32 m0, s19
    s_add_u32 s19, s19, 1024
    global_load_lds_dwordx4 v45, s[30:31]
    s_add_u32 s30, s30, 65536
    s_addc_u32 s31, s31, 0
    s_mov_b32 m0, s19
    s_add_u32 s19, s19, 1024
    global_load_lds_dwordx4 v45, s[30:31]
    s_add_u32 s30, s30, 65536
    s_addc_u32 s31, s31, 0
    s_mov_b32 m0, s19
    s_add_u32 s19, s19, 1024
    global_load_lds_dwordx4 v45, s[30:31]
    s_add_u32 s30, s30, 65536
    s_addc_u32 s31, s31, 0
    s_mov_b32 m0, s19
    s_add_u32 s19, s19, 1024
    global_load_lds_dwordx4 v45, s[30:31]
    s_add_u32 s30, s30, 65536
    s_addc_u32 s31, s31, 0
    s_mov_b32 m0, s19
    s_add_u32 s19, s19, 1024
    global_load_lds_dwordx4 v45, s[30:31]
    s_add_u32 s30, s30, 65536
    s_addc_u32 s31, s31, 0
    s_mov_b32 m0, s19
    s_add_u32 s19, s19, 1024
    global_load_lds_dwordx4 v45, s[30:31]
    s_add_u32 s30, s30, 65536
    s_addc_u32 s31, s31, 0
    s_mov_b32 m0, s19
    s_add_u32 s19, s19, 1024
    global_load_lds_dwordx4 v45, s[30:31]
    s_add_u32 s30, s30, 65536
    s_addc_u32 s31, s31, 0
    s_mov_b32 m0, s19
    s_add_u32 s19, s19, 1024
    global_load_lds_dwordx4 v45, s[30:31]
    s_add_u32 s30, s30, 65536
    s_addc_u32 s31, s31, 0
    s_mov_b32 m0, s19
    s_add_u32 s19, s19, 1024
    global_load_lds_dwordx4 v45, s[30:31]
    s_add_u32 s30, s30, 65536
    s_addc_u32 s31, s31, 0
    s_mov_b32 m0, s19
    s_add_u32 s19, s19, 1024
    global_load_lds_dwordx4 v45, s[30:31]
    s_add_u32 s30, s30, 65536
    s_addc_u32 s31, s31, 0
    s_mov_b32 m0, s19
    s_add_u32 s19, s19, 1024
    global_load_lds_dwordx4 v45, s[30:31]
    s_add_u32 s30, s30, 65536
    s_addc_u32 s31, s31, 0
    s_mov_b32 m0, s19
    s_add_u32 s19, s19, 1024
    global_load_lds_dwordx4 v45, s[30:31]
    s_add_u32 s30, s30, 65536
    s_addc_u32 s31, s31, 0
    s_mov_b32 m0, s19
    s_add_u32 s19, s19, 1024
    global_load_lds_dwordx4 v45, s[30:31]
    s_add_u32 s30, s30, 65536
    s_addc_u32 s31, s31, 0
    s_mov_b32 m0, s19
    s_add_u32 s19, s19, 1024
    global_load_lds_dwordx4 v45, s[30:31]
    s_add_u32 s30, s30, 65536
    s_addc_u32 s31, s31, 0
    s_mov_b32 m0, s19
    s_add_u32 s19, s19, 1024
    global_load_lds_dwordx4 v45, s[30:31]
    s_add_u32 s30, s30, 65536
    s_addc_u32 s31, s31, 0
    s_mov_b32 m0, s19
    s_add_u32 s19, s19, 1024
    global_load_lds_dwordx4 v45, s[30:31]
    s_add_u32 s30, s30, 65536
    s_addc_u32 s31, s31, 0
    s_mov_b32 m0, s19
    s_add_u32 s19, s19, 1024
    global_load_lds_dwordx4 v45, s[30:31]
    s_add_u32 s30, s30, 65536
    s_addc_u32 s31, s31, 0
    s_mov_b32 m0, s19
    s_add_u32 s19, s19, 1024
    global_load_lds_dwordx4 v45, s[30:31]
    s_add_u32 s30, s30, 65536
    s_addc_u32 s31, s31, 0
    s_mov_b32 m0, s19
    s_add_u32 s19, s19, 1024
    global_load_lds_dwordx4 v45, s[30:31]
    s_add_u32 s30, s30, 65536
    s_addc_u32 s31, s31, 0
    s_mov_b32 m0, s19
    s_add_u32 s19, s19, 1024
    global_load_lds_dwordx4 v45, s[30:31]
    s_add_u32 s30, s30, 65536
    s_addc_u32 s31, s31, 0
    s_mov_b32 m0, s19
    s_add_u32 s19, s19, 1024
    global_load_lds_dwordx4 v45, s[30:31]
    s_add_u32 s30, s30, 65536
    s_addc_u32 s31, s31, 0
    s_mov_b32 m0, s19
    s_add_u32 s19, s19, 1024
    global_load_lds_dwordx4 v45, s[30:31]
    s_add_u32 s30, s30, 65536
    s_addc_u32 s31, s31, 0
    s_mov_b32 m0, s19
    s_add_u32 s19, s19, 1024
    global_load_lds_dwordx4 v45, s[30:31]
    s_add_u32 s30, s30, 65536
    s_addc_u32 s31, s31, 0
    s_mov_b32 m0, s19
    s_add_u32 s19, s19, 1024
    global_load_lds_dwordx4 v45, s[30:31]
    s_add_u32 s30, s30, 65536
    s_addc_u32 s31, s31, 0
    s_mov_b32 m0, s19
    s_add_u32 s19, s19, 1024
    global_load_lds_dwordx4 v45, s[30:31]
    s_add_u32 s30, s30, 65536
    s_addc_u32 s31, s31, 0
    s_mov_b32 m0, s19
    s_add_u32 s19, s19, 1024
    global_load_lds_dwordx4 v45, s[30:31]
    s_add_u32 s30, s30, 65536
    s_addc_u32 s31, s31, 0
    s_mov_b32 m0, s19
    s_add_u32 s19, s19, 1024
    global_load_lds_dwordx4 v45, s[30:31]
    s_add_u32 s30, s30, 65536
    s_addc_u32 s31, s31, 0
    s_waitcnt vmcnt(0)
    ds_read_b64_tr_b16 a[0:1], v46 offset:0
    ds_read_b64_tr_b16 a[2:3], v46 offset:512
    ds_read_b64_tr_b16 a[128:129], v46 offset:64
    ds_read_b64_tr_b16 a[130:131], v46 offset:576
    ds_read_b64_tr_b16 a[4:5], v46 offset:2048
    ds_read_b64_tr_b16 a[6:7], v46 offset:2560
    ds_read_b64_tr_b16 a[132:133], v46 offset:2112
    ds_read_b64_tr_b16 a[134:135], v46 offset:2624
    s_waitcnt lgkmcnt(0)
    ds_read_b64_tr_b16 a[8:9], v46 offset:4096
    ds_read_b64_tr_b16 a[10:11], v46 offset:4608
    ds_read_b64_tr_b16 a[136:137], v46 offset:4160
    ds_read_b64_tr_b16 a[138:139], v46 offset:4672
    ds_read_b64_tr_b16 a[12:13], v46 offset:6144
    ds_read_b64_tr_b16 a[14:15], v46 offset:6656
    ds_read_b64_tr_b16 a[140:141], v46 offset:6208
    ds_read_b64_tr_b16 a[142:143], v46 offset:6720
    s_waitcnt lgkmcnt(0)
    ds_read_b64_tr_b16 a[16:17], v46 offset:8192
    ds_read_b64_tr_b16 a[18:19], v46 offset:8704
    ds_read_b64_tr_b16 a[144:145], v46 offset:8256
    ds_read_b64_tr_b16 a[146:147], v46 offset:8768
    ds_read_b64_tr_b16 a[20:21], v46 offset:10240
    ds_read_b64_tr_b16 a[22:23], v46 offset:10752
    ds_read_b64_tr_b16 a[148:149], v46 offset:10304
    ds_read_b64_tr_b16 a[150:151], v46 offset:10816
    s_waitcnt lgkmcnt(0)
    ds_read_b64_tr_b16 a[24:25], v46 offset:12288
    ds_read_b64_tr_b16 a[26:27], v46 offset:12800
    ds_read_b64_tr_b16 a[152:153], v46 offset:12352
    ds_read_b64_tr_b16 a[154:155], v46 offset:12864
    ds_read_b64_tr_b16 a[28:29], v46 offset:14336
    ds_read_b64_tr_b16 a[30:31], v46 offset:14848
    ds_read_b64_tr_b16 a[156:157], v46 offset:14400
    ds_read_b64_tr_b16 a[158:159], v46 offset:14912
    s_waitcnt lgkmcnt(0)
    ds_read_b64_tr_b16 a[32:33], v46 offset:16384
    ds_read_b64_tr_b16 a[34:35], v46 offset:16896
    ds_read_b64_tr_b16 a[160:161], v46 offset:16448
    ds_read_b64_tr_b16 a[162:163], v46 offset:16960
    ds_read_b64_tr_b16 a[36:37], v46 offset:18432
    ds_read_b64_tr_b16 a[38:39], v46 offset:18944
    ds_read_b64_tr_b16 a[164:165], v46 offset:18496
    ds_read_b64_tr_b16 a[166:167], v46 offset:19008
    s_waitcnt lgkmcnt(0)
    ds_read_b64_tr_b16 a[40:41], v46 offset:20480
    ds_read_b64_tr_b16 a[42:43], v46 offset:20992
    ds_read_b64_tr_b16 a[168:169], v46 offset:20544
    ds_read_b64_tr_b16 a[170:171], v46 offset:21056
    ds_read_b64_tr_b16 a[44:45], v46 offset:22528
    ds_read_b64_tr_b16 a[46:47], v46 offset:23040
    ds_read_b64_tr_b16 a[172:173], v46 offset:22592
    ds_read_b64_tr_b16 a[174:175], v46 offset:23104
    s_waitcnt lgkmcnt(0)
    ds_read_b64_tr_b16 a[48:49], v46 offset:24576
    ds_read_b64_tr_b16 a[50:51], v46 offset:25088
    ds_read_b64_tr_b16 a[176:177], v46 offset:24640
    ds_read_b64_tr_b16 a[178:179], v46 offset:25152
    ds_read_b64_tr_b16 a[52:53], v46 offset:26624
    ds_read_b64_tr_b16 a[54:55], v46 offset:27136
    ds_read_b64_tr_b16 a[180:181], v46 offset:26688
    ds_read_b64_tr_b16 a[182:183], v46 offset:27200
    s_waitcnt lgkmcnt(0)
    ds_read_b64_tr_b16 a[56:57], v46 offset:28672
    ds_read_b64_tr_b16 a[58:59], v46 offset:29184
    ds_read_b64_tr_b16 a[184:185], v46 offset:28736
    ds_read_b64_tr_b16 a[186:187], v46 offset:29248
    ds_read_b64_tr_b16 a[60:61], v46 offset:30720
    ds_read_b64_tr_b16 a[62:63], v46 offset:31232
    ds_read_b64_tr_b16 a[188:189], v46 offset:30784
    ds_read_b64_tr_b16 a[190:191], v46 offset:31296
    s_waitcnt lgkmcnt(0)
    s_waitcnt lgkmcnt(0)
    s_load_dwordx2 s[30:31], s[0:1], 48
    s_lshl_b32 s17, s33, 8
    s_and_b32 s18, s5, 1
    s_lshl_b32 s18, s18, 7
    s_add_u32 s17, s17, s18
    s_add_u32 s17, s17, 2097152
    s_lshl_b32 s19, s5, 15
    s_waitcnt lgkmcnt(0)
    s_add_u32 s30, s30, s17
    s_addc_u32 s31, s31, 0
    s_mov_b32 m0, s19
    s_add_u32 s19, s19, 1024
    global_load_lds_dwordx4 v45, s[30:31]
    s_add_u32 s30, s30, 65536
    s_addc_u32 s31, s31, 0
    s_mov_b32 m0, s19
    s_add_u32 s19, s19, 1024
    global_load_lds_dwordx4 v45, s[30:31]
    s_add_u32 s30, s30, 65536
    s_addc_u32 s31, s31, 0
    s_mov_b32 m0, s19
    s_add_u32 s19, s19, 1024
    global_load_lds_dwordx4 v45, s[30:31]
    s_add_u32 s30, s30, 65536
    s_addc_u32 s31, s31, 0
    s_mov_b32 m0, s19
    s_add_u32 s19, s19, 1024
    global_load_lds_dwordx4 v45, s[30:31]
    s_add_u32 s30, s30, 65536
    s_addc_u32 s31, s31, 0
    s_mov_b32 m0, s19
    s_add_u32 s19, s19, 1024
    global_load_lds_dwordx4 v45, s[30:31]
    s_add_u32 s30, s30, 65536
    s_addc_u32 s31, s31, 0
    s_mov_b32 m0, s19
    s_add_u32 s19, s19, 1024
    global_load_lds_dwordx4 v45, s[30:31]
    s_add_u32 s30, s30, 65536
    s_addc_u32 s31, s31, 0
    s_mov_b32 m0, s19
    s_add_u32 s19, s19, 1024
    global_load_lds_dwordx4 v45, s[30:31]
    s_add_u32 s30, s30, 65536
    s_addc_u32 s31, s31, 0
    s_mov_b32 m0, s19
    s_add_u32 s19, s19, 1024
    global_load_lds_dwordx4 v45, s[30:31]
    s_add_u32 s30, s30, 65536
    s_addc_u32 s31, s31, 0
    s_mov_b32 m0, s19
    s_add_u32 s19, s19, 1024
    global_load_lds_dwordx4 v45, s[30:31]
    s_add_u32 s30, s30, 65536
    s_addc_u32 s31, s31, 0
    s_mov_b32 m0, s19
    s_add_u32 s19, s19, 1024
    global_load_lds_dwordx4 v45, s[30:31]
    s_add_u32 s30, s30, 65536
    s_addc_u32 s31, s31, 0
    s_mov_b32 m0, s19
    s_add_u32 s19, s19, 1024
    global_load_lds_dwordx4 v45, s[30:31]
    s_add_u32 s30, s30, 65536
    s_addc_u32 s31, s31, 0
    s_mov_b32 m0, s19
    s_add_u32 s19, s19, 1024
    global_load_lds_dwordx4 v45, s[30:31]
    s_add_u32 s30, s30, 65536
    s_addc_u32 s31, s31, 0
    s_mov_b32 m0, s19
    s_add_u32 s19, s19, 1024
    global_load_lds_dwordx4 v45, s[30:31]
    s_add_u32 s30, s30, 65536
    s_addc_u32 s31, s31, 0
    s_mov_b32 m0, s19
    s_add_u32 s19, s19, 1024
    global_load_lds_dwordx4 v45, s[30:31]
    s_add_u32 s30, s30, 65536
    s_addc_u32 s31, s31, 0
    s_mov_b32 m0, s19
    s_add_u32 s19, s19, 1024
    global_load_lds_dwordx4 v45, s[30:31]
    s_add_u32 s30, s30, 65536
    s_addc_u32 s31, s31, 0
    s_mov_b32 m0, s19
    s_add_u32 s19, s19, 1024
    global_load_lds_dwordx4 v45, s[30:31]
    s_add_u32 s30, s30, 65536
    s_addc_u32 s31, s31, 0
    s_mov_b32 m0, s19
    s_add_u32 s19, s19, 1024
    global_load_lds_dwordx4 v45, s[30:31]
    s_add_u32 s30, s30, 65536
    s_addc_u32 s31, s31, 0
    s_mov_b32 m0, s19
    s_add_u32 s19, s19, 1024
    global_load_lds_dwordx4 v45, s[30:31]
    s_add_u32 s30, s30, 65536
    s_addc_u32 s31, s31, 0
    s_mov_b32 m0, s19
    s_add_u32 s19, s19, 1024
    global_load_lds_dwordx4 v45, s[30:31]
    s_add_u32 s30, s30, 65536
    s_addc_u32 s31, s31, 0
    s_mov_b32 m0, s19
    s_add_u32 s19, s19, 1024
    global_load_lds_dwordx4 v45, s[30:31]
    s_add_u32 s30, s30, 65536
    s_addc_u32 s31, s31, 0
    s_mov_b32 m0, s19
    s_add_u32 s19, s19, 1024
    global_load_lds_dwordx4 v45, s[30:31]
    s_add_u32 s30, s30, 65536
    s_addc_u32 s31, s31, 0
    s_mov_b32 m0, s19
    s_add_u32 s19, s19, 1024
    global_load_lds_dwordx4 v45, s[30:31]
    s_add_u32 s30, s30, 65536
    s_addc_u32 s31, s31, 0
    s_mov_b32 m0, s19
    s_add_u32 s19, s19, 1024
    global_load_lds_dwordx4 v45, s[30:31]
    s_add_u32 s30, s30, 65536
    s_addc_u32 s31, s31, 0
    s_mov_b32 m0, s19
    s_add_u32 s19, s19, 1024
    global_load_lds_dwordx4 v45, s[30:31]
    s_add_u32 s30, s30, 65536
    s_addc_u32 s31, s31, 0
    s_mov_b32 m0, s19
    s_add_u32 s19, s19, 1024
    global_load_lds_dwordx4 v45, s[30:31]
    s_add_u32 s30, s30, 65536
    s_addc_u32 s31, s31, 0
    s_mov_b32 m0, s19
    s_add_u32 s19, s19, 1024
    global_load_lds_dwordx4 v45, s[30:31]
    s_add_u32 s30, s30, 65536
    s_addc_u32 s31, s31, 0
    s_mov_b32 m0, s19
    s_add_u32 s19, s19, 1024
    global_load_lds_dwordx4 v45, s[30:31]
    s_add_u32 s30, s30, 65536
    s_addc_u32 s31, s31, 0
    s_mov_b32 m0, s19
    s_add_u32 s19, s19, 1024
    global_load_lds_dwordx4 v45, s[30:31]
    s_add_u32 s30, s30, 65536
    s_addc_u32 s31, s31, 0
    s_mov_b32 m0, s19
    s_add_u32 s19, s19, 1024
    global_load_lds_dwordx4 v45, s[30:31]
    s_add_u32 s30, s30, 65536
    s_addc_u32 s31, s31, 0
    s_mov_b32 m0, s19
    s_add_u32 s19, s19, 1024
    global_load_lds_dwordx4 v45, s[30:31]
    s_add_u32 s30, s30, 65536
    s_addc_u32 s31, s31, 0
    s_mov_b32 m0, s19
    s_add_u32 s19, s19, 1024
    global_load_lds_dwordx4 v45, s[30:31]
    s_add_u32 s30, s30, 65536
    s_addc_u32 s31, s31, 0
    s_mov_b32 m0, s19
    s_add_u32 s19, s19, 1024
    global_load_lds_dwordx4 v45, s[30:31]
    s_add_u32 s30, s30, 65536
    s_addc_u32 s31, s31, 0
    s_waitcnt vmcnt(0)
    ds_read_b64_tr_b16 a[64:65], v46 offset:0
    ds_read_b64_tr_b16 a[66:67], v46 offset:512
    ds_read_b64_tr_b16 a[192:193], v46 offset:64
    ds_read_b64_tr_b16 a[194:195], v46 offset:576
    ds_read_b64_tr_b16 a[68:69], v46 offset:2048
    ds_read_b64_tr_b16 a[70:71], v46 offset:2560
    ds_read_b64_tr_b16 a[196:197], v46 offset:2112
    ds_read_b64_tr_b16 a[198:199], v46 offset:2624
    s_waitcnt lgkmcnt(0)
    ds_read_b64_tr_b16 a[72:73], v46 offset:4096
    ds_read_b64_tr_b16 a[74:75], v46 offset:4608
    ds_read_b64_tr_b16 a[200:201], v46 offset:4160
    ds_read_b64_tr_b16 a[202:203], v46 offset:4672
    ds_read_b64_tr_b16 a[76:77], v46 offset:6144
    ds_read_b64_tr_b16 a[78:79], v46 offset:6656
    ds_read_b64_tr_b16 a[204:205], v46 offset:6208
    ds_read_b64_tr_b16 a[206:207], v46 offset:6720
    s_waitcnt lgkmcnt(0)
    ds_read_b64_tr_b16 a[80:81], v46 offset:8192
    ds_read_b64_tr_b16 a[82:83], v46 offset:8704
    ds_read_b64_tr_b16 a[208:209], v46 offset:8256
    ds_read_b64_tr_b16 a[210:211], v46 offset:8768
    ds_read_b64_tr_b16 a[84:85], v46 offset:10240
    ds_read_b64_tr_b16 a[86:87], v46 offset:10752
    ds_read_b64_tr_b16 a[212:213], v46 offset:10304
    ds_read_b64_tr_b16 a[214:215], v46 offset:10816
    s_waitcnt lgkmcnt(0)
    ds_read_b64_tr_b16 a[88:89], v46 offset:12288
    ds_read_b64_tr_b16 a[90:91], v46 offset:12800
    ds_read_b64_tr_b16 a[216:217], v46 offset:12352
    ds_read_b64_tr_b16 a[218:219], v46 offset:12864
    ds_read_b64_tr_b16 a[92:93], v46 offset:14336
    ds_read_b64_tr_b16 a[94:95], v46 offset:14848
    ds_read_b64_tr_b16 a[220:221], v46 offset:14400
    ds_read_b64_tr_b16 a[222:223], v46 offset:14912
    s_waitcnt lgkmcnt(0)
    ds_read_b64_tr_b16 a[96:97], v46 offset:16384
    ds_read_b64_tr_b16 a[98:99], v46 offset:16896
    ds_read_b64_tr_b16 a[224:225], v46 offset:16448
    ds_read_b64_tr_b16 a[226:227], v46 offset:16960
    ds_read_b64_tr_b16 a[100:101], v46 offset:18432
    ds_read_b64_tr_b16 a[102:103], v46 offset:18944
    ds_read_b64_tr_b16 a[228:229], v46 offset:18496
    ds_read_b64_tr_b16 a[230:231], v46 offset:19008
    s_waitcnt lgkmcnt(0)
    ds_read_b64_tr_b16 a[104:105], v46 offset:20480
    ds_read_b64_tr_b16 a[106:107], v46 offset:20992
    ds_read_b64_tr_b16 a[232:233], v46 offset:20544
    ds_read_b64_tr_b16 a[234:235], v46 offset:21056
    ds_read_b64_tr_b16 a[108:109], v46 offset:22528
    ds_read_b64_tr_b16 a[110:111], v46 offset:23040
    ds_read_b64_tr_b16 a[236:237], v46 offset:22592
    ds_read_b64_tr_b16 a[238:239], v46 offset:23104
    s_waitcnt lgkmcnt(0)
    ds_read_b64_tr_b16 a[112:113], v46 offset:24576
    ds_read_b64_tr_b16 a[114:115], v46 offset:25088
    ds_read_b64_tr_b16 a[240:241], v46 offset:24640
    ds_read_b64_tr_b16 a[242:243], v46 offset:25152
    ds_read_b64_tr_b16 a[116:117], v46 offset:26624
    ds_read_b64_tr_b16 a[118:119], v46 offset:27136
    ds_read_b64_tr_b16 a[244:245], v46 offset:26688
    ds_read_b64_tr_b16 a[246:247], v46 offset:27200
    s_waitcnt lgkmcnt(0)
    ds_read_b64_tr_b16 a[120:121], v46 offset:28672
    ds_read_b64_tr_b16 a[122:123], v46 offset:29184
    ds_read_b64_tr_b16 a[248:249], v46 offset:28736
    ds_read_b64_tr_b16 a[250:251], v46 offset:29248
    ds_read_b64_tr_b16 a[124:125], v46 offset:30720
    ds_read_b64_tr_b16 a[126:127], v46 offset:31232
    ds_read_b64_tr_b16 a[252:253], v46 offset:30784
    ds_read_b64_tr_b16 a[254:255], v46 offset:31296
    s_waitcnt lgkmcnt(0)
    s_waitcnt lgkmcnt(0)
Le_83:
    v_mov_b32 v8, 1065369472
    v_mov_b32 v9, 1065369472
    v_mov_b32 v10, 1065369472
    v_mov_b32 v11, 1065369472
    s_nop 1
    v_mfma_f32_32x32x16_bf16 v[64:79], a[0:3], v[8:11], 0
    v_mfma_f32_32x32x16_bf16 v[80:95], a[128:131], v[8:11], 0
    v_mfma_f32_32x32x16_bf16 v[64:79], a[4:7], v[8:11], v[64:79]
    v_mfma_f32_32x32x16_bf16 v[80:95], a[132:135], v[8:11], v[80:95]
    v_mfma_f32_32x32x16_bf16 v[64:79], a[8:11], v[8:11], v[64:79]
    v_mfma_f32_32x32x16_bf16 v[80:95], a[136:139], v[8:11], v[80:95]
    v_mfma_f32_32x32x16_bf16 v[64:79], a[12:15], v[8:11], v[64:79]
    v_mfma_f32_32x32x16_bf16 v[80:95], a[140:143], v[8:11], v[80:95]
    v_mfma_f32_32x32x16_bf16 v[64:79], a[16:19], v[8:11], v[64:79]
    v_mfma_f32_32x32x16_bf16 v[80:95], a[144:147], v[8:11], v[80:95]
    v_mfma_f32_32x32x16_bf16 v[64:79], a[20:23], v[8:11], v[64:79]
    v_mfma_f32_32x32x16_bf16 v[80:95], a[148:151], v[8:11], v[80:95]
    v_mfma_f32_32x32x16_bf16 v[64:79], a[24:27], v[8:11], v[64:79]
    v_mfma_f32_32x32x16_bf16 v[80:95], a[152:155], v[8:11], v[80:95]
    v_mfma_f32_32x32x16_bf16 v[64:79], a[28:31], v[8:11], v[64:79]
    v_mfma_f32_32x32x16_bf16 v[80:95], a[156:159], v[8:11], v[80:95]
    v_mfma_f32_32x32x16_bf16 v[64:79], a[32:35], v[8:11], v[64:79]
    v_mfma_f32_32x32x16_bf16 v[80:95], a[160:163], v[8:11], v[80:95]
    v_mfma_f32_32x32x16_bf16 v[64:79], a[36:39], v[8:11], v[64:79]
    v_mfma_f32_32x32x16_bf16 v[80:95], a[164:167], v[8:11], v[80:95]
    v_mfma_f32_32x32x16_bf16 v[64:79], a[40:43], v[8:11], v[64:79]
    v_mfma_f32_32x32x16_bf16 v[80:95], a[168:171], v[8:11], v[80:95]
    v_mfma_f32_32x32x16_bf16 v[64:79], a[44:47], v[8:11], v[64:79]
    v_mfma_f32_32x32x16_bf16 v[80:95], a[172:175], v[8:11], v[80:95]
    v_mfma_f32_32x32x16_bf16 v[64:79], a[48:51], v[8:11], v[64:79]
    v_mfma_f32_32x32x16_bf16 v[80:95], a[176:179], v[8:11], v[80:95]
    v_mfma_f32_32x32x16_bf16 v[64:79], a[52:55], v[8:11], v[64:79]
    v_mfma_f32_32x32x16_bf16 v[80:95], a[180:183], v[8:11], v[80:95]
    v_mfma_f32_32x32x16_bf16 v[64:79], a[56:59], v[8:11], v[64:79]
    v_mfma_f32_32x32x16_bf16 v[80:95], a[184:187], v[8:11], v[80:95]
    v_mfma_f32_32x32x16_bf16 v[64:79], a[60:63], v[8:11], v[64:79]
    v_mfma_f32_32x32x16_bf16 v[80:95], a[188:191], v[8:11], v[80:95]
    v_mfma_f32_32x32x16_bf16 v[64:79], a[64:67], v[8:11], v[64:79]
    v_mfma_f32_32x32x16_bf16 v[80:95], a[192:195], v[8:11], v[80:95]
    v_mfma_f32_32x32x16_bf16 v[64:79], a[68:71], v[8:11], v[64:79]
    v_mfma_f32_32x32x16_bf16 v[80:95], a[196:199], v[8:11], v[80:95]
    v_mfma_f32_32x32x16_bf16 v[64:79], a[72:75], v[8:11], v[64:79]
    v_mfma_f32_32x32x16_bf16 v[80:95], a[200:203], v[8:11], v[80:95]
    v_mfma_f32_32x32x16_bf16 v[64:79], a[76:79], v[8:11], v[64:79]
    v_mfma_f32_32x32x16_bf16 v[80:95], a[204:207], v[8:11], v[80:95]
    v_mfma_f32_32x32x16_bf16 v[64:79], a[80:83], v[8:11], v[64:79]
    v_mfma_f32_32x32x16_bf16 v[80:95], a[208:211], v[8:11], v[80:95]
    v_mfma_f32_32x32x16_bf16 v[64:79], a[84:87], v[8:11], v[64:79]
    v_mfma_f32_32x32x16_bf16 v[80:95], a[212:215], v[8:11], v[80:95]
    v_mfma_f32_32x32x16_bf16 v[64:79], a[88:91], v[8:11], v[64:79]
    v_mfma_f32_32x32x16_bf16 v[80:95], a[216:219], v[8:11], v[80:95]
    v_mfma_f32_32x32x16_bf16 v[64:79], a[92:95], v[8:11], v[64:79]
    v_mfma_f32_32x32x16_bf16 v[80:95], a[220:223], v[8:11], v[80:95]
    v_mfma_f32_32x32x16_bf16 v[64:79], a[96:99], v[8:11], v[64:79]
    v_mfma_f32_32x32x16_bf16 v[80:95], a[224:227], v[8:11], v[80:95]
    v_mfma_f32_32x32x16_bf16 v[64:79], a[100:103], v[8:11], v[64:79]
    v_mfma_f32_32x32x16_bf16 v[80:95], a[228:231], v[8:11], v[80:95]
    v_mfma_f32_32x32x16_bf16 v[64:79], a[104:107], v[8:11], v[64:79]
    v_mfma_f32_32x32x16_bf16 v[80:95], a[232:235], v[8:11], v[80:95]
    v_mfma_f32_32x32x16_bf16 v[64:79], a[108:111], v[8:11], v[64:79]
    v_mfma_f32_32x32x16_bf16 v[80:95], a[236:239], v[8:11], v[80:95]
    v_mfma_f32_32x32x16_bf16 v[64:79], a[112:115], v[8:11], v[64:79]
    v_mfma_f32_32x32x16_bf16 v[80:95], a[240:243], v[8:11], v[80:95]
    v_mfma_f32_32x32x16_bf16 v[64:79], a[116:119], v[8:11], v[64:79]
    v_mfma_f32_32x32x16_bf16 v[80:95], a[244:247], v[8:11], v[80:95]
    v_mfma_f32_32x32x16_bf16 v[64:79], a[120:123], v[8:11], v[64:79]
    v_mfma_f32_32x32x16_bf16 v[80:95], a[248:251], v[8:11], v[80:95]
    v_mfma_f32_32x32x16_bf16 v[64:79], a[124:127], v[8:11], v[64:79]
    v_mfma_f32_32x32x16_bf16 v[80:95], a[252:255], v[8:11], v[80:95]
    s_nop 11
    s_barrier
    v_lshlrev_b32 v0, 4, v40
    v_xor_b32 v1, 0x8000, v0
    s_lshl_b32 s28, s5, 12
    s_mul_i32 s17, s6, 256
    s_add_u32 s17, s17, 18432
    v_and_b32 v2, 3, v40
    v_lshlrev_b32 v2, 2, v2
    v_bfe_u32 v47, v40, 2, 1
    v_lshl_add_u32 v2, v47, 6, v2
    v_add_u32 v2, s17, v2
    s_mov_b32 s12, s8
    s_mov_b32 s13, s9
    s_mul_i32 s18, s6, 4096
    s_add_u32 s18, s18, 4096
    s_sub_u32 s19, s34, 1
    s_lshl_b32 s19, s19, 1
    s_cmp_eq_u32 s34, 0
    s_cselect_b32 s19, 4, s19
    s_and_b32 s17, s5, 1
    s_add_u32 s19, s19, s17
    s_lshl_b32 s19, s19, 4
    s_lshl_b32 s17, s33, 7
    s_add_u32 s17, s17, s19
    s_add_u32 s18, s18, s17
    s_add_u32 s26, s8, s18
    s_addc_u32 s27, s9, 0
    s_mul_i32 s18, s6, 2097152
    s_add_u32 s18, s18, 16777216
    s_lshl_b32 s17, s5, 12
    s_add_u32 s18, s18, s17
    s_add_u32 s10, s8, s18
    s_addc_u32 s11, s9, 0
    s_mul_i32 s18, s6, 262144
    s_add_u32 s18, s18, 20971520
    s_add_u32 s22, s8, s18
    s_addc_u32 s23, s9, 0
    s_cmp_lg_u32 s34, 0
    s_cbranch_scc1 Lq_84
    s_mul_i32 s18, s6, 16777216
    s_add_u32 s18, s18, 50331648
    s_lshl_b32 s17, s33, 13
    s_and_b32 s19, s5, 1
    s_lshl_b32 s19, s19, 12
    s_add_u32 s17, s17, s19
    s_add_u32 s18, s18, s17
    s_add_u32 s20, s8, s18
    s_addc_u32 s21, s9, 0
    s_branch Le_85
Lq_84:
    s_mul_i32 s18, s6, 16777216
    s_add_u32 s18, s18, 83886080
    s_lshl_b32 s17, s33, 13
    s_and_b32 s19, s5, 1
    s_lshl_b32 s19, s19, 12
    s_add_u32 s17, s17, s19
    s_add_u32 s18, s18, s17
    s_add_u32 s20, s8, s18
    s_addc_u32 s21, s9, 0
Le_85:
    v_lshlrev_b32 v4, 10, v42
    v_lshl_add_u32 v4, v41, 3, v4
    v_lshlrev_b32 v5, 11, v42
    v_lshl_add_u32 v5, v41, 4, v5
    v_add_u32 v6, 4096, v5
    s_lshl_b32 s17, s5, 8
    s_add_u32 s17, s17, 65536
    v_lshlrev_b32 v7, 2, v41
    v_add_u32 v7, s17, v7
    v_lshlrev_b32 v45, 4, v42
    v_add_u32 v45, s17, v45
    v_mov_b32 v31, v45
    s_load_dwordx2 s[30:31], s[0:1], 88
    s_mov_b32 s14, 1
    s_mov_b32 s7, 0
    v_mov_b32 v123, 248
    s_waitcnt lgkmcnt(0)
    s_mov_b32 s16, 0
Lp_90:
    global_load_dword v3, v123, s[30:31] sc1
    s_add_u32 s16, s16, 1
    s_cmp_gt_u32 s16, 262144
    s_cbranch_scc1 Lwito_88
    s_waitcnt vmcnt(0)
    v_cmp_gt_u32 vcc, s14, v3
    s_cbranch_vccnz Lp_90
    s_branch Lwisk_89
Lwito_88:
    s_load_dwordx2 s[30:31], s[0:1], 88
    s_waitcnt lgkmcnt(0)
    s_mov_b64 exec, 1
    v_mov_b32 v2, 176
    v_mov_b32 v3, s7
    v_add_u32 v3, 0x10000, v3
    global_store_dword v2, v3, s[30:31] sc1
    s_waitcnt vmcnt(0)
    s_endpgm
Lwisk_89:
    s_mov_b32 s7, 0
    s_mov_b32 s19, 0
    s_mov_b32 s35, 0
    s_mov_b32 s37, 0
    s_add_u32 s14, s19, 1
    s_mov_b32 s16, 0
Lp_91:
    global_load_dword v3, v2, s[12:13] sc1
    s_add_u32 s16, s16, 1
    s_cmp_gt_u32 s16, 262144
    s_cbranch_scc1 LtoT3q_86
    s_waitcnt vmcnt(0)
    v_cmp_gt_u32 vcc, s14, v3
    s_cbranch_vccnz Lp_91
    s_add_u32 s17, s28, 0
    s_mov_b32 m0, s17
    s_nop 0
    global_load_lds_dwordx4 v0, s[10:11] offset:0 sc1
    global_load_lds_dwordx4 v0, s[10:11] offset:1024 sc1
    global_load_lds_dwordx4 v0, s[10:11] offset:2048 sc1
    global_load_lds_dwordx4 v0, s[10:11] offset:3072 sc1
    s_add_u32 s10, s10, 16384
    s_addc_u32 s11, s11, 0
    s_add_u32 s17, s28, 16384
    s_mov_b32 m0, s17
    s_nop 0
    global_load_lds_dwordx4 v0, s[10:11] offset:0 sc1
    global_load_lds_dwordx4 v0, s[10:11] offset:1024 sc1
    global_load_lds_dwordx4 v0, s[10:11] offset:2048 sc1
    global_load_lds_dwordx4 v0, s[10:11] offset:3072 sc1
    s_add_u32 s10, s10, 16384
    s_addc_u32 s11, s11, 0
    s_waitcnt vmcnt(0)
    s_barrier
LitT3q_87:
    v_xor_b32 v1, 0x8000, v1
    s_xor_b32 s28, s28, 0x8000
    s_add_u32 s19, s7, 1
    s_add_u32 s14, s19, 1
    s_cmp_ge_u32 s19, 64
    s_cselect_b32 s15, 1, 0
    ds_read_b128 v[8:11], v1 offset:0
    ds_read_b128 v[12:15], v1 offset:1024
    ds_read_b128 v[16:19], v1 offset:2048
    ds_read_b128 v[20:23], v1 offset:3072
    s_waitcnt lgkmcnt(3)
    v_mfma_f32_32x32x16_bf16 v[32:47], a[0:3], v[8:11], 0
    v_mfma_f32_32x32x16_bf16 v[48:63], a[128:131], v[8:11], 0
    global_load_dword v3, v2, s[12:13] sc1
    ds_read_b128 v[8:11], v1 offset:4096
    s_waitcnt lgkmcnt(3)
    v_mfma_f32_32x32x16_bf16 v[32:47], a[4:7], v[12:15], v[32:47]
    v_mfma_f32_32x32x16_bf16 v[48:63], a[132:135], v[12:15], v[48:63]
    global_load_dwordx2 v[100:101], v4, s[22:23] offset:0 sc1
    ds_read_b128 v[12:15], v1 offset:5120
    s_waitcnt lgkmcnt(3)
    v_mfma_f32_32x32x16_bf16 v[32:47], a[8:11], v[16:19], v[32:47]
    v_mfma_f32_32x32x16_bf16 v[48:63], a[136:139], v[16:19], v[48:63]
    global_load_dwordx2 v[102:103], v4, s[22:23] offset:256 sc1
    ds_read_b128 v[16:19], v1 offset:6144
    s_waitcnt lgkmcnt(3)
    v_mfma_f32_32x32x16_bf16 v[32:47], a[12:15], v[20:23], v[32:47]
    v_mfma_f32_32x32x16_bf16 v[48:63], a[140:143], v[20:23], v[48:63]
    global_load_dwordx2 v[104:105], v4, s[22:23] offset:512 sc1
    ds_read_b128 v[20:23], v1 offset:7168
    s_waitcnt lgkmcnt(3)
    v_mfma_f32_32x32x16_bf16 v[32:47], a[16:19], v[8:11], v[32:47]
    v_mfma_f32_32x32x16_bf16 v[48:63], a[144:147], v[8:11], v[48:63]
    global_load_dwordx2 v[106:107], v4, s[22:23] offset:768 sc1
    ds_read_b128 v[8:11], v1 offset:8192
    s_waitcnt lgkmcnt(3)
    v_mfma_f32_32x32x16_bf16 v[32:47], a[20:23], v[12:15], v[32:47]
    v_mfma_f32_32x32x16_bf16 v[48:63], a[148:151], v[12:15], v[48:63]
    s_add_u32 s22, s22, 2048
    s_addc_u32 s23, s23, 0
    ds_read_b128 v[12:15], v1 offset:9216
    s_waitcnt lgkmcnt(3)
    v_mfma_f32_32x32x16_bf16 v[32:47], a[24:27], v[16:19], v[32:47]
    v_mfma_f32_32x32x16_bf16 v[48:63], a[152:155], v[16:19], v[48:63]
    ds_read_b128 v[16:19], v1 offset:10240
    s_waitcnt lgkmcnt(3)
    v_mfma_f32_32x32x16_bf16 v[32:47], a[28:31], v[20:23], v[32:47]
    v_mfma_f32_32x32x16_bf16 v[48:63], a[156:159], v[20:23], v[48:63]
    ds_read_b128 v[20:23], v1 offset:11264
    s_waitcnt lgkmcnt(3)
    v_mfma_f32_32x32x16_bf16 v[32:47], a[32:35], v[8:11], v[32:47]
    v_mfma_f32_32x32x16_bf16 v[48:63], a[160:163], v[8:11], v[48:63]
    ds_read_b128 v[8:11], v1 offset:12288
    s_waitcnt lgkmcnt(3)
    v_mfma_f32_32x32x16_bf16 v[32:47], a[36:39], v[12:15], v[32:47]
    v_mfma_f32_32x32x16_bf16 v[48:63], a[164:167], v[12:15], v[48:63]
    ds_read_b128 v[12:15], v1 offset:13312
    s_waitcnt lgkmcnt(3)
    v_mfma_f32_32x32x16_bf16 v[32:47], a[40:43], v[16:19], v[32:47]
    v_mfma_f32_32x32x16_bf16 v[48:63], a[168:171], v[16:19], v[48:63]
    ds_read_b128 v[16:19], v1 offset:14336
    s_waitcnt lgkmcnt(3)
    v_mfma_f32_32x32x16_bf16 v[32:47], a[44:47], v[20:23], v[32:47]
    v_mfma_f32_32x32x16_bf16 v[48:63], a[172:175], v[20:23], v[48:63]
    ds_read_b128 v[20:23], v1 offset:15360
    s_waitcnt lgkmcnt(3)
    v_mfma_f32_32x32x16_bf16 v[32:47], a[48:51], v[8:11], v[32:47]
    v_mfma_f32_32x32x16_bf16 v[48:63], a[176:179], v[8:11], v[48:63]
    s_waitcnt vmcnt(4)
    s_barrier
    v_cmp_gt_u32 vcc, s14, v3
    s_cmp_eq_u32 s35, 0
    s_cbranch_scc1 Lnp_93
    v_mov_b32 v3, s7
    s_mov_b64 exec, 1
    global_store_dword v0, v3, s[26:27] sc1
    s_mov_b64 exec, -1
Lpub_94:
    s_mov_b32 s35, 0
Lnp_93:
    s_cmp_lg_u32 s15, 0
    s_cbranch_scc1 Lhk_92
    s_cbranch_vccnz Lnr_95
    s_mov_b32 s15, 1
    s_mov_b32 s37, 1
    s_branch Lhk_92
Lnr_95:
    global_load_dword v3, v2, s[12:13] sc1
Lhk_92:
    ds_read_b128 v[8:11], v1 offset:16384
    s_waitcnt lgkmcnt(3)
    v_mfma_f32_32x32x16_bf16 v[32:47], a[52:55], v[12:15], v[32:47]
    v_mfma_f32_32x32x16_bf16 v[48:63], a[180:183], v[12:15], v[48:63]
    s_cmp_eq_u32 s37, 0
    s_cbranch_scc1 Lch_96
    s_add_u32 s17, s28, 0
    s_mov_b32 m0, s17
    s_nop 0
    global_load_lds_dwordx4 v0, s[10:11] offset:0 sc1
Lch_96:
    ds_read_b128 v[12:15], v1 offset:17408
    s_waitcnt lgkmcnt(3)
    v_mfma_f32_32x32x16_bf16 v[32:47], a[56:59], v[16:19], v[32:47]
    v_mfma_f32_32x32x16_bf16 v[48:63], a[184:187], v[16:19], v[48:63]
    s_cmp_eq_u32 s37, 0
    s_cbranch_scc1 Lch_97
    global_load_lds_dwordx4 v0, s[10:11] offset:1024 sc1
Lch_97:
    ds_read_b128 v[16:19], v1 offset:18432
    s_waitcnt lgkmcnt(3)
    v_mfma_f32_32x32x16_bf16 v[32:47], a[60:63], v[20:23], v[32:47]
    v_mfma_f32_32x32x16_bf16 v[48:63], a[188:191], v[20:23], v[48:63]
    s_cmp_eq_u32 s37, 0
    s_cbranch_scc1 Lch_98
    global_load_lds_dwordx4 v0, s[10:11] offset:2048 sc1
Lch_98:
    ds_read_b128 v[20:23], v1 offset:19456
    s_waitcnt lgkmcnt(3)
    v_mfma_f32_32x32x16_bf16 v[32:47], a[64:67], v[8:11], v[32:47]
    v_mfma_f32_32x32x16_bf16 v[48:63], a[192:195], v[8:11], v[48:63]
    s_cmp_eq_u32 s37, 0
    s_cbranch_scc1 Lch_99
    global_load_lds_dwordx4 v0, s[10:11] offset:3072 sc1
    s_add_u32 s10, s10, 16384
    s_addc_u32 s11, s11, 0
Lch_99:
    ds_read_b128 v[8:11], v1 offset:20480
    s_waitcnt lgkmcnt(3)
    v_mfma_f32_32x32x16_bf16 v[32:47], a[68:71], v[12:15], v[32:47]
    v_mfma_f32_32x32x16_bf16 v[48:63], a[196:199], v[12:15], v[48:63]
    s_cmp_eq_u32 s37, 0
    s_cbranch_scc1 Lch_100
    s_add_u32 s17, s28, 16384
    s_mov_b32 m0, s17
    s_nop 0
    global_load_lds_dwordx4 v0, s[10:11] offset:0 sc1
Lch_100:
    ds_read_b128 v[12:15], v1 offset:21504
    s_waitcnt lgkmcnt(3)
    v_mfma_f32_32x32x16_bf16 v[32:47], a[72:75], v[16:19], v[32:47]
    v_mfma_f32_32x32x16_bf16 v[48:63], a[200:203], v[16:19], v[48:63]
    s_cmp_eq_u32 s37, 0
    s_cbranch_scc1 Lch_101
    global_load_lds_dwordx4 v0, s[10:11] offset:1024 sc1
Lch_101:
    ds_read_b128 v[16:19], v1 offset:22528
    s_waitcnt lgkmcnt(3)
    v_mfma_f32_32x32x16_bf16 v[32:47], a[76:79], v[20:23], v[32:47]
    v_mfma_f32_32x32x16_bf16 v[48:63], a[204:207], v[20:23], v[48:63]
    s_cmp_eq_u32 s37, 0
    s_cbranch_scc1 Lch_102
    global_load_lds_dwordx4 v0, s[10:11] offset:2048 sc1
Lch_102:
    ds_read_b128 v[20:23], v1 offset:23552
    s_waitcnt lgkmcnt(3)
    v_mfma_f32_32x32x16_bf16 v[32:47], a[80:83], v[8:11], v[32:47]
    v_mfma_f32_32x32x16_bf16 v[48:63], a[208:211], v[8:11], v[48:63]
    s_cmp_eq_u32 s37, 0
    s_cbranch_scc1 Lch_103
    global_load_lds_dwordx4 v0, s[10:11] offset:3072 sc1
    s_add_u32 s10, s10, 16384
    s_addc_u32 s11, s11, 0
    s_mov_b32 s37, 0
Lch_103:
    ds_read_b128 v[8:11], v1 offset:24576
    s_waitcnt lgkmcnt(3)
    v_mfma_f32_32x32x16_bf16 v[32:47], a[84:87], v[12:15], v[32:47]
    v_mfma_f32_32x32x16_bf16 v[48:63], a[212:215], v[12:15], v[48:63]
    ds_read_b128 v[12:15], v1 offset:25600
    s_waitcnt lgkmcnt(3)
    v_mfma_f32_32x32x16_bf16 v[32:47], a[88:91], v[16:19], v[32:47]
    v_mfma_f32_32x32x16_bf16 v[48:63], a[216:219], v[16:19], v[48:63]
    ds_read_b128 v[16:19], v1 offset:26624
    s_waitcnt lgkmcnt(3)
    v_mfma_f32_32x32x16_bf16 v[32:47], a[92:95], v[20:23], v[32:47]
    v_mfma_f32_32x32x16_bf16 v[48:63], a[220:223], v[20:23], v[48:63]
    ds_read_b128 v[20:23], v1 offset:27648
    s_waitcnt lgkmcnt(3)
    v_mfma_f32_32x32x16_bf16 v[32:47], a[96:99], v[8:11], v[32:47]
    v_mfma_f32_32x32x16_bf16 v[48:63], a[224:227], v[8:11], v[48:63]
    s_cmp_lg_u32 s15, 0
    s_cbranch_scc1 Lhk_104
    s_waitcnt vmcnt(0)
    v_cmp_gt_u32 vcc, s14, v3
    s_cbranch_vccnz Lnr1_105
    s_add_u32 s17, s28, 0
    s_mov_b32 m0, s17
    s_nop 0
    global_load_lds_dwordx4 v0, s[10:11] offset:0 sc1
    global_load_lds_dwordx4 v0, s[10:11] offset:1024 sc1
    global_load_lds_dwordx4 v0, s[10:11] offset:2048 sc1
    global_load_lds_dwordx4 v0, s[10:11] offset:3072 sc1
    s_add_u32 s10, s10, 16384
    s_addc_u32 s11, s11, 0
    s_add_u32 s17, s28, 16384
    s_mov_b32 m0, s17
    s_nop 0
    global_load_lds_dwordx4 v0, s[10:11] offset:0 sc1
    global_load_lds_dwordx4 v0, s[10:11] offset:1024 sc1
    global_load_lds_dwordx4 v0, s[10:11] offset:2048 sc1
    global_load_lds_dwordx4 v0, s[10:11] offset:3072 sc1
    s_add_u32 s10, s10, 16384
    s_addc_u32 s11, s11, 0
    s_mov_b32 s15, 1
    s_branch Lhk_104
Lnr1_105:
    global_load_dword v3, v2, s[12:13] sc1
Lhk_104:
    ds_read_b128 v[8:11], v1 offset:28672
    s_waitcnt lgkmcnt(3)
    v_mfma_f32_32x32x16_bf16 v[32:47], a[100:103], v[12:15], v[32:47]
    v_mfma_f32_32x32x16_bf16 v[48:63], a[228:231], v[12:15], v[48:63]
    ds_read_b128 v[12:15], v1 offset:29696
    s_waitcnt lgkmcnt(3)
    v_mfma_f32_32x32x16_bf16 v[32:47], a[104:107], v[16:19], v[32:47]
    v_mfma_f32_32x32x16_bf16 v[48:63], a[232:235], v[16:19], v[48:63]
    ds_read_b128 v[16:19], v1 offset:30720
    s_waitcnt lgkmcnt(3)
    v_mfma_f32_32x32x16_bf16 v[32:47], a[108:111], v[20:23], v[32:47]
    v_mfma_f32_32x32x16_bf16 v[48:63], a[236:239], v[20:23], v[48:63]
    ds_read_b128 v[20:23], v1 offset:31744
    s_waitcnt lgkmcnt(3)
    v_mfma_f32_32x32x16_bf16 v[32:47], a[112:115], v[8:11], v[32:47]
    v_mfma_f32_32x32x16_bf16 v[48:63], a[240:243], v[8:11], v[48:63]
    s_waitcnt lgkmcnt(2)
    v_mfma_f32_32x32x16_bf16 v[32:47], a[116:119], v[12:15], v[32:47]
    v_mfma_f32_32x32x16_bf16 v[48:63], a[244:247], v[12:15], v[48:63]
    s_waitcnt lgkmcnt(1)
    v_mfma_f32_32x32x16_bf16 v[32:47], a[120:123], v[16:19], v[32:47]
    v_mfma_f32_32x32x16_bf16 v[48:63], a[248:251], v[16:19], v[48:63]
    s_waitcnt lgkmcnt(0)
    v_mfma_f32_32x32x16_bf16 v[32:47], a[124:127], v[20:23], v[32:47]
    v_mfma_f32_32x32x16_bf16 v[48:63], a[252:255], v[20:23], v[48:63]
    s_nop 11
    s_cmp_ge_u32 s19, 64
    s_cbranch_scc1 Law_106
    s_waitcnt vmcnt(8)
    s_branch Law2_107
Law_106:
    s_waitcnt vmcnt(0)
Law2_107:
    v_add_f32 v100, v100, v102
    v_add_f32 v101, v101, v103
    v_add_f32 v104, v104, v106
    v_add_f32 v105, v105, v107
    v_add_f32 v100, v100, v104
    v_add_f32 v101, v101, v105
    v_mov_b32 v102, v100
    v_mov_b32 v103, v101
    s_nop 1
    v_permlane32_swap_b32 v100, v102
    v_permlane32_swap_b32 v101, v103
    v_add_f32 v100, v100, v102
    v_add_f32 v101, v101, v103
    v_mul_f32 v100, 0x3b000000, v100
    v_mul_f32 v101, 0x3b000000, v101
    v_fma_f32 v101, -v100, v100, v101
    v_max_f32 v101, 0, v101
    v_add_f32 v101, 0x3727c5ac, v101
    v_rsq_f32 v96, v101
    s_nop 0
    v_mul_f32 v97, v100, v96
    v_pk_mul_f32 v[32:33], v[32:33], v[96:97] op_sel_hi:[1,0]
    v_pk_mul_f32 v[34:35], v[34:35], v[96:97] op_sel_hi:[1,0]
    v_pk_mul_f32 v[36:37], v[36:37], v[96:97] op_sel_hi:[1,0]
    v_pk_mul_f32 v[38:39], v[38:39], v[96:97] op_sel_hi:[1,0]
    v_pk_mul_f32 v[40:41], v[40:41], v[96:97] op_sel_hi:[1,0]
    v_pk_mul_f32 v[42:43], v[42:43], v[96:97] op_sel_hi:[1,0]
    v_pk_mul_f32 v[44:45], v[44:45], v[96:97] op_sel_hi:[1,0]
    v_pk_mul_f32 v[46:47], v[46:47], v[96:97] op_sel_hi:[1,0]
    v_pk_mul_f32 v[48:49], v[48:49], v[96:97] op_sel_hi:[1,0]
    v_pk_mul_f32 v[50:51], v[50:51], v[96:97] op_sel_hi:[1,0]
    v_pk_mul_f32 v[52:53], v[52:53], v[96:97] op_sel_hi:[1,0]
    v_pk_mul_f32 v[54:55], v[54:55], v[96:97] op_sel_hi:[1,0]
    v_pk_mul_f32 v[56:57], v[56:57], v[96:97] op_sel_hi:[1,0]
    v_pk_mul_f32 v[58:59], v[58:59], v[96:97] op_sel_hi:[1,0]
    v_pk_mul_f32 v[60:61], v[60:61], v[96:97] op_sel_hi:[1,0]
    v_pk_mul_f32 v[62:63], v[62:63], v[96:97] op_sel_hi:[1,0]
    v_pk_fma_f32 v[32:33], v[64:65], v[96:97], v[32:33] op_sel:[0,1,0] op_sel_hi:[1,1,1] neg_lo:[0,1,0] neg_hi:[0,1,0]
    v_pk_fma_f32 v[34:35], v[66:67], v[96:97], v[34:35] op_sel:[0,1,0] op_sel_hi:[1,1,1] neg_lo:[0,1,0] neg_hi:[0,1,0]
    v_pk_fma_f32 v[36:37], v[68:69], v[96:97], v[36:37] op_sel:[0,1,0] op_sel_hi:[1,1,1] neg_lo:[0,1,0] neg_hi:[0,1,0]
    v_pk_fma_f32 v[38:39], v[70:71], v[96:97], v[38:39] op_sel:[0,1,0] op_sel_hi:[1,1,1] neg_lo:[0,1,0] neg_hi:[0,1,0]
    v_pk_fma_f32 v[40:41], v[72:73], v[96:97], v[40:41] op_sel:[0,1,0] op_sel_hi:[1,1,1] neg_lo:[0,1,0] neg_hi:[0,1,0]
    v_pk_fma_f32 v[42:43], v[74:75], v[96:97], v[42:43] op_sel:[0,1,0] op_sel_hi:[1,1,1] neg_lo:[0,1,0] neg_hi:[0,1,0]
    v_pk_fma_f32 v[44:45], v[76:77], v[96:97], v[44:45] op_sel:[0,1,0] op_sel_hi:[1,1,1] neg_lo:[0,1,0] neg_hi:[0,1,0]
    v_pk_fma_f32 v[46:47], v[78:79], v[96:97], v[46:47] op_sel:[0,1,0] op_sel_hi:[1,1,1] neg_lo:[0,1,0] neg_hi:[0,1,0]
    v_pk_fma_f32 v[48:49], v[80:81], v[96:97], v[48:49] op_sel:[0,1,0] op_sel_hi:[1,1,1] neg_lo:[0,1,0] neg_hi:[0,1,0]
    v_pk_fma_f32 v[50:51], v[82:83], v[96:97], v[50:51] op_sel:[0,1,0] op_sel_hi:[1,1,1] neg_lo:[0,1,0] neg_hi:[0,1,0]
    v_pk_fma_f32 v[52:53], v[84:85], v[96:97], v[52:53] op_sel:[0,1,0] op_sel_hi:[1,1,1] neg_lo:[0,1,0] neg_hi:[0,1,0]
    v_pk_fma_f32 v[54:55], v[86:87], v[96:97], v[54:55] op_sel:[0,1,0] op_sel_hi:[1,1,1] neg_lo:[0,1,0] neg_hi:[0,1,0]
    v_pk_fma_f32 v[56:57], v[88:89], v[96:97], v[56:57] op_sel:[0,1,0] op_sel_hi:[1,1,1] neg_lo:[0,1,0] neg_hi:[0,1,0]
    v_pk_fma_f32 v[58:59], v[90:91], v[96:97], v[58:59] op_sel:[0,1,0] op_sel_hi:[1,1,1] neg_lo:[0,1,0] neg_hi:[0,1,0]
    v_pk_fma_f32 v[60:61], v[92:93], v[96:97], v[60:61] op_sel:[0,1,0] op_sel_hi:[1,1,1] neg_lo:[0,1,0] neg_hi:[0,1,0]
    v_pk_fma_f32 v[62:63], v[94:95], v[96:97], v[62:63] op_sel:[0,1,0] op_sel_hi:[1,1,1] neg_lo:[0,1,0] neg_hi:[0,1,0]
    s_cmp_lg_u32 s15, 0
    s_cbranch_scc1 Lhk_108
    s_waitcnt vmcnt(0)
    v_cmp_gt_u32 vcc, s14, v3
    s_cbranch_vccnz Lnr2_109
    s_mov_b32 s37, 2
    s_branch Lhk_108
Lnr2_109:
    global_load_dword v3, v2, s[12:13] sc1
Lhk_108:
    v_cvt_pk_bf16_f32 v100, v32, v33
    v_cvt_pk_bf16_f32 v101, v34, v35
    v_cvt_pk_bf16_f32 v102, v36, v37
    v_cvt_pk_bf16_f32 v103, v38, v39
    s_nop 1
    v_permlane32_swap_b32 v100, v102
    v_permlane32_swap_b32 v101, v103
    global_store_dwordx4 v0, v[100:103], s[20:21] offset:0 sc1
    v_cvt_pk_bf16_f32 v104, v40, v41
    v_cvt_pk_bf16_f32 v105, v42, v43
    v_cvt_pk_bf16_f32 v106, v44, v45
    v_cvt_pk_bf16_f32 v107, v46, v47
    s_nop 1
    v_permlane32_swap_b32 v104, v106
    v_permlane32_swap_b32 v105, v107
    global_store_dwordx4 v0, v[104:107], s[20:21] offset:1024 sc1
    v_cvt_pk_bf16_f32 v108, v48, v49
    v_cvt_pk_bf16_f32 v109, v50, v51
    v_cvt_pk_bf16_f32 v110, v52, v53
    v_cvt_pk_bf16_f32 v111, v54, v55
    s_nop 1
    v_permlane32_swap_b32 v108, v110
    v_permlane32_swap_b32 v109, v111
    global_store_dwordx4 v0, v[108:111], s[20:21] offset:2048 sc1
    v_cvt_pk_bf16_f32 v112, v56, v57
    v_cvt_pk_bf16_f32 v113, v58, v59
    v_cvt_pk_bf16_f32 v114, v60, v61
    v_cvt_pk_bf16_f32 v115, v62, v63
    s_nop 1
    v_permlane32_swap_b32 v112, v114
    v_permlane32_swap_b32 v113, v115
    global_store_dwordx4 v0, v[112:115], s[20:21] offset:3072 sc1
    s_add_u32 s20, s20, 262144
    s_addc_u32 s21, s21, 0
    s_add_u32 s7, s7, 1
    s_cmp_lg_u32 s15, 0
    s_cbranch_scc1 Lh3_113
    s_cmp_eq_u32 s37, 2
    s_cbranch_scc1 Lh3_113
    s_waitcnt vmcnt(4)
    v_cmp_gt_u32 vcc, s14, v3
    s_cbranch_vccnz Lh3_113
    s_mov_b32 s37, 2
Lh3_113:
    s_cmp_lg_u32 s37, 2
    s_cbranch_scc1 Lng2_112
    s_add_u32 s17, s28, 0
    s_mov_b32 m0, s17
    s_nop 0
    global_load_lds_dwordx4 v0, s[10:11] offset:0 sc1
    global_load_lds_dwordx4 v0, s[10:11] offset:1024 sc1
    global_load_lds_dwordx4 v0, s[10:11] offset:2048 sc1
    global_load_lds_dwordx4 v0, s[10:11] offset:3072 sc1
    s_add_u32 s10, s10, 16384
    s_addc_u32 s11, s11, 0
    s_add_u32 s17, s28, 16384
    s_mov_b32 m0, s17
    s_nop 0
    global_load_lds_dwordx4 v0, s[10:11] offset:0 sc1
    global_load_lds_dwordx4 v0, s[10:11] offset:1024 sc1
    global_load_lds_dwordx4 v0, s[10:11] offset:2048 sc1
    global_load_lds_dwordx4 v0, s[10:11] offset:3072 sc1
    s_add_u32 s10, s10, 16384
    s_addc_u32 s11, s11, 0
    s_mov_b32 s37, 0
    s_waitcnt vmcnt(8)
    v_mov_b32 v3, s7
    s_mov_b64 exec, 1
    global_store_dword v0, v3, s[26:27] sc1
    s_mov_b64 exec, -1
Lpub_114:
    s_waitcnt vmcnt(5)
    s_branch Ljoin_111
Lng2_112:
    s_cmp_ge_u32 s7, 64
    s_cbranch_scc1 Llate_110
    s_cmp_eq_u32 s15, 0
    s_cbranch_scc1 Llate_110
    s_waitcnt vmcnt(4)
    s_mov_b32 s35, 1
    s_branch Ljoin_111
Llate_110:
    s_waitcnt vmcnt(0)
    v_mov_b32 v3, s7
    s_mov_b64 exec, 1
    global_store_dword v0, v3, s[26:27] sc1
    s_mov_b64 exec, -1
Lpub_115:
    s_cmp_ge_u32 s7, 64
    s_cbranch_scc1 Ljoin_111
    s_mov_b32 s16, 0
Lp_116:
    global_load_dword v3, v2, s[12:13] sc1
    s_add_u32 s16, s16, 1
    s_cmp_gt_u32 s16, 262144
    s_cbranch_scc1 LtoT3q_86
    s_waitcnt vmcnt(0)
    v_cmp_gt_u32 vcc, s14, v3
    s_cbranch_vccnz Lp_116
    s_add_u32 s17, s28, 0
    s_mov_b32 m0, s17
    s_nop 0
    global_load_lds_dwordx4 v0, s[10:11] offset:0 sc1
    global_load_lds_dwordx4 v0, s[10:11] offset:1024 sc1
    global_load_lds_dwordx4 v0, s[10:11] offset:2048 sc1
    global_load_lds_dwordx4 v0, s[10:11] offset:3072 sc1
    s_add_u32 s10, s10, 16384
    s_addc_u32 s11, s11, 0
    s_add_u32 s17, s28, 16384
    s_mov_b32 m0, s17
    s_nop 0
    global_load_lds_dwordx4 v0, s[10:11] offset:0 sc1
    global_load_lds_dwordx4 v0, s[10:11] offset:1024 sc1
    global_load_lds_dwordx4 v0, s[10:11] offset:2048 sc1
    global_load_lds_dwordx4 v0, s[10:11] offset:3072 sc1
    s_add_u32 s10, s10, 16384
    s_addc_u32 s11, s11, 0
    s_waitcnt vmcnt(4)
Ljoin_111:
    s_barrier
    s_cmp_lt_u32 s7, 64
    s_cbranch_scc1 LitT3q_87
    s_waitcnt vmcnt(0)
    s_endpgm
LtoT3q_86:
    s_load_dwordx2 s[30:31], s[0:1], 88
    s_waitcnt lgkmcnt(0)
    s_mov_b64 exec, 1
    v_mov_b32 v2, 144
    v_mov_b32 v3, s7
    v_add_u32 v3, 0x10000, v3
    global_store_dword v2, v3, s[30:31] sc1
    s_waitcnt vmcnt(0)
    s_endpgm
ROLE_T3v:
    s_lshr_b32 s34, s4, 4
    s_and_b32 s17, s4, 15
    s_lshl_b32 s17, s17, 1
    s_lshr_b32 s18, s5, 1
    s_add_u32 s33, s17, s18
    v_and_b32 v40, 63, v0
    v_and_b32 v41, 31, v40
    v_lshrrev_b32 v42, 5, v40
    v_and_b32 v43, 15, v40
    v_lshrrev_b32 v44, 4, v40
    s_cmp_lg_u32 s6, 0
    s_cbranch_scc1 Lwsg_119
    s_branch Lws_117
Lwsg_119:
    s_load_dwordx2 s[30:31], s[0:1], 88
    s_mov_b32 s14, 1
    s_mov_b32 s7, 0
    v_mov_b32 v2, 248
    s_waitcnt lgkmcnt(0)
    s_mov_b32 s16, 0
Lp_122:
    global_load_dword v3, v2, s[30:31] sc1
    s_add_u32 s16, s16, 1
    s_cmp_gt_u32 s16, 262144
    s_cbranch_scc1 Lwito_120
    s_waitcnt vmcnt(0)
    v_cmp_gt_u32 vcc, s14, v3
    s_cbranch_vccnz Lp_122
    s_branch Lwisk_121
Lwito_120:
    s_load_dwordx2 s[30:31], s[0:1], 88
    s_waitcnt lgkmcnt(0)
    s_mov_b64 exec, 1
    v_mov_b32 v2, 176
    v_mov_b32 v3, s7
    v_add_u32 v3, 0x10000, v3
    global_store_dword v2, v3, s[30:31] sc1
    s_waitcnt vmcnt(0)
    s_endpgm
Lwisk_121:
    v_mov_b32 v2, 0
    s_mov_b32 s12, s8
    s_mov_b32 s13, s9
    s_mov_b32 s14, 1
    s_mov_b32 s7, 0
    s_mov_b32 s16, 0
Lp_123:
    global_load_dword v3, v2, s[12:13] sc1
    s_add_u32 s16, s16, 1
    s_cmp_gt_u32 s16, 262144
    s_cbranch_scc1 Lwsto_118
    s_waitcnt vmcnt(0)
    v_cmp_gt_u32 vcc, s14, v3
    s_cbranch_vccnz Lp_123
    s_branch Lws_117
Lwsto_118:
    s_load_dwordx2 s[30:31], s[0:1], 88
    s_waitcnt lgkmcnt(0)
    s_mov_b64 exec, 1
    v_mov_b32 v2, 168
    v_mov_b32 v3, s7
    v_add_u32 v3, 0x10000, v3
    global_store_dword v2, v3, s[30:31] sc1
    s_waitcnt vmcnt(0)
    s_endpgm
Lws_117:
    v_lshrrev_b32 v45, 3, v40
    v_mul_u32_u24 v45, 8192, v45
    v_and_b32 v46, 7, v40
    v_lshl_add_u32 v45, v46, 4, v45
    v_lshrrev_b32 v46, 2, v43
    v_lshl_add_u32 v46, v42, 3, v46
    v_lshlrev_b32 v46, 7, v46
    v_and_b32 v47, 1, v44
    v_lshl_add_u32 v46, v47, 5, v46
    v_and_b32 v47, 3, v43
    v_lshl_add_u32 v46, v47, 3, v46
    s_lshl_b32 s18, s5, 15
    v_add_u32 v46, s18, v46
    s_load_dwordx2 s[30:31], s[0:1], 56
    s_lshl_b32 s17, s33, 8
    s_and_b32 s18, s5, 1
    s_lshl_b32 s18, s18, 7
    s_add_u32 s17, s17, s18
    s_add_u32 s17, s17, 0
    s_lshl_b32 s19, s5, 15
    s_waitcnt lgkmcnt(0)
    s_add_u32 s30, s30, s17
    s_addc_u32 s31, s31, 0
    s_mov_b32 m0, s19
    s_add_u32 s19, s19, 1024
    global_load_lds_dwordx4 v45, s[30:31]
    s_add_u32 s30, s30, 65536
    s_addc_u32 s31, s31, 0
    s_mov_b32 m0, s19
    s_add_u32 s19, s19, 1024
    global_load_lds_dwordx4 v45, s[30:31]
    s_add_u32 s30, s30, 65536
    s_addc_u32 s31, s31, 0
    s_mov_b32 m0, s19
    s_add_u32 s19, s19, 1024
    global_load_lds_dwordx4 v45, s[30:31]
    s_add_u32 s30, s30, 65536
    s_addc_u32 s31, s31, 0
    s_mov_b32 m0, s19
    s_add_u32 s19, s19, 1024
    global_load_lds_dwordx4 v45, s[30:31]
    s_add_u32 s30, s30, 65536
    s_addc_u32 s31, s31, 0
    s_mov_b32 m0, s19
    s_add_u32 s19, s19, 1024
    global_load_lds_dwordx4 v45, s[30:31]
    s_add_u32 s30, s30, 65536
    s_addc_u32 s31, s31, 0
    s_mov_b32 m0, s19
    s_add_u32 s19, s19, 1024
    global_load_lds_dwordx4 v45, s[30:31]
    s_add_u32 s30, s30, 65536
    s_addc_u32 s31, s31, 0
    s_mov_b32 m0, s19
    s_add_u32 s19, s19, 1024
    global_load_lds_dwordx4 v45, s[30:31]
    s_add_u32 s30, s30, 65536
    s_addc_u32 s31, s31, 0
    s_mov_b32 m0, s19
    s_add_u32 s19, s19, 1024
    global_load_lds_dwordx4 v45, s[30:31]
    s_add_u32 s30, s30, 65536
    s_addc_u32 s31, s31, 0
    s_mov_b32 m0, s19
    s_add_u32 s19, s19, 1024
    global_load_lds_dwordx4 v45, s[30:31]
    s_add_u32 s30, s30, 65536
    s_addc_u32 s31, s31, 0
    s_mov_b32 m0, s19
    s_add_u32 s19, s19, 1024
    global_load_lds_dwordx4 v45, s[30:31]
    s_add_u32 s30, s30, 65536
    s_addc_u32 s31, s31, 0
    s_mov_b32 m0, s19
    s_add_u32 s19, s19, 1024
    global_load_lds_dwordx4 v45, s[30:31]
    s_add_u32 s30, s30, 65536
    s_addc_u32 s31, s31, 0
    s_mov_b32 m0, s19
    s_add_u32 s19, s19, 1024
    global_load_lds_dwordx4 v45, s[30:31]
    s_add_u32 s30, s30, 65536
    s_addc_u32 s31, s31, 0
    s_mov_b32 m0, s19
    s_add_u32 s19, s19, 1024
    global_load_lds_dwordx4 v45, s[30:31]
    s_add_u32 s30, s30, 65536
    s_addc_u32 s31, s31, 0
    s_mov_b32 m0, s19
    s_add_u32 s19, s19, 1024
    global_load_lds_dwordx4 v45, s[30:31]
    s_add_u32 s30, s30, 65536
    s_addc_u32 s31, s31, 0
    s_mov_b32 m0, s19
    s_add_u32 s19, s19, 1024
    global_load_lds_dwordx4 v45, s[30:31]
    s_add_u32 s30, s30, 65536
    s_addc_u32 s31, s31, 0
    s_mov_b32 m0, s19
    s_add_u32 s19, s19, 1024
    global_load_lds_dwordx4 v45, s[30:31]
    s_add_u32 s30, s30, 65536
    s_addc_u32 s31, s31, 0
    s_mov_b32 m0, s19
    s_add_u32 s19, s19, 1024
    global_load_lds_dwordx4 v45, s[30:31]
    s_add_u32 s30, s30, 65536
    s_addc_u32 s31, s31, 0
    s_mov_b32 m0, s19
    s_add_u32 s19, s19, 1024
    global_load_lds_dwordx4 v45, s[30:31]
    s_add_u32 s30, s30, 65536
    s_addc_u32 s31, s31, 0
    s_mov_b32 m0, s19
    s_add_u32 s19, s19, 1024
    global_load_lds_dwordx4 v45, s[30:31]
    s_add_u32 s30, s30, 65536
    s_addc_u32 s31, s31, 0
    s_mov_b32 m0, s19
    s_add_u32 s19, s19, 1024
    global_load_lds_dwordx4 v45, s[30:31]
    s_add_u32 s30, s30, 65536
    s_addc_u32 s31, s31, 0
    s_mov_b32 m0, s19
    s_add_u32 s19, s19, 1024
    global_load_lds_dwordx4 v45, s[30:31]
    s_add_u32 s30, s30, 65536
    s_addc_u32 s31, s31, 0
    s_mov_b32 m0, s19
    s_add_u32 s19, s19, 1024
    global_load_lds_dwordx4 v45, s[30:31]
    s_add_u32 s30, s30, 65536
    s_addc_u32 s31, s31, 0
    s_mov_b32 m0, s19
    s_add_u32 s19, s19, 1024
    global_load_lds_dwordx4 v45, s[30:31]
    s_add_u32 s30, s30, 65536
    s_addc_u32 s31, s31, 0
    s_mov_b32 m0, s19
    s_add_u32 s19, s19, 1024
    global_load_lds_dwordx4 v45, s[30:31]
    s_add_u32 s30, s30, 65536
    s_addc_u32 s31, s31, 0
    s_mov_b32 m0, s19
    s_add_u32 s19, s19, 1024
    global_load_lds_dwordx4 v45, s[30:31]
    s_add_u32 s30, s30, 65536
    s_addc_u32 s31, s31, 0
    s_mov_b32 m0, s19
    s_add_u32 s19, s19, 1024
    global_load_lds_dwordx4 v45, s[30:31]
    s_add_u32 s30, s30, 65536
    s_addc_u32 s31, s31, 0
    s_mov_b32 m0, s19
    s_add_u32 s19, s19, 1024
    global_load_lds_dwordx4 v45, s[30:31]
    s_add_u32 s30, s30, 65536
    s_addc_u32 s31, s31, 0
    s_mov_b32 m0, s19
    s_add_u32 s19, s19, 1024
    global_load_lds_dwordx4 v45, s[30:31]
    s_add_u32 s30, s30, 65536
    s_addc_u32 s31, s31, 0
    s_mov_b32 m0, s19
    s_add_u32 s19, s19, 1024
    global_load_lds_dwordx4 v45, s[30:31]
    s_add_u32 s30, s30, 65536
    s_addc_u32 s31, s31, 0
    s_mov_b32 m0, s19
    s_add_u32 s19, s19, 1024
    global_load_lds_dwordx4 v45, s[30:31]
    s_add_u32 s30, s30, 65536
    s_addc_u32 s31, s31, 0
    s_mov_b32 m0, s19
    s_add_u32 s19, s19, 1024
    global_load_lds_dwordx4 v45, s[30:31]
    s_add_u32 s30, s30, 65536
    s_addc_u32 s31, s31, 0
    s_mov_b32 m0, s19
    s_add_u32 s19, s19, 1024
    global_load_lds_dwordx4 v45, s[30:31]
    s_add_u32 s30, s30, 65536
    s_addc_u32 s31, s31, 0
    s_waitcnt vmcnt(0)
    ds_read_b64_tr_b16 a[0:1], v46 offset:0
    ds_read_b64_tr_b16 a[2:3], v46 offset:512
    ds_read_b64_tr_b16 a[128:129], v46 offset:64
    ds_read_b64_tr_b16 a[130:131], v46 offset:576
    ds_read_b64_tr_b16 a[4:5], v46 offset:2048
    ds_read_b64_tr_b16 a[6:7], v46 offset:2560
    ds_read_b64_tr_b16 a[132:133], v46 offset:2112
    ds_read_b64_tr_b16 a[134:135], v46 offset:2624
    s_waitcnt lgkmcnt(0)
    ds_read_b64_tr_b16 a[8:9], v46 offset:4096
    ds_read_b64_tr_b16 a[10:11], v46 offset:4608
    ds_read_b64_tr_b16 a[136:137], v46 offset:4160
    ds_read_b64_tr_b16 a[138:139], v46 offset:4672
    ds_read_b64_tr_b16 a[12:13], v46 offset:6144
    ds_read_b64_tr_b16 a[14:15], v46 offset:6656
    ds_read_b64_tr_b16 a[140:141], v46 offset:6208
    ds_read_b64_tr_b16 a[142:143], v46 offset:6720
    s_waitcnt lgkmcnt(0)
    ds_read_b64_tr_b16 a[16:17], v46 offset:8192
    ds_read_b64_tr_b16 a[18:19], v46 offset:8704
    ds_read_b64_tr_b16 a[144:145], v46 offset:8256
    ds_read_b64_tr_b16 a[146:147], v46 offset:8768
    ds_read_b64_tr_b16 a[20:21], v46 offset:10240
    ds_read_b64_tr_b16 a[22:23], v46 offset:10752
    ds_read_b64_tr_b16 a[148:149], v46 offset:10304
    ds_read_b64_tr_b16 a[150:151], v46 offset:10816
    s_waitcnt lgkmcnt(0)
    ds_read_b64_tr_b16 a[24:25], v46 offset:12288
    ds_read_b64_tr_b16 a[26:27], v46 offset:12800
    ds_read_b64_tr_b16 a[152:153], v46 offset:12352
    ds_read_b64_tr_b16 a[154:155], v46 offset:12864
    ds_read_b64_tr_b16 a[28:29], v46 offset:14336
    ds_read_b64_tr_b16 a[30:31], v46 offset:14848
    ds_read_b64_tr_b16 a[156:157], v46 offset:14400
    ds_read_b64_tr_b16 a[158:159], v46 offset:14912
    s_waitcnt lgkmcnt(0)
    ds_read_b64_tr_b16 a[32:33], v46 offset:16384
    ds_read_b64_tr_b16 a[34:35], v46 offset:16896
    ds_read_b64_tr_b16 a[160:161], v46 offset:16448
    ds_read_b64_tr_b16 a[162:163], v46 offset:16960
    ds_read_b64_tr_b16 a[36:37], v46 offset:18432
    ds_read_b64_tr_b16 a[38:39], v46 offset:18944
    ds_read_b64_tr_b16 a[164:165], v46 offset:18496
    ds_read_b64_tr_b16 a[166:167], v46 offset:19008
    s_waitcnt lgkmcnt(0)
    ds_read_b64_tr_b16 a[40:41], v46 offset:20480
    ds_read_b64_tr_b16 a[42:43], v46 offset:20992
    ds_read_b64_tr_b16 a[168:169], v46 offset:20544
    ds_read_b64_tr_b16 a[170:171], v46 offset:21056
    ds_read_b64_tr_b16 a[44:45], v46 offset:22528
    ds_read_b64_tr_b16 a[46:47], v46 offset:23040
    ds_read_b64_tr_b16 a[172:173], v46 offset:22592
    ds_read_b64_tr_b16 a[174:175], v46 offset:23104
    s_waitcnt lgkmcnt(0)
    ds_read_b64_tr_b16 a[48:49], v46 offset:24576
    ds_read_b64_tr_b16 a[50:51], v46 offset:25088
    ds_read_b64_tr_b16 a[176:177], v46 offset:24640
    ds_read_b64_tr_b16 a[178:179], v46 offset:25152
    ds_read_b64_tr_b16 a[52:53], v46 offset:26624
    ds_read_b64_tr_b16 a[54:55], v46 offset:27136
    ds_read_b64_tr_b16 a[180:181], v46 offset:26688
    ds_read_b64_tr_b16 a[182:183], v46 offset:27200
    s_waitcnt lgkmcnt(0)
    ds_read_b64_tr_b16 a[56:57], v46 offset:28672
    ds_read_b64_tr_b16 a[58:59], v46 offset:29184
    ds_read_b64_tr_b16 a[184:185], v46 offset:28736
    ds_read_b64_tr_b16 a[186:187], v46 offset:29248
    ds_read_b64_tr_b16 a[60:61], v46 offset:30720
    ds_read_b64_tr_b16 a[62:63], v46 offset:31232
    ds_read_b64_tr_b16 a[188:189], v46 offset:30784
    ds_read_b64_tr_b16 a[190:191], v46 offset:31296
    s_waitcnt lgkmcnt(0)
    s_waitcnt lgkmcnt(0)
    s_load_dwordx2 s[30:31], s[0:1], 56
    s_lshl_b32 s17, s33, 8
    s_and_b32 s18, s5, 1
    s_lshl_b32 s18, s18, 7
    s_add_u32 s17, s17, s18
    s_add_u32 s17, s17, 2097152
    s_lshl_b32 s19, s5, 15
    s_waitcnt lgkmcnt(0)
    s_add_u32 s30, s30, s17
    s_addc_u32 s31, s31, 0
    s_mov_b32 m0, s19
    s_add_u32 s19, s19, 1024
    global_load_lds_dwordx4 v45, s[30:31]
    s_add_u32 s30, s30, 65536
    s_addc_u32 s31, s31, 0
    s_mov_b32 m0, s19
    s_add_u32 s19, s19, 1024
    global_load_lds_dwordx4 v45, s[30:31]
    s_add_u32 s30, s30, 65536
    s_addc_u32 s31, s31, 0
    s_mov_b32 m0, s19
    s_add_u32 s19, s19, 1024
    global_load_lds_dwordx4 v45, s[30:31]
    s_add_u32 s30, s30, 65536
    s_addc_u32 s31, s31, 0
    s_mov_b32 m0, s19
    s_add_u32 s19, s19, 1024
    global_load_lds_dwordx4 v45, s[30:31]
    s_add_u32 s30, s30, 65536
    s_addc_u32 s31, s31, 0
    s_mov_b32 m0, s19
    s_add_u32 s19, s19, 1024
    global_load_lds_dwordx4 v45, s[30:31]
    s_add_u32 s30, s30, 65536
    s_addc_u32 s31, s31, 0
    s_mov_b32 m0, s19
    s_add_u32 s19, s19, 1024
    global_load_lds_dwordx4 v45, s[30:31]
    s_add_u32 s30, s30, 65536
    s_addc_u32 s31, s31, 0
    s_mov_b32 m0, s19
    s_add_u32 s19, s19, 1024
    global_load_lds_dwordx4 v45, s[30:31]
    s_add_u32 s30, s30, 65536
    s_addc_u32 s31, s31, 0
    s_mov_b32 m0, s19
    s_add_u32 s19, s19, 1024
    global_load_lds_dwordx4 v45, s[30:31]
    s_add_u32 s30, s30, 65536
    s_addc_u32 s31, s31, 0
    s_mov_b32 m0, s19
    s_add_u32 s19, s19, 1024
    global_load_lds_dwordx4 v45, s[30:31]
    s_add_u32 s30, s30, 65536
    s_addc_u32 s31, s31, 0
    s_mov_b32 m0, s19
    s_add_u32 s19, s19, 1024
    global_load_lds_dwordx4 v45, s[30:31]
    s_add_u32 s30, s30, 65536
    s_addc_u32 s31, s31, 0
    s_mov_b32 m0, s19
    s_add_u32 s19, s19, 1024
    global_load_lds_dwordx4 v45, s[30:31]
    s_add_u32 s30, s30, 65536
    s_addc_u32 s31, s31, 0
    s_mov_b32 m0, s19
    s_add_u32 s19, s19, 1024
    global_load_lds_dwordx4 v45, s[30:31]
    s_add_u32 s30, s30, 65536
    s_addc_u32 s31, s31, 0
    s_mov_b32 m0, s19
    s_add_u32 s19, s19, 1024
    global_load_lds_dwordx4 v45, s[30:31]
    s_add_u32 s30, s30, 65536
    s_addc_u32 s31, s31, 0
    s_mov_b32 m0, s19
    s_add_u32 s19, s19, 1024
    global_load_lds_dwordx4 v45, s[30:31]
    s_add_u32 s30, s30, 65536
    s_addc_u32 s31, s31, 0
    s_mov_b32 m0, s19
    s_add_u32 s19, s19, 1024
    global_load_lds_dwordx4 v45, s[30:31]
    s_add_u32 s30, s30, 65536
    s_addc_u32 s31, s31, 0
    s_mov_b32 m0, s19
    s_add_u32 s19, s19, 1024
    global_load_lds_dwordx4 v45, s[30:31]
    s_add_u32 s30, s30, 65536
    s_addc_u32 s31, s31, 0
    s_mov_b32 m0, s19
    s_add_u32 s19, s19, 1024
    global_load_lds_dwordx4 v45, s[30:31]
    s_add_u32 s30, s30, 65536
    s_addc_u32 s31, s31, 0
    s_mov_b32 m0, s19
    s_add_u32 s19, s19, 1024
    global_load_lds_dwordx4 v45, s[30:31]
    s_add_u32 s30, s30, 65536
    s_addc_u32 s31, s31, 0
    s_mov_b32 m0, s19
    s_add_u32 s19, s19, 1024
    global_load_lds_dwordx4 v45, s[30:31]
    s_add_u32 s30, s30, 65536
    s_addc_u32 s31, s31, 0
    s_mov_b32 m0, s19
    s_add_u32 s19, s19, 1024
    global_load_lds_dwordx4 v45, s[30:31]
    s_add_u32 s30, s30, 65536
    s_addc_u32 s31, s31, 0
    s_mov_b32 m0, s19
    s_add_u32 s19, s19, 1024
    global_load_lds_dwordx4 v45, s[30:31]
    s_add_u32 s30, s30, 65536
    s_addc_u32 s31, s31, 0
    s_mov_b32 m0, s19
    s_add_u32 s19, s19, 1024
    global_load_lds_dwordx4 v45, s[30:31]
    s_add_u32 s30, s30, 65536
    s_addc_u32 s31, s31, 0
    s_mov_b32 m0, s19
    s_add_u32 s19, s19, 1024
    global_load_lds_dwordx4 v45, s[30:31]
    s_add_u32 s30, s30, 65536
    s_addc_u32 s31, s31, 0
    s_mov_b32 m0, s19
    s_add_u32 s19, s19, 1024
    global_load_lds_dwordx4 v45, s[30:31]
    s_add_u32 s30, s30, 65536
    s_addc_u32 s31, s31, 0
    s_mov_b32 m0, s19
    s_add_u32 s19, s19, 1024
    global_load_lds_dwordx4 v45, s[30:31]
    s_add_u32 s30, s30, 65536
    s_addc_u32 s31, s31, 0
    s_mov_b32 m0, s19
    s_add_u32 s19, s19, 1024
    global_load_lds_dwordx4 v45, s[30:31]
    s_add_u32 s30, s30, 65536
    s_addc_u32 s31, s31, 0
    s_mov_b32 m0, s19
    s_add_u32 s19, s19, 1024
    global_load_lds_dwordx4 v45, s[30:31]
    s_add_u32 s30, s30, 65536
    s_addc_u32 s31, s31, 0
    s_mov_b32 m0, s19
    s_add_u32 s19, s19, 1024
    global_load_lds_dwordx4 v45, s[30:31]
    s_add_u32 s30, s30, 65536
    s_addc_u32 s31, s31, 0
    s_mov_b32 m0, s19
    s_add_u32 s19, s19, 1024
    global_load_lds_dwordx4 v45, s[30:31]
    s_add_u32 s30, s30, 65536
    s_addc_u32 s31, s31, 0
    s_mov_b32 m0, s19
    s_add_u32 s19, s19, 1024
    global_load_lds_dwordx4 v45, s[30:31]
    s_add_u32 s30, s30, 65536
    s_addc_u32 s31, s31, 0
    s_mov_b32 m0, s19
    s_add_u32 s19, s19, 1024
    global_load_lds_dwordx4 v45, s[30:31]
    s_add_u32 s30, s30, 65536
    s_addc_u32 s31, s31, 0
    s_mov_b32 m0, s19
    s_add_u32 s19, s19, 1024
    global_load_lds_dwordx4 v45, s[30:31]
    s_add_u32 s30, s30, 65536
    s_addc_u32 s31, s31, 0
    s_waitcnt vmcnt(0)
    ds_read_b64_tr_b16 a[64:65], v46 offset:0
    ds_read_b64_tr_b16 a[66:67], v46 offset:512
    ds_read_b64_tr_b16 a[192:193], v46 offset:64
    ds_read_b64_tr_b16 a[194:195], v46 offset:576
    ds_read_b64_tr_b16 a[68:69], v46 offset:2048
    ds_read_b64_tr_b16 a[70:71], v46 offset:2560
    ds_read_b64_tr_b16 a[196:197], v46 offset:2112
    ds_read_b64_tr_b16 a[198:199], v46 offset:2624
    s_waitcnt lgkmcnt(0)
    ds_read_b64_tr_b16 a[72:73], v46 offset:4096
    ds_read_b64_tr_b16 a[74:75], v46 offset:4608
    ds_read_b64_tr_b16 a[200:201], v46 offset:4160
    ds_read_b64_tr_b16 a[202:203], v46 offset:4672
    ds_read_b64_tr_b16 a[76:77], v46 offset:6144
    ds_read_b64_tr_b16 a[78:79], v46 offset:6656
    ds_read_b64_tr_b16 a[204:205], v46 offset:6208
    ds_read_b64_tr_b16 a[206:207], v46 offset:6720
    s_waitcnt lgkmcnt(0)
    ds_read_b64_tr_b16 a[80:81], v46 offset:8192
    ds_read_b64_tr_b16 a[82:83], v46 offset:8704
    ds_read_b64_tr_b16 a[208:209], v46 offset:8256
    ds_read_b64_tr_b16 a[210:211], v46 offset:8768
    ds_read_b64_tr_b16 a[84:85], v46 offset:10240
    ds_read_b64_tr_b16 a[86:87], v46 offset:10752
    ds_read_b64_tr_b16 a[212:213], v46 offset:10304
    ds_read_b64_tr_b16 a[214:215], v46 offset:10816
    s_waitcnt lgkmcnt(0)
    ds_read_b64_tr_b16 a[88:89], v46 offset:12288
    ds_read_b64_tr_b16 a[90:91], v46 offset:12800
    ds_read_b64_tr_b16 a[216:217], v46 offset:12352
    ds_read_b64_tr_b16 a[218:219], v46 offset:12864
    ds_read_b64_tr_b16 a[92:93], v46 offset:14336
    ds_read_b64_tr_b16 a[94:95], v46 offset:14848
    ds_read_b64_tr_b16 a[220:221], v46 offset:14400
    ds_read_b64_tr_b16 a[222:223], v46 offset:14912
    s_waitcnt lgkmcnt(0)
    ds_read_b64_tr_b16 a[96:97], v46 offset:16384
    ds_read_b64_tr_b16 a[98:99], v46 offset:16896
    ds_read_b64_tr_b16 a[224:225], v46 offset:16448
    ds_read_b64_tr_b16 a[226:227], v46 offset:16960
    ds_read_b64_tr_b16 a[100:101], v46 offset:18432
    ds_read_b64_tr_b16 a[102:103], v46 offset:18944
    ds_read_b64_tr_b16 a[228:229], v46 offset:18496
    ds_read_b64_tr_b16 a[230:231], v46 offset:19008
    s_waitcnt lgkmcnt(0)
    ds_read_b64_tr_b16 a[104:105], v46 offset:20480
    ds_read_b64_tr_b16 a[106:107], v46 offset:20992
    ds_read_b64_tr_b16 a[232:233], v46 offset:20544
    ds_read_b64_tr_b16 a[234:235], v46 offset:21056
    ds_read_b64_tr_b16 a[108:109], v46 offset:22528
    ds_read_b64_tr_b16 a[110:111], v46 offset:23040
    ds_read_b64_tr_b16 a[236:237], v46 offset:22592
    ds_read_b64_tr_b16 a[238:239], v46 offset:23104
    s_waitcnt lgkmcnt(0)
    ds_read_b64_tr_b16 a[112:113], v46 offset:24576
    ds_read_b64_tr_b16 a[114:115], v46 offset:25088
    ds_read_b64_tr_b16 a[240:241], v46 offset:24640
    ds_read_b64_tr_b16 a[242:243], v46 offset:25152
    ds_read_b64_tr_b16 a[116:117], v46 offset:26624
    ds_read_b64_tr_b16 a[118:119], v46 offset:27136
    ds_read_b64_tr_b16 a[244:245], v46 offset:26688
    ds_read_b64_tr_b16 a[246:247], v46 offset:27200
    s_waitcnt lgkmcnt(0)
    ds_read_b64_tr_b16 a[120:121], v46 offset:28672
    ds_read_b64_tr_b16 a[122:123], v46 offset:29184
    ds_read_b64_tr_b16 a[248:249], v46 offset:28736
    ds_read_b64_tr_b16 a[250:251], v46 offset:29248
    ds_read_b64_tr_b16 a[124:125], v46 offset:30720
    ds_read_b64_tr_b16 a[126:127], v46 offset:31232
    ds_read_b64_tr_b16 a[252:253], v46 offset:30784
    ds_read_b64_tr_b16 a[254:255], v46 offset:31296
    s_waitcnt lgkmcnt(0)
    s_waitcnt lgkmcnt(0)
    v_mov_b32 v8, 1065369472
    v_mov_b32 v9, 1065369472
    v_mov_b32 v10, 1065369472
    v_mov_b32 v11, 1065369472
    s_nop 1
    v_mfma_f32_32x32x16_bf16 v[64:79], v[8:11], a[0:3], 0
    v_mfma_f32_32x32x16_bf16 v[80:95], v[8:11], a[128:131], 0
    v_mfma_f32_32x32x16_bf16 v[64:79], v[8:11], a[4:7], v[64:79]
    v_mfma_f32_32x32x16_bf16 v[80:95], v[8:11], a[132:135], v[80:95]
    v_mfma_f32_32x32x16_bf16 v[64:79], v[8:11], a[8:11], v[64:79]
    v_mfma_f32_32x32x16_bf16 v[80:95], v[8:11], a[136:139], v[80:95]
    v_mfma_f32_32x32x16_bf16 v[64:79], v[8:11], a[12:15], v[64:79]
    v_mfma_f32_32x32x16_bf16 v[80:95], v[8:11], a[140:143], v[80:95]
    v_mfma_f32_32x32x16_bf16 v[64:79], v[8:11], a[16:19], v[64:79]
    v_mfma_f32_32x32x16_bf16 v[80:95], v[8:11], a[144:147], v[80:95]
    v_mfma_f32_32x32x16_bf16 v[64:79], v[8:11], a[20:23], v[64:79]
    v_mfma_f32_32x32x16_bf16 v[80:95], v[8:11], a[148:151], v[80:95]
    v_mfma_f32_32x32x16_bf16 v[64:79], v[8:11], a[24:27], v[64:79]
    v_mfma_f32_32x32x16_bf16 v[80:95], v[8:11], a[152:155], v[80:95]
    v_mfma_f32_32x32x16_bf16 v[64:79], v[8:11], a[28:31], v[64:79]
    v_mfma_f32_32x32x16_bf16 v[80:95], v[8:11], a[156:159], v[80:95]
    v_mfma_f32_32x32x16_bf16 v[64:79], v[8:11], a[32:35], v[64:79]
    v_mfma_f32_32x32x16_bf16 v[80:95], v[8:11], a[160:163], v[80:95]
    v_mfma_f32_32x32x16_bf16 v[64:79], v[8:11], a[36:39], v[64:79]
    v_mfma_f32_32x32x16_bf16 v[80:95], v[8:11], a[164:167], v[80:95]
    v_mfma_f32_32x32x16_bf16 v[64:79], v[8:11], a[40:43], v[64:79]
    v_mfma_f32_32x32x16_bf16 v[80:95], v[8:11], a[168:171], v[80:95]
    v_mfma_f32_32x32x16_bf16 v[64:79], v[8:11], a[44:47], v[64:79]
    v_mfma_f32_32x32x16_bf16 v[80:95], v[8:11], a[172:175], v[80:95]
    v_mfma_f32_32x32x16_bf16 v[64:79], v[8:11], a[48:51], v[64:79]
    v_mfma_f32_32x32x16_bf16 v[80:95], v[8:11], a[176:179], v[80:95]
    v_mfma_f32_32x32x16_bf16 v[64:79], v[8:11], a[52:55], v[64:79]
    v_mfma_f32_32x32x16_bf16 v[80:95], v[8:11], a[180:183], v[80:95]
    v_mfma_f32_32x32x16_bf16 v[64:79], v[8:11], a[56:59], v[64:79]
    v_mfma_f32_32x32x16_bf16 v[80:95], v[8:11], a[184:187], v[80:95]
    v_mfma_f32_32x32x16_bf16 v[64:79], v[8:11], a[60:63], v[64:79]
    v_mfma_f32_32x32x16_bf16 v[80:95], v[8:11], a[188:191], v[80:95]
    v_mfma_f32_32x32x16_bf16 v[64:79], v[8:11], a[64:67], v[64:79]
    v_mfma_f32_32x32x16_bf16 v[80:95], v[8:11], a[192:195], v[80:95]
    v_mfma_f32_32x32x16_bf16 v[64:79], v[8:11], a[68:71], v[64:79]
    v_mfma_f32_32x32x16_bf16 v[80:95], v[8:11], a[196:199], v[80:95]
    v_mfma_f32_32x32x16_bf16 v[64:79], v[8:11], a[72:75], v[64:79]
    v_mfma_f32_32x32x16_bf16 v[80:95], v[8:11], a[200:203], v[80:95]
    v_mfma_f32_32x32x16_bf16 v[64:79], v[8:11], a[76:79], v[64:79]
    v_mfma_f32_32x32x16_bf16 v[80:95], v[8:11], a[204:207], v[80:95]
    v_mfma_f32_32x32x16_bf16 v[64:79], v[8:11], a[80:83], v[64:79]
    v_mfma_f32_32x32x16_bf16 v[80:95], v[8:11], a[208:211], v[80:95]
    v_mfma_f32_32x32x16_bf16 v[64:79], v[8:11], a[84:87], v[64:79]
    v_mfma_f32_32x32x16_bf16 v[80:95], v[8:11], a[212:215], v[80:95]
    v_mfma_f32_32x32x16_bf16 v[64:79], v[8:11], a[88:91], v[64:79]
    v_mfma_f32_32x32x16_bf16 v[80:95], v[8:11], a[216:219], v[80:95]
    v_mfma_f32_32x32x16_bf16 v[64:79], v[8:11], a[92:95], v[64:79]
    v_mfma_f32_32x32x16_bf16 v[80:95], v[8:11], a[220:223], v[80:95]
    v_mfma_f32_32x32x16_bf16 v[64:79], v[8:11], a[96:99], v[64:79]
    v_mfma_f32_32x32x16_bf16 v[80:95], v[8:11], a[224:227], v[80:95]
    v_mfma_f32_32x32x16_bf16 v[64:79], v[8:11], a[100:103], v[64:79]
    v_mfma_f32_32x32x16_bf16 v[80:95], v[8:11], a[228:231], v[80:95]
    v_mfma_f32_32x32x16_bf16 v[64:79], v[8:11], a[104:107], v[64:79]
    v_mfma_f32_32x32x16_bf16 v[80:95], v[8:11], a[232:235], v[80:95]
    v_mfma_f32_32x32x16_bf16 v[64:79], v[8:11], a[108:111], v[64:79]
    v_mfma_f32_32x32x16_bf16 v[80:95], v[8:11], a[236:239], v[80:95]
    v_mfma_f32_32x32x16_bf16 v[64:79], v[8:11], a[112:115], v[64:79]
    v_mfma_f32_32x32x16_bf16 v[80:95], v[8:11], a[240:243], v[80:95]
    v_mfma_f32_32x32x16_bf16 v[64:79], v[8:11], a[116:119], v[64:79]
    v_mfma_f32_32x32x16_bf16 v[80:95], v[8:11], a[244:247], v[80:95]
    v_mfma_f32_32x32x16_bf16 v[64:79], v[8:11], a[120:123], v[64:79]
    v_mfma_f32_32x32x16_bf16 v[80:95], v[8:11], a[248:251], v[80:95]
    v_mfma_f32_32x32x16_bf16 v[64:79], v[8:11], a[124:127], v[64:79]
    v_mfma_f32_32x32x16_bf16 v[80:95], v[8:11], a[252:255], v[80:95]
    s_nop 11
    s_barrier
    v_lshlrev_b32 v0, 4, v40
    v_xor_b32 v1, 0x8000, v0
    s_lshl_b32 s28, s5, 12
    s_mul_i32 s17, s6, 256
    s_add_u32 s17, s17, 18432
    v_and_b32 v2, 3, v40
    v_lshlrev_b32 v2, 2, v2
    v_bfe_u32 v47, v40, 2, 1
    v_lshl_add_u32 v2, v47, 6, v2
    v_add_u32 v2, s17, v2
    s_mov_b32 s12, s8
    s_mov_b32 s13, s9
    s_mul_i32 s18, s6, 4096
    s_add_u32 s18, s18, 4096
    s_sub_u32 s19, s34, 1
    s_lshl_b32 s19, s19, 1
    s_cmp_eq_u32 s34, 0
    s_cselect_b32 s19, 4, s19
    s_and_b32 s17, s5, 1
    s_add_u32 s19, s19, s17
    s_lshl_b32 s19, s19, 4
    s_lshl_b32 s17, s33, 7
    s_add_u32 s17, s17, s19
    s_add_u32 s18, s18, s17
    s_add_u32 s26, s8, s18
    s_addc_u32 s27, s9, 0
    s_mul_i32 s18, s6, 2097152
    s_add_u32 s18, s18, 16777216
    s_lshl_b32 s17, s5, 12
    s_add_u32 s18, s18, s17
    s_add_u32 s10, s8, s18
    s_addc_u32 s11, s9, 0
    s_mul_i32 s18, s6, 262144
    s_add_u32 s18, s18, 20971520
    s_add_u32 s22, s8, s18
    s_addc_u32 s23, s9, 0
    s_mul_i32 s18, s6, 16777216
    s_add_u32 s18, s18, 117440512
    s_lshl_b32 s17, s33, 13
    s_and_b32 s19, s5, 1
    s_lshl_b32 s19, s19, 12
    s_add_u32 s17, s17, s19
    s_add_u32 s18, s18, s17
    s_add_u32 s20, s8, s18
    s_addc_u32 s21, s9, 0
    v_lshlrev_b32 v4, 10, v42
    v_lshl_add_u32 v4, v41, 3, v4
    v_lshlrev_b32 v5, 11, v42
    v_lshl_add_u32 v5, v41, 4, v5
    v_add_u32 v6, 4096, v5
    s_lshl_b32 s17, s5, 8
    s_add_u32 s17, s17, 65536
    v_lshlrev_b32 v7, 2, v41
    v_add_u32 v7, s17, v7
    v_lshlrev_b32 v45, 4, v42
    v_add_u32 v45, s17, v45
    v_mov_b32 v31, v45
    s_load_dwordx2 s[30:31], s[0:1], 88
    s_mov_b32 s14, 1
    s_mov_b32 s7, 0
    v_mov_b32 v123, 248
    s_waitcnt lgkmcnt(0)
    s_mov_b32 s16, 0
Lp_128:
    global_load_dword v3, v123, s[30:31] sc1
    s_add_u32 s16, s16, 1
    s_cmp_gt_u32 s16, 262144
    s_cbranch_scc1 Lwito_126
    s_waitcnt vmcnt(0)
    v_cmp_gt_u32 vcc, s14, v3
    s_cbranch_vccnz Lp_128
    s_branch Lwisk_127
Lwito_126:
    s_load_dwordx2 s[30:31], s[0:1], 88
    s_waitcnt lgkmcnt(0)
    s_mov_b64 exec, 1
    v_mov_b32 v2, 176
    v_mov_b32 v3, s7
    v_add_u32 v3, 0x10000, v3
    global_store_dword v2, v3, s[30:31] sc1
    s_waitcnt vmcnt(0)
    s_endpgm
Lwisk_127:
    s_mov_b32 s7, 0
    s_mov_b32 s19, 0
    s_mov_b32 s35, 0
    s_mov_b32 s37, 0
    s_add_u32 s14, s19, 1
    s_mov_b32 s16, 0
Lp_129:
    global_load_dword v3, v2, s[12:13] sc1
    s_add_u32 s16, s16, 1
    s_cmp_gt_u32 s16, 262144
    s_cbranch_scc1 LtoT3v_124
    s_waitcnt vmcnt(0)
    v_cmp_gt_u32 vcc, s14, v3
    s_cbranch_vccnz Lp_129
    s_add_u32 s17, s28, 0
    s_mov_b32 m0, s17
    s_nop 0
    global_load_lds_dwordx4 v0, s[10:11] offset:0 sc1
    global_load_lds_dwordx4 v0, s[10:11] offset:1024 sc1
    global_load_lds_dwordx4 v0, s[10:11] offset:2048 sc1
    global_load_lds_dwordx4 v0, s[10:11] offset:3072 sc1
    s_add_u32 s10, s10, 16384
    s_addc_u32 s11, s11, 0
    s_add_u32 s17, s28, 16384
    s_mov_b32 m0, s17
    s_nop 0
    global_load_lds_dwordx4 v0, s[10:11] offset:0 sc1
    global_load_lds_dwordx4 v0, s[10:11] offset:1024 sc1
    global_load_lds_dwordx4 v0, s[10:11] offset:2048 sc1
    global_load_lds_dwordx4 v0, s[10:11] offset:3072 sc1
    s_add_u32 s10, s10, 16384
    s_addc_u32 s11, s11, 0
    s_waitcnt vmcnt(0)
    s_barrier
LitT3v_125:
    v_xor_b32 v1, 0x8000, v1
    s_xor_b32 s28, s28, 0x8000
    s_add_u32 s19, s7, 1
    s_add_u32 s14, s19, 1
    s_cmp_ge_u32 s19, 64
    s_cselect_b32 s15, 1, 0
    ds_read_b128 v[8:11], v1 offset:0
    ds_read_b128 v[12:15], v1 offset:1024
    ds_read_b128 v[16:19], v1 offset:2048
    ds_read_b128 v[20:23], v1 offset:3072
    s_waitcnt lgkmcnt(3)
    v_mfma_f32_32x32x16_bf16 v[32:47], v[8:11], a[0:3], 0
    v_mfma_f32_32x32x16_bf16 v[48:63], v[8:11], a[128:131], 0
    global_load_dword v3, v2, s[12:13] sc1
    ds_read_b128 v[8:11], v1 offset:4096
    s_waitcnt lgkmcnt(3)
    v_mfma_f32_32x32x16_bf16 v[32:47], v[12:15], a[4:7], v[32:47]
    v_mfma_f32_32x32x16_bf16 v[48:63], v[12:15], a[132:135], v[48:63]
    global_load_dwordx2 v[100:101], v4, s[22:23] offset:0 sc1
    ds_read_b128 v[12:15], v1 offset:5120
    s_waitcnt lgkmcnt(3)
    v_mfma_f32_32x32x16_bf16 v[32:47], v[16:19], a[8:11], v[32:47]
    v_mfma_f32_32x32x16_bf16 v[48:63], v[16:19], a[136:139], v[48:63]
    global_load_dwordx2 v[102:103], v4, s[22:23] offset:256 sc1
    ds_read_b128 v[16:19], v1 offset:6144
    s_waitcnt lgkmcnt(3)
    v_mfma_f32_32x32x16_bf16 v[32:47], v[20:23], a[12:15], v[32:47]
    v_mfma_f32_32x32x16_bf16 v[48:63], v[20:23], a[140:143], v[48:63]
    global_load_dwordx2 v[104:105], v4, s[22:23] offset:512 sc1
    ds_read_b128 v[20:23], v1 offset:7168
    s_waitcnt lgkmcnt(3)
    v_mfma_f32_32x32x16_bf16 v[32:47], v[8:11], a[16:19], v[32:47]
    v_mfma_f32_32x32x16_bf16 v[48:63], v[8:11], a[144:147], v[48:63]
    global_load_dwordx2 v[106:107], v4, s[22:23] offset:768 sc1
    ds_read_b128 v[8:11], v1 offset:8192
    s_waitcnt lgkmcnt(3)
    v_mfma_f32_32x32x16_bf16 v[32:47], v[12:15], a[20:23], v[32:47]
    v_mfma_f32_32x32x16_bf16 v[48:63], v[12:15], a[148:151], v[48:63]
    s_add_u32 s22, s22, 2048
    s_addc_u32 s23, s23, 0
    ds_read_b128 v[12:15], v1 offset:9216
    s_waitcnt lgkmcnt(3)
    v_mfma_f32_32x32x16_bf16 v[32:47], v[16:19], a[24:27], v[32:47]
    v_mfma_f32_32x32x16_bf16 v[48:63], v[16:19], a[152:155], v[48:63]
    ds_read_b128 v[16:19], v1 offset:10240
    s_waitcnt lgkmcnt(3)
    v_mfma_f32_32x32x16_bf16 v[32:47], v[20:23], a[28:31], v[32:47]
    v_mfma_f32_32x32x16_bf16 v[48:63], v[20:23], a[156:159], v[48:63]
    ds_read_b128 v[20:23], v1 offset:11264
    s_waitcnt lgkmcnt(3)
    v_mfma_f32_32x32x16_bf16 v[32:47], v[8:11], a[32:35], v[32:47]
    v_mfma_f32_32x32x16_bf16 v[48:63], v[8:11], a[160:163], v[48:63]
    ds_read_b128 v[8:11], v1 offset:12288
    s_waitcnt lgkmcnt(3)
    v_mfma_f32_32x32x16_bf16 v[32:47], v[12:15], a[36:39], v[32:47]
    v_mfma_f32_32x32x16_bf16 v[48:63], v[12:15], a[164:167], v[48:63]
    ds_read_b128 v[12:15], v1 offset:13312
    s_waitcnt lgkmcnt(3)
    v_mfma_f32_32x32x16_bf16 v[32:47], v[16:19], a[40:43], v[32:47]
    v_mfma_f32_32x32x16_bf16 v[48:63], v[16:19], a[168:171], v[48:63]
    ds_read_b128 v[16:19], v1 offset:14336
    s_waitcnt lgkmcnt(3)
    v_mfma_f32_32x32x16_bf16 v[32:47], v[20:23], a[44:47], v[32:47]
    v_mfma_f32_32x32x16_bf16 v[48:63], v[20:23], a[172:175], v[48:63]
    ds_read_b128 v[20:23], v1 offset:15360
    s_waitcnt lgkmcnt(3)
    v_mfma_f32_32x32x16_bf16 v[32:47], v[8:11], a[48:51], v[32:47]
    v_mfma_f32_32x32x16_bf16 v[48:63], v[8:11], a[176:179], v[48:63]
    s_waitcnt vmcnt(4)
    s_barrier
    v_cmp_gt_u32 vcc, s14, v3
    s_cmp_eq_u32 s35, 0
    s_cbranch_scc1 Lnp_131
    v_mov_b32 v3, s7
    s_mov_b64 exec, 1
    global_store_dword v0, v3, s[26:27] sc1
    s_mov_b64 exec, -1
Lpub_132:
    s_mov_b32 s35, 0
Lnp_131:
    s_cmp_lg_u32 s15, 0
    s_cbranch_scc1 Lhk_130
    s_cbranch_vccnz Lnr_133
    s_mov_b32 s15, 1
    s_mov_b32 s37, 1
    s_branch Lhk_130
Lnr_133:
    global_load_dword v3, v2, s[12:13] sc1
Lhk_130:
    ds_read_b128 v[8:11], v1 offset:16384
    s_waitcnt lgkmcnt(3)
    v_mfma_f32_32x32x16_bf16 v[32:47], v[12:15], a[52:55], v[32:47]
    v_mfma_f32_32x32x16_bf16 v[48:63], v[12:15], a[180:183], v[48:63]
    s_cmp_eq_u32 s37, 0
    s_cbranch_scc1 Lch_134
    s_add_u32 s17, s28, 0
    s_mov_b32 m0, s17
    s_nop 0
    global_load_lds_dwordx4 v0, s[10:11] offset:0 sc1
Lch_134:
    ds_read_b128 v[12:15], v1 offset:17408
    s_waitcnt lgkmcnt(3)
    v_mfma_f32_32x32x16_bf16 v[32:47], v[16:19], a[56:59], v[32:47]
    v_mfma_f32_32x32x16_bf16 v[48:63], v[16:19], a[184:187], v[48:63]
    s_cmp_eq_u32 s37, 0
    s_cbranch_scc1 Lch_135
    global_load_lds_dwordx4 v0, s[10:11] offset:1024 sc1
Lch_135:
    ds_read_b128 v[16:19], v1 offset:18432
    s_waitcnt lgkmcnt(3)
    v_mfma_f32_32x32x16_bf16 v[32:47], v[20:23], a[60:63], v[32:47]
    v_mfma_f32_32x32x16_bf16 v[48:63], v[20:23], a[188:191], v[48:63]
    s_cmp_eq_u32 s37, 0
    s_cbranch_scc1 Lch_136
    global_load_lds_dwordx4 v0, s[10:11] offset:2048 sc1
Lch_136:
    ds_read_b128 v[20:23], v1 offset:19456
    s_waitcnt lgkmcnt(3)
    v_mfma_f32_32x32x16_bf16 v[32:47], v[8:11], a[64:67], v[32:47]
    v_mfma_f32_32x32x16_bf16 v[48:63], v[8:11], a[192:195], v[48:63]
    s_cmp_eq_u32 s37, 0
    s_cbranch_scc1 Lch_137
    global_load_lds_dwordx4 v0, s[10:11] offset:3072 sc1
    s_add_u32 s10, s10, 16384
    s_addc_u32 s11, s11, 0
Lch_137:
    ds_read_b128 v[8:11], v1 offset:20480
    s_waitcnt lgkmcnt(3)
    v_mfma_f32_32x32x16_bf16 v[32:47], v[12:15], a[68:71], v[32:47]
    v_mfma_f32_32x32x16_bf16 v[48:63], v[12:15], a[196:199], v[48:63]
    s_cmp_eq_u32 s37, 0
    s_cbranch_scc1 Lch_138
    s_add_u32 s17, s28, 16384
    s_mov_b32 m0, s17
    s_nop 0
    global_load_lds_dwordx4 v0, s[10:11] offset:0 sc1
Lch_138:
    ds_read_b128 v[12:15], v1 offset:21504
    s_waitcnt lgkmcnt(3)
    v_mfma_f32_32x32x16_bf16 v[32:47], v[16:19], a[72:75], v[32:47]
    v_mfma_f32_32x32x16_bf16 v[48:63], v[16:19], a[200:203], v[48:63]
    s_cmp_eq_u32 s37, 0
    s_cbranch_scc1 Lch_139
    global_load_lds_dwordx4 v0, s[10:11] offset:1024 sc1
Lch_139:
    ds_read_b128 v[16:19], v1 offset:22528
    s_waitcnt lgkmcnt(3)
    v_mfma_f32_32x32x16_bf16 v[32:47], v[20:23], a[76:79], v[32:47]
    v_mfma_f32_32x32x16_bf16 v[48:63], v[20:23], a[204:207], v[48:63]
    s_cmp_eq_u32 s37, 0
    s_cbranch_scc1 Lch_140
    global_load_lds_dwordx4 v0, s[10:11] offset:2048 sc1
Lch_140:
    ds_read_b128 v[20:23], v1 offset:23552
    s_waitcnt lgkmcnt(3)
    v_mfma_f32_32x32x16_bf16 v[32:47], v[8:11], a[80:83], v[32:47]
    v_mfma_f32_32x32x16_bf16 v[48:63], v[8:11], a[208:211], v[48:63]
    s_cmp_eq_u32 s37, 0
    s_cbranch_scc1 Lch_141
    global_load_lds_dwordx4 v0, s[10:11] offset:3072 sc1
    s_add_u32 s10, s10, 16384
    s_addc_u32 s11, s11, 0
    s_mov_b32 s37, 0
Lch_141:
    ds_read_b128 v[8:11], v1 offset:24576
    s_waitcnt lgkmcnt(3)
    v_mfma_f32_32x32x16_bf16 v[32:47], v[12:15], a[84:87], v[32:47]
    v_mfma_f32_32x32x16_bf16 v[48:63], v[12:15], a[212:215], v[48:63]
    ds_read_b128 v[12:15], v1 offset:25600
    s_waitcnt lgkmcnt(3)
    v_mfma_f32_32x32x16_bf16 v[32:47], v[16:19], a[88:91], v[32:47]
    v_mfma_f32_32x32x16_bf16 v[48:63], v[16:19], a[216:219], v[48:63]
    ds_read_b128 v[16:19], v1 offset:26624
    s_waitcnt lgkmcnt(3)
    v_mfma_f32_32x32x16_bf16 v[32:47], v[20:23], a[92:95], v[32:47]
    v_mfma_f32_32x32x16_bf16 v[48:63], v[20:23], a[220:223], v[48:63]
    ds_read_b128 v[20:23], v1 offset:27648
    s_waitcnt lgkmcnt(3)
    v_mfma_f32_32x32x16_bf16 v[32:47], v[8:11], a[96:99], v[32:47]
    v_mfma_f32_32x32x16_bf16 v[48:63], v[8:11], a[224:227], v[48:63]
    s_cmp_lg_u32 s15, 0
    s_cbranch_scc1 Lhk_142
    s_waitcnt vmcnt(0)
    v_cmp_gt_u32 vcc, s14, v3
    s_cbranch_vccnz Lnr1_143
    s_add_u32 s17, s28, 0
    s_mov_b32 m0, s17
    s_nop 0
    global_load_lds_dwordx4 v0, s[10:11] offset:0 sc1
    global_load_lds_dwordx4 v0, s[10:11] offset:1024 sc1
    global_load_lds_dwordx4 v0, s[10:11] offset:2048 sc1
    global_load_lds_dwordx4 v0, s[10:11] offset:3072 sc1
    s_add_u32 s10, s10, 16384
    s_addc_u32 s11, s11, 0
    s_add_u32 s17, s28, 16384
    s_mov_b32 m0, s17
    s_nop 0
    global_load_lds_dwordx4 v0, s[10:11] offset:0 sc1
    global_load_lds_dwordx4 v0, s[10:11] offset:1024 sc1
    global_load_lds_dwordx4 v0, s[10:11] offset:2048 sc1
    global_load_lds_dwordx4 v0, s[10:11] offset:3072 sc1
    s_add_u32 s10, s10, 16384
    s_addc_u32 s11, s11, 0
    s_mov_b32 s15, 1
    s_branch Lhk_142
Lnr1_143:
    global_load_dword v3, v2, s[12:13] sc1
Lhk_142:
    ds_read_b128 v[8:11], v1 offset:28672
    s_waitcnt lgkmcnt(3)
    v_mfma_f32_32x32x16_bf16 v[32:47], v[12:15], a[100:103], v[32:47]
    v_mfma_f32_32x32x16_bf16 v[48:63], v[12:15], a[228:231], v[48:63]
    ds_read_b128 v[12:15], v1 offset:29696
    s_waitcnt lgkmcnt(3)
    v_mfma_f32_32x32x16_bf16 v[32:47], v[16:19], a[104:107], v[32:47]
    v_mfma_f32_32x32x16_bf16 v[48:63], v[16:19], a[232:235], v[48:63]
    ds_read_b128 v[16:19], v1 offset:30720
    s_waitcnt lgkmcnt(3)
    v_mfma_f32_32x32x16_bf16 v[32:47], v[20:23], a[108:111], v[32:47]
    v_mfma_f32_32x32x16_bf16 v[48:63], v[20:23], a[236:239], v[48:63]
    ds_read_b128 v[20:23], v1 offset:31744
    s_waitcnt lgkmcnt(3)
    v_mfma_f32_32x32x16_bf16 v[32:47], v[8:11], a[112:115], v[32:47]
    v_mfma_f32_32x32x16_bf16 v[48:63], v[8:11], a[240:243], v[48:63]
    s_waitcnt lgkmcnt(2)
    v_mfma_f32_32x32x16_bf16 v[32:47], v[12:15], a[116:119], v[32:47]
    v_mfma_f32_32x32x16_bf16 v[48:63], v[12:15], a[244:247], v[48:63]
    s_waitcnt lgkmcnt(1)
    v_mfma_f32_32x32x16_bf16 v[32:47], v[16:19], a[120:123], v[32:47]
    v_mfma_f32_32x32x16_bf16 v[48:63], v[16:19], a[248:251], v[48:63]
    s_waitcnt lgkmcnt(0)
    v_mfma_f32_32x32x16_bf16 v[32:47], v[20:23], a[124:127], v[32:47]
    v_mfma_f32_32x32x16_bf16 v[48:63], v[20:23], a[252:255], v[48:63]
    s_nop 11
    s_cmp_ge_u32 s19, 64
    s_cbranch_scc1 Law_144
    s_waitcnt vmcnt(8)
    s_branch Law2_145
Law_144:
    s_waitcnt vmcnt(0)
Law2_145:
    v_add_f32 v100, v100, v102
    v_add_f32 v101, v101, v103
    v_add_f32 v104, v104, v106
    v_add_f32 v105, v105, v107
    v_add_f32 v100, v100, v104
    v_add_f32 v101, v101, v105
    v_mov_b32 v102, v100
    v_mov_b32 v103, v101
    s_nop 1
    v_permlane32_swap_b32 v100, v102
    v_permlane32_swap_b32 v101, v103
    v_add_f32 v100, v100, v102
    v_add_f32 v101, v101, v103
    v_mul_f32 v100, 0x3b000000, v100
    v_mul_f32 v101, 0x3b000000, v101
    v_fma_f32 v101, -v100, v100, v101
    v_max_f32 v101, 0, v101
    v_add_f32 v101, 0x3727c5ac, v101
    v_rsq_f32 v96, v101
    s_nop 0
    v_mul_f32 v97, v100, v96
    ds_write_b32 v7, v96
    ds_write_b32 v7, v97 offset:128
    s_waitcnt lgkmcnt(0)
    ds_read_b128 v[100:103], v31 offset:0
    ds_read_b128 v[116:119], v31 offset:128
    ds_read_b128 v[104:107], v31 offset:32
    ds_read_b128 v[120:123], v31 offset:160
    ds_read_b128 v[108:111], v31 offset:64
    ds_read_b128 v[124:127], v31 offset:192
    ds_read_b128 v[112:115], v31 offset:96
    ds_read_b128 v[128:131], v31 offset:224
    s_waitcnt lgkmcnt(0)
    v_pk_mul_f32 v[32:33], v[32:33], v[100:101]
    v_pk_mul_f32 v[34:35], v[34:35], v[102:103]
    v_pk_mul_f32 v[36:37], v[36:37], v[104:105]
    v_pk_mul_f32 v[38:39], v[38:39], v[106:107]
    v_pk_mul_f32 v[40:41], v[40:41], v[108:109]
    v_pk_mul_f32 v[42:43], v[42:43], v[110:111]
    v_pk_mul_f32 v[44:45], v[44:45], v[112:113]
    v_pk_mul_f32 v[46:47], v[46:47], v[114:115]
    v_pk_fma_f32 v[32:33], v[116:117], v[64:65], v[32:33] op_sel_hi:[1,0,1] neg_lo:[1,0,0] neg_hi:[1,0,0]
    v_pk_fma_f32 v[34:35], v[118:119], v[64:65], v[34:35] op_sel_hi:[1,0,1] neg_lo:[1,0,0] neg_hi:[1,0,0]
    v_pk_fma_f32 v[36:37], v[120:121], v[64:65], v[36:37] op_sel_hi:[1,0,1] neg_lo:[1,0,0] neg_hi:[1,0,0]
    v_pk_fma_f32 v[38:39], v[122:123], v[64:65], v[38:39] op_sel_hi:[1,0,1] neg_lo:[1,0,0] neg_hi:[1,0,0]
    v_pk_fma_f32 v[40:41], v[124:125], v[64:65], v[40:41] op_sel_hi:[1,0,1] neg_lo:[1,0,0] neg_hi:[1,0,0]
    v_pk_fma_f32 v[42:43], v[126:127], v[64:65], v[42:43] op_sel_hi:[1,0,1] neg_lo:[1,0,0] neg_hi:[1,0,0]
    v_pk_fma_f32 v[44:45], v[128:129], v[64:65], v[44:45] op_sel_hi:[1,0,1] neg_lo:[1,0,0] neg_hi:[1,0,0]
    v_pk_fma_f32 v[46:47], v[130:131], v[64:65], v[46:47] op_sel_hi:[1,0,1] neg_lo:[1,0,0] neg_hi:[1,0,0]
    v_pk_mul_f32 v[48:49], v[48:49], v[100:101]
    v_pk_mul_f32 v[50:51], v[50:51], v[102:103]
    v_pk_mul_f32 v[52:53], v[52:53], v[104:105]
    v_pk_mul_f32 v[54:55], v[54:55], v[106:107]
    v_pk_mul_f32 v[56:57], v[56:57], v[108:109]
    v_pk_mul_f32 v[58:59], v[58:59], v[110:111]
    v_pk_mul_f32 v[60:61], v[60:61], v[112:113]
    v_pk_mul_f32 v[62:63], v[62:63], v[114:115]
    v_pk_fma_f32 v[48:49], v[116:117], v[80:81], v[48:49] op_sel_hi:[1,0,1] neg_lo:[1,0,0] neg_hi:[1,0,0]
    v_pk_fma_f32 v[50:51], v[118:119], v[80:81], v[50:51] op_sel_hi:[1,0,1] neg_lo:[1,0,0] neg_hi:[1,0,0]
    v_pk_fma_f32 v[52:53], v[120:121], v[80:81], v[52:53] op_sel_hi:[1,0,1] neg_lo:[1,0,0] neg_hi:[1,0,0]
    v_pk_fma_f32 v[54:55], v[122:123], v[80:81], v[54:55] op_sel_hi:[1,0,1] neg_lo:[1,0,0] neg_hi:[1,0,0]
    v_pk_fma_f32 v[56:57], v[124:125], v[80:81], v[56:57] op_sel_hi:[1,0,1] neg_lo:[1,0,0] neg_hi:[1,0,0]
    v_pk_fma_f32 v[58:59], v[126:127], v[80:81], v[58:59] op_sel_hi:[1,0,1] neg_lo:[1,0,0] neg_hi:[1,0,0]
    v_pk_fma_f32 v[60:61], v[128:129], v[80:81], v[60:61] op_sel_hi:[1,0,1] neg_lo:[1,0,0] neg_hi:[1,0,0]
    v_pk_fma_f32 v[62:63], v[130:131], v[80:81], v[62:63] op_sel_hi:[1,0,1] neg_lo:[1,0,0] neg_hi:[1,0,0]
    s_cmp_lg_u32 s15, 0
    s_cbranch_scc1 Lhk_146
    s_waitcnt vmcnt(0)
    v_cmp_gt_u32 vcc, s14, v3
    s_cbranch_vccnz Lnr2_147
    s_mov_b32 s37, 2
    s_branch Lhk_146
Lnr2_147:
    global_load_dword v3, v2, s[12:13] sc1
Lhk_146:
    v_cvt_pk_bf16_f32 v132, v32, v33
    v_cvt_pk_bf16_f32 v133, v34, v35
    v_cvt_pk_bf16_f32 v134, v40, v41
    v_cvt_pk_bf16_f32 v135, v42, v43
    global_store_dwordx4 v0, v[132:135], s[20:21] offset:0 sc1
    v_cvt_pk_bf16_f32 v136, v36, v37
    v_cvt_pk_bf16_f32 v137, v38, v39
    v_cvt_pk_bf16_f32 v138, v44, v45
    v_cvt_pk_bf16_f32 v139, v46, v47
    global_store_dwordx4 v0, v[136:139], s[20:21] offset:1024 sc1
    v_cvt_pk_bf16_f32 v140, v48, v49
    v_cvt_pk_bf16_f32 v141, v50, v51
    v_cvt_pk_bf16_f32 v142, v56, v57
    v_cvt_pk_bf16_f32 v143, v58, v59
    global_store_dwordx4 v0, v[140:143], s[20:21] offset:2048 sc1
    v_cvt_pk_bf16_f32 v144, v52, v53
    v_cvt_pk_bf16_f32 v145, v54, v55
    v_cvt_pk_bf16_f32 v146, v60, v61
    v_cvt_pk_bf16_f32 v147, v62, v63
    global_store_dwordx4 v0, v[144:147], s[20:21] offset:3072 sc1
    s_add_u32 s20, s20, 262144
    s_addc_u32 s21, s21, 0
    s_add_u32 s7, s7, 1
    s_cmp_lg_u32 s15, 0
    s_cbranch_scc1 Lh3_151
    s_cmp_eq_u32 s37, 2
    s_cbranch_scc1 Lh3_151
    s_waitcnt vmcnt(4)
    v_cmp_gt_u32 vcc, s14, v3
    s_cbranch_vccnz Lh3_151
    s_mov_b32 s37, 2
Lh3_151:
    s_cmp_lg_u32 s37, 2
    s_cbranch_scc1 Lng2_150
    s_add_u32 s17, s28, 0
    s_mov_b32 m0, s17
    s_nop 0
    global_load_lds_dwordx4 v0, s[10:11] offset:0 sc1
    global_load_lds_dwordx4 v0, s[10:11] offset:1024 sc1
    global_load_lds_dwordx4 v0, s[10:11] offset:2048 sc1
    global_load_lds_dwordx4 v0, s[10:11] offset:3072 sc1
    s_add_u32 s10, s10, 16384
    s_addc_u32 s11, s11, 0
    s_add_u32 s17, s28, 16384
    s_mov_b32 m0, s17
    s_nop 0
    global_load_lds_dwordx4 v0, s[10:11] offset:0 sc1
    global_load_lds_dwordx4 v0, s[10:11] offset:1024 sc1
    global_load_lds_dwordx4 v0, s[10:11] offset:2048 sc1
    global_load_lds_dwordx4 v0, s[10:11] offset:3072 sc1
    s_add_u32 s10, s10, 16384
    s_addc_u32 s11, s11, 0
    s_mov_b32 s37, 0
    s_waitcnt vmcnt(8)
    v_mov_b32 v3, s7
    s_mov_b64 exec, 1
    global_store_dword v0, v3, s[26:27] sc1
    s_mov_b64 exec, -1
Lpub_152:
    s_waitcnt vmcnt(5)
    s_branch Ljoin_149
Lng2_150:
    s_cmp_ge_u32 s7, 64
    s_cbranch_scc1 Llate_148
    s_cmp_eq_u32 s15, 0
    s_cbranch_scc1 Llate_148
    s_waitcnt vmcnt(4)
    s_mov_b32 s35, 1
    s_branch Ljoin_149
Llate_148:
    s_waitcnt vmcnt(0)
    v_mov_b32 v3, s7
    s_mov_b64 exec, 1
    global_store_dword v0, v3, s[26:27] sc1
    s_mov_b64 exec, -1
Lpub_153:
    s_cmp_ge_u32 s7, 64
    s_cbranch_scc1 Ljoin_149
    s_mov_b32 s16, 0
Lp_154:
    global_load_dword v3, v2, s[12:13] sc1
    s_add_u32 s16, s16, 1
    s_cmp_gt_u32 s16, 262144
    s_cbranch_scc1 LtoT3v_124
    s_waitcnt vmcnt(0)
    v_cmp_gt_u32 vcc, s14, v3
    s_cbranch_vccnz Lp_154
    s_add_u32 s17, s28, 0
    s_mov_b32 m0, s17
    s_nop 0
    global_load_lds_dwordx4 v0, s[10:11] offset:0 sc1
    global_load_lds_dwordx4 v0, s[10:11] offset:1024 sc1
    global_load_lds_dwordx4 v0, s[10:11] offset:2048 sc1
    global_load_lds_dwordx4 v0, s[10:11] offset:3072 sc1
    s_add_u32 s10, s10, 16384
    s_addc_u32 s11, s11, 0
    s_add_u32 s17, s28, 16384
    s_mov_b32 m0, s17
    s_nop 0
    global_load_lds_dwordx4 v0, s[10:11] offset:0 sc1
    global_load_lds_dwordx4 v0, s[10:11] offset:1024 sc1
    global_load_lds_dwordx4 v0, s[10:11] offset:2048 sc1
    global_load_lds_dwordx4 v0, s[10:11] offset:3072 sc1
    s_add_u32 s10, s10, 16384
    s_addc_u32 s11, s11, 0
    s_waitcnt vmcnt(4)
Ljoin_149:
    s_barrier
    s_cmp_lt_u32 s7, 64
    s_cbranch_scc1 LitT3v_125
    s_waitcnt vmcnt(0)
    s_endpgm
LtoT3v_124:
    s_load_dwordx2 s[30:31], s[0:1], 88
    s_waitcnt lgkmcnt(0)
    s_mov_b64 exec, 1
    v_mov_b32 v2, 144
    v_mov_b32 v3, s7
    v_add_u32 v3, 0x10000, v3
    global_store_dword v2, v3, s[30:31] sc1
    s_waitcnt vmcnt(0)
    s_endpgm
ROLE_TW:
    v_and_b32 v40, 63, v0
    v_and_b32 v41, 31, v40
    v_lshrrev_b32 v42, 5, v40
    v_and_b32 v43, 15, v40
    v_lshrrev_b32 v44, 4, v40
    s_cmp_lg_u32 s6, 0
    s_cbranch_scc1 Lwsg_157
    s_branch Lws_155
Lwsg_157:
    s_load_dwordx2 s[30:31], s[0:1], 88
    s_mov_b32 s14, 1
    s_mov_b32 s7, 0
    v_mov_b32 v2, 248
    s_waitcnt lgkmcnt(0)
    s_mov_b32 s16, 0
Lp_160:
    global_load_dword v3, v2, s[30:31] sc1
    s_add_u32 s16, s16, 1
    s_cmp_gt_u32 s16, 262144
    s_cbranch_scc1 Lwito_158
    s_waitcnt vmcnt(0)
    v_cmp_gt_u32 vcc, s14, v3
    s_cbranch_vccnz Lp_160
    s_branch Lwisk_159
Lwito_158:
    s_load_dwordx2 s[30:31], s[0:1], 88
    s_waitcnt lgkmcnt(0)
    s_mov_b64 exec, 1
    v_mov_b32 v2, 176
    v_mov_b32 v3, s7
    v_add_u32 v3, 0x10000, v3
    global_store_dword v2, v3, s[30:31] sc1
    s_waitcnt vmcnt(0)
    s_endpgm
Lwisk_159:
    v_mov_b32 v2, 0
    s_mov_b32 s12, s8
    s_mov_b32 s13, s9
    s_mov_b32 s14, 1
    s_mov_b32 s7, 0
    s_mov_b32 s16, 0
Lp_161:
    global_load_dword v3, v2, s[12:13] sc1
    s_add_u32 s16, s16, 1
    s_cmp_gt_u32 s16, 262144
    s_cbranch_scc1 Lwsto_156
    s_waitcnt vmcnt(0)
    v_cmp_gt_u32 vcc, s14, v3
    s_cbranch_vccnz Lp_161
    s_branch Lws_155
Lwsto_156:
    s_load_dwordx2 s[30:31], s[0:1], 88
    s_waitcnt lgkmcnt(0)
    s_mov_b64 exec, 1
    v_mov_b32 v2, 168
    v_mov_b32 v3, s7
    v_add_u32 v3, 0x10000, v3
    global_store_dword v2, v3, s[30:31] sc1
    s_waitcnt vmcnt(0)
    s_endpgm
Lws_155:
    v_lshrrev_b32 v45, 3, v40
    v_mul_u32_u24 v45, 1024, v45
    v_and_b32 v46, 7, v40
    v_lshl_add_u32 v45, v46, 4, v45
    v_lshrrev_b32 v46, 2, v43
    v_lshl_add_u32 v46, v42, 3, v46
    v_lshlrev_b32 v46, 7, v46
    v_and_b32 v47, 1, v44
    v_lshl_add_u32 v46, v47, 5, v46
    v_and_b32 v47, 3, v43
    v_lshl_add_u32 v46, v47, 3, v46
    s_lshl_b32 s18, s5, 15
    v_add_u32 v46, s18, v46
    s_load_dwordx2 s[30:31], s[0:1], 16
    s_lshl_b32 s17, s4, 9
    s_lshl_b32 s18, s5, 7
    s_add_u32 s17, s17, s18
    s_add_u32 s17, s17, 0
    s_lshl_b32 s19, s5, 15
    s_waitcnt lgkmcnt(0)
    s_add_u32 s30, s30, s17
    s_addc_u32 s31, s31, 0
    s_mov_b32 m0, s19
    s_add_u32 s19, s19, 1024
    global_load_lds_dwordx4 v45, s[30:31]
    s_add_u32 s30, s30, 8192
    s_addc_u32 s31, s31, 0
    s_mov_b32 m0, s19
    s_add_u32 s19, s19, 1024
    global_load_lds_dwordx4 v45, s[30:31]
    s_add_u32 s30, s30, 8192
    s_addc_u32 s31, s31, 0
    s_mov_b32 m0, s19
    s_add_u32 s19, s19, 1024
    global_load_lds_dwordx4 v45, s[30:31]
    s_add_u32 s30, s30, 8192
    s_addc_u32 s31, s31, 0
    s_mov_b32 m0, s19
    s_add_u32 s19, s19, 1024
    global_load_lds_dwordx4 v45, s[30:31]
    s_add_u32 s30, s30, 8192
    s_addc_u32 s31, s31, 0
    s_mov_b32 m0, s19
    s_add_u32 s19, s19, 1024
    global_load_lds_dwordx4 v45, s[30:31]
    s_add_u32 s30, s30, 8192
    s_addc_u32 s31, s31, 0
    s_mov_b32 m0, s19
    s_add_u32 s19, s19, 1024
    global_load_lds_dwordx4 v45, s[30:31]
    s_add_u32 s30, s30, 8192
    s_addc_u32 s31, s31, 0
    s_mov_b32 m0, s19
    s_add_u32 s19, s19, 1024
    global_load_lds_dwordx4 v45, s[30:31]
    s_add_u32 s30, s30, 8192
    s_addc_u32 s31, s31, 0
    s_mov_b32 m0, s19
    s_add_u32 s19, s19, 1024
    global_load_lds_dwordx4 v45, s[30:31]
    s_add_u32 s30, s30, 8192
    s_addc_u32 s31, s31, 0
    s_mov_b32 m0, s19
    s_add_u32 s19, s19, 1024
    global_load_lds_dwordx4 v45, s[30:31]
    s_add_u32 s30, s30, 8192
    s_addc_u32 s31, s31, 0
    s_mov_b32 m0, s19
    s_add_u32 s19, s19, 1024
    global_load_lds_dwordx4 v45, s[30:31]
    s_add_u32 s30, s30, 8192
    s_addc_u32 s31, s31, 0
    s_mov_b32 m0, s19
    s_add_u32 s19, s19, 1024
    global_load_lds_dwordx4 v45, s[30:31]
    s_add_u32 s30, s30, 8192
    s_addc_u32 s31, s31, 0
    s_mov_b32 m0, s19
    s_add_u32 s19, s19, 1024
    global_load_lds_dwordx4 v45, s[30:31]
    s_add_u32 s30, s30, 8192
    s_addc_u32 s31, s31, 0
    s_mov_b32 m0, s19
    s_add_u32 s19, s19, 1024
    global_load_lds_dwordx4 v45, s[30:31]
    s_add_u32 s30, s30, 8192
    s_addc_u32 s31, s31, 0
    s_mov_b32 m0, s19
    s_add_u32 s19, s19, 1024
    global_load_lds_dwordx4 v45, s[30:31]
    s_add_u32 s30, s30, 8192
    s_addc_u32 s31, s31, 0
    s_mov_b32 m0, s19
    s_add_u32 s19, s19, 1024
    global_load_lds_dwordx4 v45, s[30:31]
    s_add_u32 s30, s30, 8192
    s_addc_u32 s31, s31, 0
    s_mov_b32 m0, s19
    s_add_u32 s19, s19, 1024
    global_load_lds_dwordx4 v45, s[30:31]
    s_add_u32 s30, s30, 8192
    s_addc_u32 s31, s31, 0
    s_mov_b32 m0, s19
    s_add_u32 s19, s19, 1024
    global_load_lds_dwordx4 v45, s[30:31]
    s_add_u32 s30, s30, 8192
    s_addc_u32 s31, s31, 0
    s_mov_b32 m0, s19
    s_add_u32 s19, s19, 1024
    global_load_lds_dwordx4 v45, s[30:31]
    s_add_u32 s30, s30, 8192
    s_addc_u32 s31, s31, 0
    s_mov_b32 m0, s19
    s_add_u32 s19, s19, 1024
    global_load_lds_dwordx4 v45, s[30:31]
    s_add_u32 s30, s30, 8192
    s_addc_u32 s31, s31, 0
    s_mov_b32 m0, s19
    s_add_u32 s19, s19, 1024
    global_load_lds_dwordx4 v45, s[30:31]
    s_add_u32 s30, s30, 8192
    s_addc_u32 s31, s31, 0
    s_mov_b32 m0, s19
    s_add_u32 s19, s19, 1024
    global_load_lds_dwordx4 v45, s[30:31]
    s_add_u32 s30, s30, 8192
    s_addc_u32 s31, s31, 0
    s_mov_b32 m0, s19
    s_add_u32 s19, s19, 1024
    global_load_lds_dwordx4 v45, s[30:31]
    s_add_u32 s30, s30, 8192
    s_addc_u32 s31, s31, 0
    s_mov_b32 m0, s19
    s_add_u32 s19, s19, 1024
    global_load_lds_dwordx4 v45, s[30:31]
    s_add_u32 s30, s30, 8192
    s_addc_u32 s31, s31, 0
    s_mov_b32 m0, s19
    s_add_u32 s19, s19, 1024
    global_load_lds_dwordx4 v45, s[30:31]
    s_add_u32 s30, s30, 8192
    s_addc_u32 s31, s31, 0
    s_mov_b32 m0, s19
    s_add_u32 s19, s19, 1024
    global_load_lds_dwordx4 v45, s[30:31]
    s_add_u32 s30, s30, 8192
    s_addc_u32 s31, s31, 0
    s_mov_b32 m0, s19
    s_add_u32 s19, s19, 1024
    global_load_lds_dwordx4 v45, s[30:31]
    s_add_u32 s30, s30, 8192
    s_addc_u32 s31, s31, 0
    s_mov_b32 m0, s19
    s_add_u32 s19, s19, 1024
    global_load_lds_dwordx4 v45, s[30:31]
    s_add_u32 s30, s30, 8192
    s_addc_u32 s31, s31, 0
    s_mov_b32 m0, s19
    s_add_u32 s19, s19, 1024
    global_load_lds_dwordx4 v45, s[30:31]
    s_add_u32 s30, s30, 8192
    s_addc_u32 s31, s31, 0
    s_mov_b32 m0, s19
    s_add_u32 s19, s19, 1024
    global_load_lds_dwordx4 v45, s[30:31]
    s_add_u32 s30, s30, 8192
    s_addc_u32 s31, s31, 0
    s_mov_b32 m0, s19
    s_add_u32 s19, s19, 1024
    global_load_lds_dwordx4 v45, s[30:31]
    s_add_u32 s30, s30, 8192
    s_addc_u32 s31, s31, 0
    s_mov_b32 m0, s19
    s_add_u32 s19, s19, 1024
    global_load_lds_dwordx4 v45, s[30:31]
    s_add_u32 s30, s30, 8192
    s_addc_u32 s31, s31, 0
    s_mov_b32 m0, s19
    s_add_u32 s19, s19, 1024
    global_load_lds_dwordx4 v45, s[30:31]
    s_add_u32 s30, s30, 8192
    s_addc_u32 s31, s31, 0
    s_waitcnt vmcnt(0)
    ds_read_b64_tr_b16 a[0:1], v46 offset:0
    ds_read_b64_tr_b16 a[2:3], v46 offset:512
    ds_read_b64_tr_b16 a[128:129], v46 offset:64
    ds_read_b64_tr_b16 a[130:131], v46 offset:576
    ds_read_b64_tr_b16 a[4:5], v46 offset:2048
    ds_read_b64_tr_b16 a[6:7], v46 offset:2560
    ds_read_b64_tr_b16 a[132:133], v46 offset:2112
    ds_read_b64_tr_b16 a[134:135], v46 offset:2624
    s_waitcnt lgkmcnt(0)
    ds_read_b64_tr_b16 a[8:9], v46 offset:4096
    ds_read_b64_tr_b16 a[10:11], v46 offset:4608
    ds_read_b64_tr_b16 a[136:137], v46 offset:4160
    ds_read_b64_tr_b16 a[138:139], v46 offset:4672
    ds_read_b64_tr_b16 a[12:13], v46 offset:6144
    ds_read_b64_tr_b16 a[14:15], v46 offset:6656
    ds_read_b64_tr_b16 a[140:141], v46 offset:6208
    ds_read_b64_tr_b16 a[142:143], v46 offset:6720
    s_waitcnt lgkmcnt(0)
    ds_read_b64_tr_b16 a[16:17], v46 offset:8192
    ds_read_b64_tr_b16 a[18:19], v46 offset:8704
    ds_read_b64_tr_b16 a[144:145], v46 offset:8256
    ds_read_b64_tr_b16 a[146:147], v46 offset:8768
    ds_read_b64_tr_b16 a[20:21], v46 offset:10240
    ds_read_b64_tr_b16 a[22:23], v46 offset:10752
    ds_read_b64_tr_b16 a[148:149], v46 offset:10304
    ds_read_b64_tr_b16 a[150:151], v46 offset:10816
    s_waitcnt lgkmcnt(0)
    ds_read_b64_tr_b16 a[24:25], v46 offset:12288
    ds_read_b64_tr_b16 a[26:27], v46 offset:12800
    ds_read_b64_tr_b16 a[152:153], v46 offset:12352
    ds_read_b64_tr_b16 a[154:155], v46 offset:12864
    ds_read_b64_tr_b16 a[28:29], v46 offset:14336
    ds_read_b64_tr_b16 a[30:31], v46 offset:14848
    ds_read_b64_tr_b16 a[156:157], v46 offset:14400
    ds_read_b64_tr_b16 a[158:159], v46 offset:14912
    s_waitcnt lgkmcnt(0)
    ds_read_b64_tr_b16 a[32:33], v46 offset:16384
    ds_read_b64_tr_b16 a[34:35], v46 offset:16896
    ds_read_b64_tr_b16 a[160:161], v46 offset:16448
    ds_read_b64_tr_b16 a[162:163], v46 offset:16960
    ds_read_b64_tr_b16 a[36:37], v46 offset:18432
    ds_read_b64_tr_b16 a[38:39], v46 offset:18944
    ds_read_b64_tr_b16 a[164:165], v46 offset:18496
    ds_read_b64_tr_b16 a[166:167], v46 offset:19008
    s_waitcnt lgkmcnt(0)
    ds_read_b64_tr_b16 a[40:41], v46 offset:20480
    ds_read_b64_tr_b16 a[42:43], v46 offset:20992
    ds_read_b64_tr_b16 a[168:169], v46 offset:20544
    ds_read_b64_tr_b16 a[170:171], v46 offset:21056
    ds_read_b64_tr_b16 a[44:45], v46 offset:22528
    ds_read_b64_tr_b16 a[46:47], v46 offset:23040
    ds_read_b64_tr_b16 a[172:173], v46 offset:22592
    ds_read_b64_tr_b16 a[174:175], v46 offset:23104
    s_waitcnt lgkmcnt(0)
    ds_read_b64_tr_b16 a[48:49], v46 offset:24576
    ds_read_b64_tr_b16 a[50:51], v46 offset:25088
    ds_read_b64_tr_b16 a[176:177], v46 offset:24640
    ds_read_b64_tr_b16 a[178:179], v46 offset:25152
    ds_read_b64_tr_b16 a[52:53], v46 offset:26624
    ds_read_b64_tr_b16 a[54:55], v46 offset:27136
    ds_read_b64_tr_b16 a[180:181], v46 offset:26688
    ds_read_b64_tr_b16 a[182:183], v46 offset:27200
    s_waitcnt lgkmcnt(0)
    ds_read_b64_tr_b16 a[56:57], v46 offset:28672
    ds_read_b64_tr_b16 a[58:59], v46 offset:29184
    ds_read_b64_tr_b16 a[184:185], v46 offset:28736
    ds_read_b64_tr_b16 a[186:187], v46 offset:29248
    ds_read_b64_tr_b16 a[60:61], v46 offset:30720
    ds_read_b64_tr_b16 a[62:63], v46 offset:31232
    ds_read_b64_tr_b16 a[188:189], v46 offset:30784
    ds_read_b64_tr_b16 a[190:191], v46 offset:31296
    s_waitcnt lgkmcnt(0)
    s_waitcnt lgkmcnt(0)
    s_load_dwordx2 s[30:31], s[0:1], 16
    s_lshl_b32 s17, s4, 9
    s_lshl_b32 s18, s5, 7
    s_add_u32 s17, s17, s18
    s_add_u32 s17, s17, 262144
    s_lshl_b32 s19, s5, 15
    s_waitcnt lgkmcnt(0)
    s_add_u32 s30, s30, s17
    s_addc_u32 s31, s31, 0
    s_mov_b32 m0, s19
    s_add_u32 s19, s19, 1024
    global_load_lds_dwordx4 v45, s[30:31]
    s_add_u32 s30, s30, 8192
    s_addc_u32 s31, s31, 0
    s_mov_b32 m0, s19
    s_add_u32 s19, s19, 1024
    global_load_lds_dwordx4 v45, s[30:31]
    s_add_u32 s30, s30, 8192
    s_addc_u32 s31, s31, 0
    s_mov_b32 m0, s19
    s_add_u32 s19, s19, 1024
    global_load_lds_dwordx4 v45, s[30:31]
    s_add_u32 s30, s30, 8192
    s_addc_u32 s31, s31, 0
    s_mov_b32 m0, s19
    s_add_u32 s19, s19, 1024
    global_load_lds_dwordx4 v45, s[30:31]
    s_add_u32 s30, s30, 8192
    s_addc_u32 s31, s31, 0
    s_mov_b32 m0, s19
    s_add_u32 s19, s19, 1024
    global_load_lds_dwordx4 v45, s[30:31]
    s_add_u32 s30, s30, 8192
    s_addc_u32 s31, s31, 0
    s_mov_b32 m0, s19
    s_add_u32 s19, s19, 1024
    global_load_lds_dwordx4 v45, s[30:31]
    s_add_u32 s30, s30, 8192
    s_addc_u32 s31, s31, 0
    s_mov_b32 m0, s19
    s_add_u32 s19, s19, 1024
    global_load_lds_dwordx4 v45, s[30:31]
    s_add_u32 s30, s30, 8192
    s_addc_u32 s31, s31, 0
    s_mov_b32 m0, s19
    s_add_u32 s19, s19, 1024
    global_load_lds_dwordx4 v45, s[30:31]
    s_add_u32 s30, s30, 8192
    s_addc_u32 s31, s31, 0
    s_mov_b32 m0, s19
    s_add_u32 s19, s19, 1024
    global_load_lds_dwordx4 v45, s[30:31]
    s_add_u32 s30, s30, 8192
    s_addc_u32 s31, s31, 0
    s_mov_b32 m0, s19
    s_add_u32 s19, s19, 1024
    global_load_lds_dwordx4 v45, s[30:31]
    s_add_u32 s30, s30, 8192
    s_addc_u32 s31, s31, 0
    s_mov_b32 m0, s19
    s_add_u32 s19, s19, 1024
    global_load_lds_dwordx4 v45, s[30:31]
    s_add_u32 s30, s30, 8192
    s_addc_u32 s31, s31, 0
    s_mov_b32 m0, s19
    s_add_u32 s19, s19, 1024
    global_load_lds_dwordx4 v45, s[30:31]
    s_add_u32 s30, s30, 8192
    s_addc_u32 s31, s31, 0
    s_mov_b32 m0, s19
    s_add_u32 s19, s19, 1024
    global_load_lds_dwordx4 v45, s[30:31]
    s_add_u32 s30, s30, 8192
    s_addc_u32 s31, s31, 0
    s_mov_b32 m0, s19
    s_add_u32 s19, s19, 1024
    global_load_lds_dwordx4 v45, s[30:31]
    s_add_u32 s30, s30, 8192
    s_addc_u32 s31, s31, 0
    s_mov_b32 m0, s19
    s_add_u32 s19, s19, 1024
    global_load_lds_dwordx4 v45, s[30:31]
    s_add_u32 s30, s30, 8192
    s_addc_u32 s31, s31, 0
    s_mov_b32 m0, s19
    s_add_u32 s19, s19, 1024
    global_load_lds_dwordx4 v45, s[30:31]
    s_add_u32 s30, s30, 8192
    s_addc_u32 s31, s31, 0
    s_mov_b32 m0, s19
    s_add_u32 s19, s19, 1024
    global_load_lds_dwordx4 v45, s[30:31]
    s_add_u32 s30, s30, 8192
    s_addc_u32 s31, s31, 0
    s_mov_b32 m0, s19
    s_add_u32 s19, s19, 1024
    global_load_lds_dwordx4 v45, s[30:31]
    s_add_u32 s30, s30, 8192
    s_addc_u32 s31, s31, 0
    s_mov_b32 m0, s19
    s_add_u32 s19, s19, 1024
    global_load_lds_dwordx4 v45, s[30:31]
    s_add_u32 s30, s30, 8192
    s_addc_u32 s31, s31, 0
    s_mov_b32 m0, s19
    s_add_u32 s19, s19, 1024
    global_load_lds_dwordx4 v45, s[30:31]
    s_add_u32 s30, s30, 8192
    s_addc_u32 s31, s31, 0
    s_mov_b32 m0, s19
    s_add_u32 s19, s19, 1024
    global_load_lds_dwordx4 v45, s[30:31]
    s_add_u32 s30, s30, 8192
    s_addc_u32 s31, s31, 0
    s_mov_b32 m0, s19
    s_add_u32 s19, s19, 1024
    global_load_lds_dwordx4 v45, s[30:31]
    s_add_u32 s30, s30, 8192
    s_addc_u32 s31, s31, 0
    s_mov_b32 m0, s19
    s_add_u32 s19, s19, 1024
    global_load_lds_dwordx4 v45, s[30:31]
    s_add_u32 s30, s30, 8192
    s_addc_u32 s31, s31, 0
    s_mov_b32 m0, s19
    s_add_u32 s19, s19, 1024
    global_load_lds_dwordx4 v45, s[30:31]
    s_add_u32 s30, s30, 8192
    s_addc_u32 s31, s31, 0
    s_mov_b32 m0, s19
    s_add_u32 s19, s19, 1024
    global_load_lds_dwordx4 v45, s[30:31]
    s_add_u32 s30, s30, 8192
    s_addc_u32 s31, s31, 0
    s_mov_b32 m0, s19
    s_add_u32 s19, s19, 1024
    global_load_lds_dwordx4 v45, s[30:31]
    s_add_u32 s30, s30, 8192
    s_addc_u32 s31, s31, 0
    s_mov_b32 m0, s19
    s_add_u32 s19, s19, 1024
    global_load_lds_dwordx4 v45, s[30:31]
    s_add_u32 s30, s30, 8192
    s_addc_u32 s31, s31, 0
    s_mov_b32 m0, s19
    s_add_u32 s19, s19, 1024
    global_load_lds_dwordx4 v45, s[30:31]
    s_add_u32 s30, s30, 8192
    s_addc_u32 s31, s31, 0
    s_mov_b32 m0, s19
    s_add_u32 s19, s19, 1024
    global_load_lds_dwordx4 v45, s[30:31]
    s_add_u32 s30, s30, 8192
    s_addc_u32 s31, s31, 0
    s_mov_b32 m0, s19
    s_add_u32 s19, s19, 1024
    global_load_lds_dwordx4 v45, s[30:31]
    s_add_u32 s30, s30, 8192
    s_addc_u32 s31, s31, 0
    s_mov_b32 m0, s19
    s_add_u32 s19, s19, 1024
    global_load_lds_dwordx4 v45, s[30:31]
    s_add_u32 s30, s30, 8192
    s_addc_u32 s31, s31, 0
    s_mov_b32 m0, s19
    s_add_u32 s19, s19, 1024
    global_load_lds_dwordx4 v45, s[30:31]
    s_add_u32 s30, s30, 8192
    s_addc_u32 s31, s31, 0
    s_waitcnt vmcnt(0)
    ds_read_b64_tr_b16 a[64:65], v46 offset:0
    ds_read_b64_tr_b16 a[66:67], v46 offset:512
    ds_read_b64_tr_b16 a[192:193], v46 offset:64
    ds_read_b64_tr_b16 a[194:195], v46 offset:576
    ds_read_b64_tr_b16 a[68:69], v46 offset:2048
    ds_read_b64_tr_b16 a[70:71], v46 offset:2560
    ds_read_b64_tr_b16 a[196:197], v46 offset:2112
    ds_read_b64_tr_b16 a[198:199], v46 offset:2624
    s_waitcnt lgkmcnt(0)
    ds_read_b64_tr_b16 a[72:73], v46 offset:4096
    ds_read_b64_tr_b16 a[74:75], v46 offset:4608
    ds_read_b64_tr_b16 a[200:201], v46 offset:4160
    ds_read_b64_tr_b16 a[202:203], v46 offset:4672
    ds_read_b64_tr_b16 a[76:77], v46 offset:6144
    ds_read_b64_tr_b16 a[78:79], v46 offset:6656
    ds_read_b64_tr_b16 a[204:205], v46 offset:6208
    ds_read_b64_tr_b16 a[206:207], v46 offset:6720
    s_waitcnt lgkmcnt(0)
    ds_read_b64_tr_b16 a[80:81], v46 offset:8192
    ds_read_b64_tr_b16 a[82:83], v46 offset:8704
    ds_read_b64_tr_b16 a[208:209], v46 offset:8256
    ds_read_b64_tr_b16 a[210:211], v46 offset:8768
    ds_read_b64_tr_b16 a[84:85], v46 offset:10240
    ds_read_b64_tr_b16 a[86:87], v46 offset:10752
    ds_read_b64_tr_b16 a[212:213], v46 offset:10304
    ds_read_b64_tr_b16 a[214:215], v46 offset:10816
    s_waitcnt lgkmcnt(0)
    ds_read_b64_tr_b16 a[88:89], v46 offset:12288
    ds_read_b64_tr_b16 a[90:91], v46 offset:12800
    ds_read_b64_tr_b16 a[216:217], v46 offset:12352
    ds_read_b64_tr_b16 a[218:219], v46 offset:12864
    ds_read_b64_tr_b16 a[92:93], v46 offset:14336
    ds_read_b64_tr_b16 a[94:95], v46 offset:14848
    ds_read_b64_tr_b16 a[220:221], v46 offset:14400
    ds_read_b64_tr_b16 a[222:223], v46 offset:14912
    s_waitcnt lgkmcnt(0)
    ds_read_b64_tr_b16 a[96:97], v46 offset:16384
    ds_read_b64_tr_b16 a[98:99], v46 offset:16896
    ds_read_b64_tr_b16 a[224:225], v46 offset:16448
    ds_read_b64_tr_b16 a[226:227], v46 offset:16960
    ds_read_b64_tr_b16 a[100:101], v46 offset:18432
    ds_read_b64_tr_b16 a[102:103], v46 offset:18944
    ds_read_b64_tr_b16 a[228:229], v46 offset:18496
    ds_read_b64_tr_b16 a[230:231], v46 offset:19008
    s_waitcnt lgkmcnt(0)
    ds_read_b64_tr_b16 a[104:105], v46 offset:20480
    ds_read_b64_tr_b16 a[106:107], v46 offset:20992
    ds_read_b64_tr_b16 a[232:233], v46 offset:20544
    ds_read_b64_tr_b16 a[234:235], v46 offset:21056
    ds_read_b64_tr_b16 a[108:109], v46 offset:22528
    ds_read_b64_tr_b16 a[110:111], v46 offset:23040
    ds_read_b64_tr_b16 a[236:237], v46 offset:22592
    ds_read_b64_tr_b16 a[238:239], v46 offset:23104
    s_waitcnt lgkmcnt(0)
    ds_read_b64_tr_b16 a[112:113], v46 offset:24576
    ds_read_b64_tr_b16 a[114:115], v46 offset:25088
    ds_read_b64_tr_b16 a[240:241], v46 offset:24640
    ds_read_b64_tr_b16 a[242:243], v46 offset:25152
    ds_read_b64_tr_b16 a[116:117], v46 offset:26624
    ds_read_b64_tr_b16 a[118:119], v46 offset:27136
    ds_read_b64_tr_b16 a[244:245], v46 offset:26688
    ds_read_b64_tr_b16 a[246:247], v46 offset:27200
    s_waitcnt lgkmcnt(0)
    ds_read_b64_tr_b16 a[120:121], v46 offset:28672
    ds_read_b64_tr_b16 a[122:123], v46 offset:29184
    ds_read_b64_tr_b16 a[248:249], v46 offset:28736
    ds_read_b64_tr_b16 a[250:251], v46 offset:29248
    ds_read_b64_tr_b16 a[124:125], v46 offset:30720
    ds_read_b64_tr_b16 a[126:127], v46 offset:31232
    ds_read_b64_tr_b16 a[252:253], v46 offset:30784
    ds_read_b64_tr_b16 a[254:255], v46 offset:31296
    s_waitcnt lgkmcnt(0)
    s_waitcnt lgkmcnt(0)
    s_barrier
    v_lshlrev_b32 v0, 4, v40
    v_xor_b32 v1, 0x8000, v0
    s_lshl_b32 s28, s5, 12
    s_mul_i32 s17, s6, 1024
    s_add_u32 s17, s17, 16384
    v_and_b32 v2, 3, v40
    v_lshlrev_b32 v2, 2, v2
    v_bfe_u32 v47, v40, 2, 3
    v_lshl_add_u32 v2, v47, 6, v2
    v_add_u32 v2, s17, v2
    s_mov_b32 s12, s8
    s_mov_b32 s13, s9
    s_mul_i32 s18, s6, 256
    s_add_u32 s18, s18, 18432
    s_lshl_b32 s17, s4, 4
    s_add_u32 s17, s17, s5
    s_lshl_b32 s17, s17, 2
    s_add_u32 s18, s18, s17
    s_add_u32 s26, s8, s18
    s_addc_u32 s27, s9, 0
    s_mul_i32 s18, s6, 2097152
    s_add_u32 s18, s18, 12582912
    s_lshl_b32 s17, s5, 12
    s_add_u32 s18, s18, s17
    s_add_u32 s10, s8, s18
    s_addc_u32 s11, s9, 0
    s_mul_i32 s18, s6, 2097152
    s_add_u32 s18, s18, 4194304
    s_lshl_b32 s17, s4, 14
    s_lshl_b32 s19, s5, 12
    s_add_u32 s17, s17, s19
    s_add_u32 s18, s18, s17
    s_add_u32 s22, s8, s18
    s_addc_u32 s23, s9, 0
    s_mul_i32 s18, s6, 2097152
    s_add_u32 s18, s18, 16777216
    s_lshl_b32 s17, s4, 14
    s_lshl_b32 s19, s5, 12
    s_add_u32 s17, s17, s19
    s_add_u32 s18, s18, s17
    s_add_u32 s20, s8, s18
    s_addc_u32 s21, s9, 0
    s_mul_i32 s18, s6, 262144
    s_add_u32 s18, s18, 20971520
    s_lshl_b32 s17, s4, 2
    s_add_u32 s17, s17, s5
    s_lshl_b32 s17, s17, 8
    s_add_u32 s18, s18, s17
    s_add_u32 s24, s8, s18
    s_addc_u32 s25, s9, 0
    v_lshlrev_b32 v4, 4, v41
    v_lshl_add_u32 v4, v42, 3, v4
    v_lshlrev_b32 v5, 3, v41
    s_load_dwordx2 s[30:31], s[0:1], 88
    s_mov_b32 s14, 1
    s_mov_b32 s7, 0
    v_mov_b32 v123, 248
    s_waitcnt lgkmcnt(0)
    s_mov_b32 s16, 0
Lp_166:
    global_load_dword v3, v123, s[30:31] sc1
    s_add_u32 s16, s16, 1
    s_cmp_gt_u32 s16, 262144
    s_cbranch_scc1 Lwito_164
    s_waitcnt vmcnt(0)
    v_cmp_gt_u32 vcc, s14, v3
    s_cbranch_vccnz Lp_166
    s_branch Lwisk_165
Lwito_164:
    s_load_dwordx2 s[30:31], s[0:1], 88
    s_waitcnt lgkmcnt(0)
    s_mov_b64 exec, 1
    v_mov_b32 v2, 176
    v_mov_b32 v3, s7
    v_add_u32 v3, 0x10000, v3
    global_store_dword v2, v3, s[30:31] sc1
    s_waitcnt vmcnt(0)
    s_endpgm
Lwisk_165:
    s_mov_b32 s7, 0
    s_mov_b32 s19, 0
    s_mov_b32 s35, 0
    s_mov_b32 s37, 0
    s_add_u32 s14, s19, 1
    s_mov_b32 s16, 0
Lp_167:
    global_load_dword v3, v2, s[12:13] sc1
    s_add_u32 s16, s16, 1
    s_cmp_gt_u32 s16, 262144
    s_cbranch_scc1 LtoTW_162
    s_waitcnt vmcnt(0)
    v_cmp_gt_u32 vcc, s14, v3
    s_cbranch_vccnz Lp_167
    s_add_u32 s17, s28, 0
    s_mov_b32 m0, s17
    s_nop 0
    global_load_lds_dwordx4 v0, s[10:11] offset:0 sc1
    global_load_lds_dwordx4 v0, s[10:11] offset:1024 sc1
    global_load_lds_dwordx4 v0, s[10:11] offset:2048 sc1
    global_load_lds_dwordx4 v0, s[10:11] offset:3072 sc1
    s_add_u32 s10, s10, 16384
    s_addc_u32 s11, s11, 0
    s_add_u32 s17, s28, 16384
    s_mov_b32 m0, s17
    s_nop 0
    global_load_lds_dwordx4 v0, s[10:11] offset:0 sc1
    global_load_lds_dwordx4 v0, s[10:11] offset:1024 sc1
    global_load_lds_dwordx4 v0, s[10:11] offset:2048 sc1
    global_load_lds_dwordx4 v0, s[10:11] offset:3072 sc1
    s_add_u32 s10, s10, 16384
    s_addc_u32 s11, s11, 0
    s_waitcnt vmcnt(0)
    s_barrier
LitTW_163:
    v_xor_b32 v1, 0x8000, v1
    s_xor_b32 s28, s28, 0x8000
    s_add_u32 s19, s7, 1
    s_add_u32 s14, s19, 1
    s_cmp_ge_u32 s19, 64
    s_cselect_b32 s15, 1, 0
    ds_read_b128 v[8:11], v1 offset:0
    ds_read_b128 v[12:15], v1 offset:1024
    ds_read_b128 v[16:19], v1 offset:2048
    ds_read_b128 v[20:23], v1 offset:3072
    s_waitcnt lgkmcnt(3)
    v_mfma_f32_32x32x16_bf16 v[32:47], a[0:3], v[8:11], 0
    v_mfma_f32_32x32x16_bf16 v[48:63], a[128:131], v[8:11], 0
    global_load_dword v3, v2, s[12:13] sc1
    ds_read_b128 v[8:11], v1 offset:4096
    s_waitcnt lgkmcnt(3)
    v_mfma_f32_32x32x16_bf16 v[32:47], a[4:7], v[12:15], v[32:47]
    v_mfma_f32_32x32x16_bf16 v[48:63], a[132:135], v[12:15], v[48:63]
    global_load_dwordx4 v[64:67], v0, s[22:23] offset:0 sc1
    ds_read_b128 v[12:15], v1 offset:5120
    s_waitcnt lgkmcnt(3)
    v_mfma_f32_32x32x16_bf16 v[32:47], a[8:11], v[16:19], v[32:47]
    v_mfma_f32_32x32x16_bf16 v[48:63], a[136:139], v[16:19], v[48:63]
    global_load_dwordx4 v[68:71], v0, s[22:23] offset:1024 sc1
    ds_read_b128 v[16:19], v1 offset:6144
    s_waitcnt lgkmcnt(3)
    v_mfma_f32_32x32x16_bf16 v[32:47], a[12:15], v[20:23], v[32:47]
    v_mfma_f32_32x32x16_bf16 v[48:63], a[140:143], v[20:23], v[48:63]
    global_load_dwordx4 v[72:75], v0, s[22:23] offset:2048 sc1
    ds_read_b128 v[20:23], v1 offset:7168
    s_waitcnt lgkmcnt(3)
    v_mfma_f32_32x32x16_bf16 v[32:47], a[16:19], v[8:11], v[32:47]
    v_mfma_f32_32x32x16_bf16 v[48:63], a[144:147], v[8:11], v[48:63]
    global_load_dwordx4 v[76:79], v0, s[22:23] offset:3072 sc1
    ds_read_b128 v[8:11], v1 offset:8192
    s_waitcnt lgkmcnt(3)
    v_mfma_f32_32x32x16_bf16 v[32:47], a[20:23], v[12:15], v[32:47]
    v_mfma_f32_32x32x16_bf16 v[48:63], a[148:151], v[12:15], v[48:63]
    s_add_u32 s22, s22, 32768
    s_addc_u32 s23, s23, 0
    ds_read_b128 v[12:15], v1 offset:9216
    s_waitcnt lgkmcnt(3)
    v_mfma_f32_32x32x16_bf16 v[32:47], a[24:27], v[16:19], v[32:47]
    v_mfma_f32_32x32x16_bf16 v[48:63], a[152:155], v[16:19], v[48:63]
    ds_read_b128 v[16:19], v1 offset:10240
    s_waitcnt lgkmcnt(3)
    v_mfma_f32_32x32x16_bf16 v[32:47], a[28:31], v[20:23], v[32:47]
    v_mfma_f32_32x32x16_bf16 v[48:63], a[156:159], v[20:23], v[48:63]
    ds_read_b128 v[20:23], v1 offset:11264
    s_waitcnt lgkmcnt(3)
    v_mfma_f32_32x32x16_bf16 v[32:47], a[32:35], v[8:11], v[32:47]
    v_mfma_f32_32x32x16_bf16 v[48:63], a[160:163], v[8:11], v[48:63]
    ds_read_b128 v[8:11], v1 offset:12288
    s_waitcnt lgkmcnt(3)
    v_mfma_f32_32x32x16_bf16 v[32:47], a[36:39], v[12:15], v[32:47]
    v_mfma_f32_32x32x16_bf16 v[48:63], a[164:167], v[12:15], v[48:63]
    ds_read_b128 v[12:15], v1 offset:13312
    s_waitcnt lgkmcnt(3)
    v_mfma_f32_32x32x16_bf16 v[32:47], a[40:43], v[16:19], v[32:47]
    v_mfma_f32_32x32x16_bf16 v[48:63], a[168:171], v[16:19], v[48:63]
    ds_read_b128 v[16:19], v1 offset:14336
    s_waitcnt lgkmcnt(3)
    v_mfma_f32_32x32x16_bf16 v[32:47], a[44:47], v[20:23], v[32:47]
    v_mfma_f32_32x32x16_bf16 v[48:63], a[172:175], v[20:23], v[48:63]
    ds_read_b128 v[20:23], v1 offset:15360
    s_waitcnt lgkmcnt(3)
    v_mfma_f32_32x32x16_bf16 v[32:47], a[48:51], v[8:11], v[32:47]
    v_mfma_f32_32x32x16_bf16 v[48:63], a[176:179], v[8:11], v[48:63]
    s_waitcnt vmcnt(4)
    s_barrier
    v_cmp_gt_u32 vcc, s14, v3
    s_cmp_eq_u32 s35, 0
    s_cbranch_scc1 Lnp_169
    v_mov_b32 v3, s7
    s_mov_b64 exec, 1
    global_store_dword v0, v3, s[26:27] sc1
    s_mov_b64 exec, -1
Lpub_170:
    s_mov_b32 s35, 0
Lnp_169:
    s_cmp_lg_u32 s15, 0
    s_cbranch_scc1 Lhk_168
    s_cbranch_vccnz Lnr_171
    s_mov_b32 s15, 1
    s_mov_b32 s37, 1
    s_branch Lhk_168
Lnr_171:
    global_load_dword v3, v2, s[12:13] sc1
Lhk_168:
    ds_read_b128 v[8:11], v1 offset:16384
    s_waitcnt lgkmcnt(3)
    v_mfma_f32_32x32x16_bf16 v[32:47], a[52:55], v[12:15], v[32:47]
    v_mfma_f32_32x32x16_bf16 v[48:63], a[180:183], v[12:15], v[48:63]
    s_cmp_eq_u32 s37, 0
    s_cbranch_scc1 Lch_172
    s_add_u32 s17, s28, 0
    s_mov_b32 m0, s17
    s_nop 0
    global_load_lds_dwordx4 v0, s[10:11] offset:0 sc1
Lch_172:
    ds_read_b128 v[12:15], v1 offset:17408
    s_waitcnt lgkmcnt(3)
    v_mfma_f32_32x32x16_bf16 v[32:47], a[56:59], v[16:19], v[32:47]
    v_mfma_f32_32x32x16_bf16 v[48:63], a[184:187], v[16:19], v[48:63]
    s_cmp_eq_u32 s37, 0
    s_cbranch_scc1 Lch_173
    global_load_lds_dwordx4 v0, s[10:11] offset:1024 sc1
Lch_173:
    ds_read_b128 v[16:19], v1 offset:18432
    s_waitcnt lgkmcnt(3)
    v_mfma_f32_32x32x16_bf16 v[32:47], a[60:63], v[20:23], v[32:47]
    v_mfma_f32_32x32x16_bf16 v[48:63], a[188:191], v[20:23], v[48:63]
    s_cmp_eq_u32 s37, 0
    s_cbranch_scc1 Lch_174
    global_load_lds_dwordx4 v0, s[10:11] offset:2048 sc1
Lch_174:
    ds_read_b128 v[20:23], v1 offset:19456
    s_waitcnt lgkmcnt(3)
    v_mfma_f32_32x32x16_bf16 v[32:47], a[64:67], v[8:11], v[32:47]
    v_mfma_f32_32x32x16_bf16 v[48:63], a[192:195], v[8:11], v[48:63]
    s_cmp_eq_u32 s37, 0
    s_cbranch_scc1 Lch_175
    global_load_lds_dwordx4 v0, s[10:11] offset:3072 sc1
    s_add_u32 s10, s10, 16384
    s_addc_u32 s11, s11, 0
Lch_175:
    ds_read_b128 v[8:11], v1 offset:20480
    s_waitcnt lgkmcnt(3)
    v_mfma_f32_32x32x16_bf16 v[32:47], a[68:71], v[12:15], v[32:47]
    v_mfma_f32_32x32x16_bf16 v[48:63], a[196:199], v[12:15], v[48:63]
    s_cmp_eq_u32 s37, 0
    s_cbranch_scc1 Lch_176
    s_add_u32 s17, s28, 16384
    s_mov_b32 m0, s17
    s_nop 0
    global_load_lds_dwordx4 v0, s[10:11] offset:0 sc1
Lch_176:
    ds_read_b128 v[12:15], v1 offset:21504
    s_waitcnt lgkmcnt(3)
    v_mfma_f32_32x32x16_bf16 v[32:47], a[72:75], v[16:19], v[32:47]
    v_mfma_f32_32x32x16_bf16 v[48:63], a[200:203], v[16:19], v[48:63]
    s_cmp_eq_u32 s37, 0
    s_cbranch_scc1 Lch_177
    global_load_lds_dwordx4 v0, s[10:11] offset:1024 sc1
Lch_177:
    ds_read_b128 v[16:19], v1 offset:22528
    s_waitcnt lgkmcnt(3)
    v_mfma_f32_32x32x16_bf16 v[32:47], a[76:79], v[20:23], v[32:47]
    v_mfma_f32_32x32x16_bf16 v[48:63], a[204:207], v[20:23], v[48:63]
    s_cmp_eq_u32 s37, 0
    s_cbranch_scc1 Lch_178
    global_load_lds_dwordx4 v0, s[10:11] offset:2048 sc1
Lch_178:
    ds_read_b128 v[20:23], v1 offset:23552
    s_waitcnt lgkmcnt(3)
    v_mfma_f32_32x32x16_bf16 v[32:47], a[80:83], v[8:11], v[32:47]
    v_mfma_f32_32x32x16_bf16 v[48:63], a[208:211], v[8:11], v[48:63]
    s_cmp_eq_u32 s37, 0
    s_cbranch_scc1 Lch_179
    global_load_lds_dwordx4 v0, s[10:11] offset:3072 sc1
    s_add_u32 s10, s10, 16384
    s_addc_u32 s11, s11, 0
    s_mov_b32 s37, 0
Lch_179:
    ds_read_b128 v[8:11], v1 offset:24576
    s_waitcnt lgkmcnt(3)
    v_mfma_f32_32x32x16_bf16 v[32:47], a[84:87], v[12:15], v[32:47]
    v_mfma_f32_32x32x16_bf16 v[48:63], a[212:215], v[12:15], v[48:63]
    ds_read_b128 v[12:15], v1 offset:25600
    s_waitcnt lgkmcnt(3)
    v_mfma_f32_32x32x16_bf16 v[32:47], a[88:91], v[16:19], v[32:47]
    v_mfma_f32_32x32x16_bf16 v[48:63], a[216:219], v[16:19], v[48:63]
    ds_read_b128 v[16:19], v1 offset:26624
    s_waitcnt lgkmcnt(3)
    v_mfma_f32_32x32x16_bf16 v[32:47], a[92:95], v[20:23], v[32:47]
    v_mfma_f32_32x32x16_bf16 v[48:63], a[220:223], v[20:23], v[48:63]
    ds_read_b128 v[20:23], v1 offset:27648
    s_waitcnt lgkmcnt(3)
    v_mfma_f32_32x32x16_bf16 v[32:47], a[96:99], v[8:11], v[32:47]
    v_mfma_f32_32x32x16_bf16 v[48:63], a[224:227], v[8:11], v[48:63]
    s_cmp_lg_u32 s15, 0
    s_cbranch_scc1 Lhk_180
    s_waitcnt vmcnt(0)
    v_cmp_gt_u32 vcc, s14, v3
    s_cbranch_vccnz Lnr1_181
    s_add_u32 s17, s28, 0
    s_mov_b32 m0, s17
    s_nop 0
    global_load_lds_dwordx4 v0, s[10:11] offset:0 sc1
    global_load_lds_dwordx4 v0, s[10:11] offset:1024 sc1
    global_load_lds_dwordx4 v0, s[10:11] offset:2048 sc1
    global_load_lds_dwordx4 v0, s[10:11] offset:3072 sc1
    s_add_u32 s10, s10, 16384
    s_addc_u32 s11, s11, 0
    s_add_u32 s17, s28, 16384
    s_mov_b32 m0, s17
    s_nop 0
    global_load_lds_dwordx4 v0, s[10:11] offset:0 sc1
    global_load_lds_dwordx4 v0, s[10:11] offset:1024 sc1
    global_load_lds_dwordx4 v0, s[10:11] offset:2048 sc1
    global_load_lds_dwordx4 v0, s[10:11] offset:3072 sc1
    s_add_u32 s10, s10, 16384
    s_addc_u32 s11, s11, 0
    s_mov_b32 s15, 1
    s_branch Lhk_180
Lnr1_181:
    global_load_dword v3, v2, s[12:13] sc1
Lhk_180:
    ds_read_b128 v[8:11], v1 offset:28672
    s_waitcnt lgkmcnt(3)
    v_mfma_f32_32x32x16_bf16 v[32:47], a[100:103], v[12:15], v[32:47]
    v_mfma_f32_32x32x16_bf16 v[48:63], a[228:231], v[12:15], v[48:63]
    ds_read_b128 v[12:15], v1 offset:29696
    s_waitcnt lgkmcnt(3)
    v_mfma_f32_32x32x16_bf16 v[32:47], a[104:107], v[16:19], v[32:47]
    v_mfma_f32_32x32x16_bf16 v[48:63], a[232:235], v[16:19], v[48:63]
    ds_read_b128 v[16:19], v1 offset:30720
    s_waitcnt lgkmcnt(3)
    v_mfma_f32_32x32x16_bf16 v[32:47], a[108:111], v[20:23], v[32:47]
    v_mfma_f32_32x32x16_bf16 v[48:63], a[236:239], v[20:23], v[48:63]
    ds_read_b128 v[20:23], v1 offset:31744
    s_waitcnt lgkmcnt(3)
    v_mfma_f32_32x32x16_bf16 v[32:47], a[112:115], v[8:11], v[32:47]
    v_mfma_f32_32x32x16_bf16 v[48:63], a[240:243], v[8:11], v[48:63]
    s_waitcnt lgkmcnt(2)
    v_mfma_f32_32x32x16_bf16 v[32:47], a[116:119], v[12:15], v[32:47]
    v_mfma_f32_32x32x16_bf16 v[48:63], a[244:247], v[12:15], v[48:63]
    s_waitcnt lgkmcnt(1)
    v_mfma_f32_32x32x16_bf16 v[32:47], a[120:123], v[16:19], v[32:47]
    v_mfma_f32_32x32x16_bf16 v[48:63], a[248:251], v[16:19], v[48:63]
    s_waitcnt lgkmcnt(0)
    v_mfma_f32_32x32x16_bf16 v[32:47], a[124:127], v[20:23], v[32:47]
    v_mfma_f32_32x32x16_bf16 v[48:63], a[252:255], v[20:23], v[48:63]
    s_nop 11
    s_cmp_ge_u32 s19, 64
    s_cbranch_scc1 Law_182
    s_waitcnt vmcnt(8)
    s_branch Law2_183
Law_182:
    s_waitcnt vmcnt(0)
Law2_183:
    v_mov_b32 v96, 0
    v_mov_b32 v97, 0
    s_mov_b32 s17, 1065369472
    s_mov_b32 s18, 0x00003f80
    s_mov_b32 s19, 0x3f800000
    v_permlane32_swap_b32 v64, v66
    v_permlane32_swap_b32 v65, v67
    v_permlane32_swap_b32 v68, v70
    v_permlane32_swap_b32 v69, v71
    v_permlane32_swap_b32 v72, v74
    v_permlane32_swap_b32 v73, v75
    v_permlane32_swap_b32 v76, v78
    v_permlane32_swap_b32 v77, v79
    s_nop 0
    v_dot2_f32_bf16 v32, v64, s18, v32
    v_dot2_f32_bf16 v33, v64, s19, v33
    v_dot2_f32_bf16 v34, v65, s18, v34
    v_dot2_f32_bf16 v35, v65, s19, v35
    v_dot2_f32_bf16 v36, v66, s18, v36
    v_dot2_f32_bf16 v37, v66, s19, v37
    v_dot2_f32_bf16 v38, v67, s18, v38
    v_dot2_f32_bf16 v39, v67, s19, v39
    v_dot2_f32_bf16 v40, v68, s18, v40
    v_dot2_f32_bf16 v41, v68, s19, v41
    v_dot2_f32_bf16 v42, v69, s18, v42
    v_dot2_f32_bf16 v43, v69, s19, v43
    v_dot2_f32_bf16 v44, v70, s18, v44
    v_dot2_f32_bf16 v45, v70, s19, v45
    v_dot2_f32_bf16 v46, v71, s18, v46
    v_dot2_f32_bf16 v47, v71, s19, v47
    v_dot2_f32_bf16 v48, v72, s18, v48
    v_dot2_f32_bf16 v49, v72, s19, v49
    v_dot2_f32_bf16 v50, v73, s18, v50
    v_dot2_f32_bf16 v51, v73, s19, v51
    v_dot2_f32_bf16 v52, v74, s18, v52
    v_dot2_f32_bf16 v53, v74, s19, v53
    v_dot2_f32_bf16 v54, v75, s18, v54
    v_dot2_f32_bf16 v55, v75, s19, v55
    v_dot2_f32_bf16 v56, v76, s18, v56
    v_dot2_f32_bf16 v57, v76, s19, v57
    v_dot2_f32_bf16 v58, v77, s18, v58
    v_dot2_f32_bf16 v59, v77, s19, v59
    v_dot2_f32_bf16 v60, v78, s18, v60
    v_dot2_f32_bf16 v61, v78, s19, v61
    v_dot2_f32_bf16 v62, v79, s18, v62
    v_dot2_f32_bf16 v63, v79, s19, v63
    s_nop 1
    v_cvt_pk_bf16_f32 v64, v32, v33
    v_cvt_pk_bf16_f32 v65, v34, v35
    v_cvt_pk_bf16_f32 v66, v36, v37
    v_cvt_pk_bf16_f32 v67, v38, v39
    v_cvt_pk_bf16_f32 v68, v40, v41
    v_cvt_pk_bf16_f32 v69, v42, v43
    v_cvt_pk_bf16_f32 v70, v44, v45
    v_cvt_pk_bf16_f32 v71, v46, v47
    v_cvt_pk_bf16_f32 v72, v48, v49
    v_cvt_pk_bf16_f32 v73, v50, v51
    v_cvt_pk_bf16_f32 v74, v52, v53
    v_cvt_pk_bf16_f32 v75, v54, v55
    v_cvt_pk_bf16_f32 v76, v56, v57
    v_cvt_pk_bf16_f32 v77, v58, v59
    v_cvt_pk_bf16_f32 v78, v60, v61
    v_cvt_pk_bf16_f32 v79, v62, v63
    s_cmp_lg_u32 s15, 0
    s_cbranch_scc1 Lhk_184
    s_waitcnt vmcnt(0)
    v_cmp_gt_u32 vcc, s14, v3
    s_cbranch_vccnz Lnr2_185
    s_mov_b32 s37, 2
    s_branch Lhk_184
Lnr2_185:
    global_load_dword v3, v2, s[12:13] sc1
Lhk_184:
    s_nop 0
    v_permlane32_swap_b32 v64, v66
    v_permlane32_swap_b32 v65, v67
    s_nop 0
    global_store_dwordx4 v0, v[64:67], s[20:21] offset:0 sc1
    v_permlane32_swap_b32 v68, v70
    v_permlane32_swap_b32 v69, v71
    s_nop 0
    global_store_dwordx4 v0, v[68:71], s[20:21] offset:1024 sc1
    v_permlane32_swap_b32 v72, v74
    v_permlane32_swap_b32 v73, v75
    s_nop 0
    global_store_dwordx4 v0, v[72:75], s[20:21] offset:2048 sc1
    v_permlane32_swap_b32 v76, v78
    v_permlane32_swap_b32 v77, v79
    s_nop 0
    global_store_dwordx4 v0, v[76:79], s[20:21] offset:3072 sc1
    v_dot2_f32_bf16 v96, v64, s17, v96
    v_dot2_f32_bf16 v97, v64, v64, v97
    v_dot2_f32_bf16 v96, v65, s17, v96
    v_dot2_f32_bf16 v97, v65, v65, v97
    v_dot2_f32_bf16 v96, v66, s17, v96
    v_dot2_f32_bf16 v97, v66, v66, v97
    v_dot2_f32_bf16 v96, v67, s17, v96
    v_dot2_f32_bf16 v97, v67, v67, v97
    v_dot2_f32_bf16 v96, v68, s17, v96
    v_dot2_f32_bf16 v97, v68, v68, v97
    v_dot2_f32_bf16 v96, v69, s17, v96
    v_dot2_f32_bf16 v97, v69, v69, v97
    v_dot2_f32_bf16 v96, v70, s17, v96
    v_dot2_f32_bf16 v97, v70, v70, v97
    v_dot2_f32_bf16 v96, v71, s17, v96
    v_dot2_f32_bf16 v97, v71, v71, v97
    v_dot2_f32_bf16 v96, v72, s17, v96
    v_dot2_f32_bf16 v97, v72, v72, v97
    v_dot2_f32_bf16 v96, v73, s17, v96
    v_dot2_f32_bf16 v97, v73, v73, v97
    v_dot2_f32_bf16 v96, v74, s17, v96
    v_dot2_f32_bf16 v97, v74, v74, v97
    v_dot2_f32_bf16 v96, v75, s17, v96
    v_dot2_f32_bf16 v97, v75, v75, v97
    v_dot2_f32_bf16 v96, v76, s17, v96
    v_dot2_f32_bf16 v97, v76, v76, v97
    v_dot2_f32_bf16 v96, v77, s17, v96
    v_dot2_f32_bf16 v97, v77, v77, v97
    v_dot2_f32_bf16 v96, v78, s17, v96
    v_dot2_f32_bf16 v97, v78, v78, v97
    v_dot2_f32_bf16 v96, v79, s17, v96
    v_dot2_f32_bf16 v97, v79, v79, v97
    s_nop 2
    v_mov_b32 v98, v96
    v_mov_b32 v99, v97
    s_nop 1
    v_permlane32_swap_b32 v96, v98
    v_permlane32_swap_b32 v97, v99
    v_add_f32 v96, v96, v98
    v_add_f32 v97, v97, v99
    s_mov_b64 exec, 0xffffffff
    global_store_dwordx2 v5, v[96:97], s[24:25] sc1
    s_mov_b64 exec, -1
    s_add_u32 s24, s24, 2048
    s_addc_u32 s25, s25, 0
    s_add_u32 s20, s20, 32768
    s_addc_u32 s21, s21, 0
    s_add_u32 s7, s7, 1
    s_cmp_lg_u32 s15, 0
    s_cbranch_scc1 Lh3_189
    s_cmp_eq_u32 s37, 2
    s_cbranch_scc1 Lh3_189
    s_waitcnt vmcnt(5)
    v_cmp_gt_u32 vcc, s14, v3
    s_cbranch_vccnz Lh3_189
    s_mov_b32 s37, 2
Lh3_189:
    s_cmp_lg_u32 s37, 2
    s_cbranch_scc1 Lng2_188
    s_add_u32 s17, s28, 0
    s_mov_b32 m0, s17
    s_nop 0
    global_load_lds_dwordx4 v0, s[10:11] offset:0 sc1
    global_load_lds_dwordx4 v0, s[10:11] offset:1024 sc1
    global_load_lds_dwordx4 v0, s[10:11] offset:2048 sc1
    global_load_lds_dwordx4 v0, s[10:11] offset:3072 sc1
    s_add_u32 s10, s10, 16384
    s_addc_u32 s11, s11, 0
    s_add_u32 s17, s28, 16384
    s_mov_b32 m0, s17
    s_nop 0
    global_load_lds_dwordx4 v0, s[10:11] offset:0 sc1
    global_load_lds_dwordx4 v0, s[10:11] offset:1024 sc1
    global_load_lds_dwordx4 v0, s[10:11] offset:2048 sc1
    global_load_lds_dwordx4 v0, s[10:11] offset:3072 sc1
    s_add_u32 s10, s10, 16384
    s_addc_u32 s11, s11, 0
    s_mov_b32 s37, 0
    s_waitcnt vmcnt(8)
    v_mov_b32 v3, s7
    s_mov_b64 exec, 1
    global_store_dword v0, v3, s[26:27] sc1
    s_mov_b64 exec, -1
Lpub_190:
    s_waitcnt vmcnt(5)
    s_branch Ljoin_187
Lng2_188:
    s_cmp_ge_u32 s7, 64
    s_cbranch_scc1 Llate_186
    s_cmp_eq_u32 s15, 0
    s_cbranch_scc1 Llate_186
    s_waitcnt vmcnt(5)
    s_mov_b32 s35, 1
    s_branch Ljoin_187
Llate_186:
    s_waitcnt vmcnt(0)
    v_mov_b32 v3, s7
    s_mov_b64 exec, 1
    global_store_dword v0, v3, s[26:27] sc1
    s_mov_b64 exec, -1
Lpub_191:
    s_cmp_ge_u32 s7, 64
    s_cbranch_scc1 Ljoin_187
    s_mov_b32 s16, 0
Lp_192:
    global_load_dword v3, v2, s[12:13] sc1
    s_add_u32 s16, s16, 1
    s_cmp_gt_u32 s16, 262144
    s_cbranch_scc1 LtoTW_162
    s_waitcnt vmcnt(0)
    v_cmp_gt_u32 vcc, s14, v3
    s_cbranch_vccnz Lp_192
    s_add_u32 s17, s28, 0
    s_mov_b32 m0, s17
    s_nop 0
    global_load_lds_dwordx4 v0, s[10:11] offset:0 sc1
    global_load_lds_dwordx4 v0, s[10:11] offset:1024 sc1
    global_load_lds_dwordx4 v0, s[10:11] offset:2048 sc1
    global_load_lds_dwordx4 v0, s[10:11] offset:3072 sc1
    s_add_u32 s10, s10, 16384
    s_addc_u32 s11, s11, 0
    s_add_u32 s17, s28, 16384
    s_mov_b32 m0, s17
    s_nop 0
    global_load_lds_dwordx4 v0, s[10:11] offset:0 sc1
    global_load_lds_dwordx4 v0, s[10:11] offset:1024 sc1
    global_load_lds_dwordx4 v0, s[10:11] offset:2048 sc1
    global_load_lds_dwordx4 v0, s[10:11] offset:3072 sc1
    s_add_u32 s10, s10, 16384
    s_addc_u32 s11, s11, 0
    s_waitcnt vmcnt(4)
Ljoin_187:
    s_barrier
    s_cmp_lt_u32 s7, 64
    s_cbranch_scc1 LitTW_163
    s_waitcnt vmcnt(0)
    s_endpgm
LtoTW_162:
    s_load_dwordx2 s[30:31], s[0:1], 88
    s_waitcnt lgkmcnt(0)
    s_mov_b64 exec, 1
    v_mov_b32 v2, 148
    v_mov_b32 v3, s7
    v_add_u32 v3, 0x10000, v3
    global_store_dword v2, v3, s[30:31] sc1
    s_waitcnt vmcnt(0)
    s_endpgm
ROLE_T5:
    s_lshr_b32 s33, s4, 2
    s_and_b32 s34, s4, 3
    v_and_b32 v40, 63, v0
    v_and_b32 v41, 31, v40
    v_lshrrev_b32 v42, 5, v40
    v_and_b32 v43, 15, v40
    v_lshrrev_b32 v44, 4, v40
    s_load_dwordx2 s[30:31], s[0:1], 88
    s_mov_b32 s14, 1
    s_mov_b32 s7, 0
    v_mov_b32 v2, 248
    s_waitcnt lgkmcnt(0)
    s_mov_b32 s16, 0
Lp_198:
    global_load_dword v3, v2, s[30:31] sc1
    s_add_u32 s16, s16, 1
    s_cmp_gt_u32 s16, 262144
    s_cbranch_scc1 Lwito_196
    s_waitcnt vmcnt(0)
    v_cmp_gt_u32 vcc, s14, v3
    s_cbranch_vccnz Lp_198
    s_branch Lwisk_197
Lwito_196:
    s_load_dwordx2 s[30:31], s[0:1], 88
    s_waitcnt lgkmcnt(0)
    s_mov_b64 exec, 1
    v_mov_b32 v2, 176
    v_mov_b32 v3, s7
    v_add_u32 v3, 0x10000, v3
    global_store_dword v2, v3, s[30:31] sc1
    s_waitcnt vmcnt(0)
    s_endpgm
Lwisk_197:
    v_mov_b32 v2, 0
    s_cmp_lg_u32 s6, 0
    s_cbranch_scc1 Lwsg_195
    v_mov_b32 v2, 16384
Lwsg_195:
    s_mov_b32 s12, s8
    s_mov_b32 s13, s9
    s_mov_b32 s14, 1
    s_mov_b32 s7, 0
    s_mov_b32 s16, 0
Lp_199:
    global_load_dword v3, v2, s[12:13] sc1
    s_add_u32 s16, s16, 1
    s_cmp_gt_u32 s16, 262144
    s_cbranch_scc1 Lwsto_194
    s_waitcnt vmcnt(0)
    v_cmp_gt_u32 vcc, s14, v3
    s_cbranch_vccnz Lp_199
    s_branch Lws_193
Lwsto_194:
    s_load_dwordx2 s[30:31], s[0:1], 88
    s_waitcnt lgkmcnt(0)
    s_mov_b64 exec, 1
    v_mov_b32 v2, 168
    v_mov_b32 v3, s7
    v_add_u32 v3, 0x10000, v3
    global_store_dword v2, v3, s[30:31] sc1
    s_waitcnt vmcnt(0)
    s_endpgm
Lws_193:
    v_lshrrev_b32 v45, 2, v40
    v_lshlrev_b32 v45, 10, v45
    v_and_b32 v46, 3, v40
    v_lshl_add_u32 v45, v46, 4, v45
    v_lshrrev_b32 v46, 2, v43
    v_lshl_add_u32 v46, v42, 2, v46
    v_lshlrev_b32 v46, 6, v46
    v_and_b32 v47, 1, v44
    v_lshl_add_u32 v46, v47, 5, v46
    v_and_b32 v47, 3, v43
    v_lshl_add_u32 v46, v47, 3, v46
    s_lshl_b32 s18, s5, 15
    v_add_u32 v46, s18, v46
    s_load_dwordx2 s[30:31], s[0:1], 64
    s_lshl_b32 s17, s33, 20
    s_lshl_b32 s18, s34, 8
    s_add_u32 s17, s17, s18
    s_lshl_b32 s18, s5, 6
    s_add_u32 s17, s17, s18
    s_add_u32 s17, s17, 0
    s_lshl_b32 s19, s5, 15
    s_waitcnt lgkmcnt(0)
    s_add_u32 s30, s30, s17
    s_addc_u32 s31, s31, 0
    s_mov_b32 m0, s19
    s_add_u32 s19, s19, 1024
    global_load_lds_dwordx4 v45, s[30:31]
    s_add_u32 s30, s30, 16384
    s_addc_u32 s31, s31, 0
    s_mov_b32 m0, s19
    s_add_u32 s19, s19, 1024
    global_load_lds_dwordx4 v45, s[30:31]
    s_add_u32 s30, s30, 16384
    s_addc_u32 s31, s31, 0
    s_mov_b32 m0, s19
    s_add_u32 s19, s19, 1024
    global_load_lds_dwordx4 v45, s[30:31]
    s_add_u32 s30, s30, 16384
    s_addc_u32 s31, s31, 0
    s_mov_b32 m0, s19
    s_add_u32 s19, s19, 1024
    global_load_lds_dwordx4 v45, s[30:31]
    s_add_u32 s30, s30, 16384
    s_addc_u32 s31, s31, 0
    s_mov_b32 m0, s19
    s_add_u32 s19, s19, 1024
    global_load_lds_dwordx4 v45, s[30:31]
    s_add_u32 s30, s30, 16384
    s_addc_u32 s31, s31, 0
    s_mov_b32 m0, s19
    s_add_u32 s19, s19, 1024
    global_load_lds_dwordx4 v45, s[30:31]
    s_add_u32 s30, s30, 16384
    s_addc_u32 s31, s31, 0
    s_mov_b32 m0, s19
    s_add_u32 s19, s19, 1024
    global_load_lds_dwordx4 v45, s[30:31]
    s_add_u32 s30, s30, 16384
    s_addc_u32 s31, s31, 0
    s_mov_b32 m0, s19
    s_add_u32 s19, s19, 1024
    global_load_lds_dwordx4 v45, s[30:31]
    s_add_u32 s30, s30, 16384
    s_addc_u32 s31, s31, 0
    s_mov_b32 m0, s19
    s_add_u32 s19, s19, 1024
    global_load_lds_dwordx4 v45, s[30:31]
    s_add_u32 s30, s30, 16384
    s_addc_u32 s31, s31, 0
    s_mov_b32 m0, s19
    s_add_u32 s19, s19, 1024
    global_load_lds_dwordx4 v45, s[30:31]
    s_add_u32 s30, s30, 16384
    s_addc_u32 s31, s31, 0
    s_mov_b32 m0, s19
    s_add_u32 s19, s19, 1024
    global_load_lds_dwordx4 v45, s[30:31]
    s_add_u32 s30, s30, 16384
    s_addc_u32 s31, s31, 0
    s_mov_b32 m0, s19
    s_add_u32 s19, s19, 1024
    global_load_lds_dwordx4 v45, s[30:31]
    s_add_u32 s30, s30, 16384
    s_addc_u32 s31, s31, 0
    s_mov_b32 m0, s19
    s_add_u32 s19, s19, 1024
    global_load_lds_dwordx4 v45, s[30:31]
    s_add_u32 s30, s30, 16384
    s_addc_u32 s31, s31, 0
    s_mov_b32 m0, s19
    s_add_u32 s19, s19, 1024
    global_load_lds_dwordx4 v45, s[30:31]
    s_add_u32 s30, s30, 16384
    s_addc_u32 s31, s31, 0
    s_mov_b32 m0, s19
    s_add_u32 s19, s19, 1024
    global_load_lds_dwordx4 v45, s[30:31]
    s_add_u32 s30, s30, 16384
    s_addc_u32 s31, s31, 0
    s_mov_b32 m0, s19
    s_add_u32 s19, s19, 1024
    global_load_lds_dwordx4 v45, s[30:31]
    s_add_u32 s30, s30, 16384
    s_addc_u32 s31, s31, 0
    s_mov_b32 m0, s19
    s_add_u32 s19, s19, 1024
    global_load_lds_dwordx4 v45, s[30:31]
    s_add_u32 s30, s30, 16384
    s_addc_u32 s31, s31, 0
    s_mov_b32 m0, s19
    s_add_u32 s19, s19, 1024
    global_load_lds_dwordx4 v45, s[30:31]
    s_add_u32 s30, s30, 16384
    s_addc_u32 s31, s31, 0
    s_mov_b32 m0, s19
    s_add_u32 s19, s19, 1024
    global_load_lds_dwordx4 v45, s[30:31]
    s_add_u32 s30, s30, 16384
    s_addc_u32 s31, s31, 0
    s_mov_b32 m0, s19
    s_add_u32 s19, s19, 1024
    global_load_lds_dwordx4 v45, s[30:31]
    s_add_u32 s30, s30, 16384
    s_addc_u32 s31, s31, 0
    s_mov_b32 m0, s19
    s_add_u32 s19, s19, 1024
    global_load_lds_dwordx4 v45, s[30:31]
    s_add_u32 s30, s30, 16384
    s_addc_u32 s31, s31, 0
    s_mov_b32 m0, s19
    s_add_u32 s19, s19, 1024
    global_load_lds_dwordx4 v45, s[30:31]
    s_add_u32 s30, s30, 16384
    s_addc_u32 s31, s31, 0
    s_mov_b32 m0, s19
    s_add_u32 s19, s19, 1024
    global_load_lds_dwordx4 v45, s[30:31]
    s_add_u32 s30, s30, 16384
    s_addc_u32 s31, s31, 0
    s_mov_b32 m0, s19
    s_add_u32 s19, s19, 1024
    global_load_lds_dwordx4 v45, s[30:31]
    s_add_u32 s30, s30, 16384
    s_addc_u32 s31, s31, 0
    s_mov_b32 m0, s19
    s_add_u32 s19, s19, 1024
    global_load_lds_dwordx4 v45, s[30:31]
    s_add_u32 s30, s30, 16384
    s_addc_u32 s31, s31, 0
    s_mov_b32 m0, s19
    s_add_u32 s19, s19, 1024
    global_load_lds_dwordx4 v45, s[30:31]
    s_add_u32 s30, s30, 16384
    s_addc_u32 s31, s31, 0
    s_mov_b32 m0, s19
    s_add_u32 s19, s19, 1024
    global_load_lds_dwordx4 v45, s[30:31]
    s_add_u32 s30, s30, 16384
    s_addc_u32 s31, s31, 0
    s_mov_b32 m0, s19
    s_add_u32 s19, s19, 1024
    global_load_lds_dwordx4 v45, s[30:31]
    s_add_u32 s30, s30, 16384
    s_addc_u32 s31, s31, 0
    s_mov_b32 m0, s19
    s_add_u32 s19, s19, 1024
    global_load_lds_dwordx4 v45, s[30:31]
    s_add_u32 s30, s30, 16384
    s_addc_u32 s31, s31, 0
    s_mov_b32 m0, s19
    s_add_u32 s19, s19, 1024
    global_load_lds_dwordx4 v45, s[30:31]
    s_add_u32 s30, s30, 16384
    s_addc_u32 s31, s31, 0
    s_mov_b32 m0, s19
    s_add_u32 s19, s19, 1024
    global_load_lds_dwordx4 v45, s[30:31]
    s_add_u32 s30, s30, 16384
    s_addc_u32 s31, s31, 0
    s_mov_b32 m0, s19
    s_add_u32 s19, s19, 1024
    global_load_lds_dwordx4 v45, s[30:31]
    s_add_u32 s30, s30, 16384
    s_addc_u32 s31, s31, 0
    s_waitcnt vmcnt(0)
    ds_read_b64_tr_b16 a[0:1], v46 offset:0
    ds_read_b64_tr_b16 a[2:3], v46 offset:1024
    ds_read_b64_tr_b16 a[4:5], v46 offset:512
    ds_read_b64_tr_b16 a[6:7], v46 offset:1536
    ds_read_b64_tr_b16 a[8:9], v46 offset:2048
    ds_read_b64_tr_b16 a[10:11], v46 offset:3072
    ds_read_b64_tr_b16 a[12:13], v46 offset:2560
    ds_read_b64_tr_b16 a[14:15], v46 offset:3584
    s_waitcnt lgkmcnt(0)
    ds_read_b64_tr_b16 a[16:17], v46 offset:4096
    ds_read_b64_tr_b16 a[18:19], v46 offset:5120
    ds_read_b64_tr_b16 a[20:21], v46 offset:4608
    ds_read_b64_tr_b16 a[22:23], v46 offset:5632
    ds_read_b64_tr_b16 a[24:25], v46 offset:6144
    ds_read_b64_tr_b16 a[26:27], v46 offset:7168
    ds_read_b64_tr_b16 a[28:29], v46 offset:6656
    ds_read_b64_tr_b16 a[30:31], v46 offset:7680
    s_waitcnt lgkmcnt(0)
    ds_read_b64_tr_b16 a[32:33], v46 offset:8192
    ds_read_b64_tr_b16 a[34:35], v46 offset:9216
    ds_read_b64_tr_b16 a[36:37], v46 offset:8704
    ds_read_b64_tr_b16 a[38:39], v46 offset:9728
    ds_read_b64_tr_b16 a[40:41], v46 offset:10240
    ds_read_b64_tr_b16 a[42:43], v46 offset:11264
    ds_read_b64_tr_b16 a[44:45], v46 offset:10752
    ds_read_b64_tr_b16 a[46:47], v46 offset:11776
    s_waitcnt lgkmcnt(0)
    ds_read_b64_tr_b16 a[48:49], v46 offset:12288
    ds_read_b64_tr_b16 a[50:51], v46 offset:13312
    ds_read_b64_tr_b16 a[52:53], v46 offset:12800
    ds_read_b64_tr_b16 a[54:55], v46 offset:13824
    ds_read_b64_tr_b16 a[56:57], v46 offset:14336
    ds_read_b64_tr_b16 a[58:59], v46 offset:15360
    ds_read_b64_tr_b16 a[60:61], v46 offset:14848
    ds_read_b64_tr_b16 a[62:63], v46 offset:15872
    s_waitcnt lgkmcnt(0)
    ds_read_b64_tr_b16 a[64:65], v46 offset:16384
    ds_read_b64_tr_b16 a[66:67], v46 offset:17408
    ds_read_b64_tr_b16 a[68:69], v46 offset:16896
    ds_read_b64_tr_b16 a[70:71], v46 offset:17920
    ds_read_b64_tr_b16 a[72:73], v46 offset:18432
    ds_read_b64_tr_b16 a[74:75], v46 offset:19456
    ds_read_b64_tr_b16 a[76:77], v46 offset:18944
    ds_read_b64_tr_b16 a[78:79], v46 offset:19968
    s_waitcnt lgkmcnt(0)
    ds_read_b64_tr_b16 a[80:81], v46 offset:20480
    ds_read_b64_tr_b16 a[82:83], v46 offset:21504
    ds_read_b64_tr_b16 a[84:85], v46 offset:20992
    ds_read_b64_tr_b16 a[86:87], v46 offset:22016
    ds_read_b64_tr_b16 a[88:89], v46 offset:22528
    ds_read_b64_tr_b16 a[90:91], v46 offset:23552
    ds_read_b64_tr_b16 a[92:93], v46 offset:23040
    ds_read_b64_tr_b16 a[94:95], v46 offset:24064
    s_waitcnt lgkmcnt(0)
    ds_read_b64_tr_b16 a[96:97], v46 offset:24576
    ds_read_b64_tr_b16 a[98:99], v46 offset:25600
    ds_read_b64_tr_b16 a[100:101], v46 offset:25088
    ds_read_b64_tr_b16 a[102:103], v46 offset:26112
    ds_read_b64_tr_b16 a[104:105], v46 offset:26624
    ds_read_b64_tr_b16 a[106:107], v46 offset:27648
    ds_read_b64_tr_b16 a[108:109], v46 offset:27136
    ds_read_b64_tr_b16 a[110:111], v46 offset:28160
    s_waitcnt lgkmcnt(0)
    ds_read_b64_tr_b16 a[112:113], v46 offset:28672
    ds_read_b64_tr_b16 a[114:115], v46 offset:29696
    ds_read_b64_tr_b16 a[116:117], v46 offset:29184
    ds_read_b64_tr_b16 a[118:119], v46 offset:30208
    ds_read_b64_tr_b16 a[120:121], v46 offset:30720
    ds_read_b64_tr_b16 a[122:123], v46 offset:31744
    ds_read_b64_tr_b16 a[124:125], v46 offset:31232
    ds_read_b64_tr_b16 a[126:127], v46 offset:32256
    s_waitcnt lgkmcnt(0)
    s_waitcnt lgkmcnt(0)
    s_load_dwordx2 s[30:31], s[0:1], 64
    s_lshl_b32 s17, s33, 20
    s_lshl_b32 s18, s34, 8
    s_add_u32 s17, s17, s18
    s_lshl_b32 s18, s5, 6
    s_add_u32 s17, s17, s18
    s_add_u32 s17, s17, 524288
    s_lshl_b32 s19, s5, 15
    s_waitcnt lgkmcnt(0)
    s_add_u32 s30, s30, s17
    s_addc_u32 s31, s31, 0
    s_mov_b32 m0, s19
    s_add_u32 s19, s19, 1024
    global_load_lds_dwordx4 v45, s[30:31]
    s_add_u32 s30, s30, 16384
    s_addc_u32 s31, s31, 0
    s_mov_b32 m0, s19
    s_add_u32 s19, s19, 1024
    global_load_lds_dwordx4 v45, s[30:31]
    s_add_u32 s30, s30, 16384
    s_addc_u32 s31, s31, 0
    s_mov_b32 m0, s19
    s_add_u32 s19, s19, 1024
    global_load_lds_dwordx4 v45, s[30:31]
    s_add_u32 s30, s30, 16384
    s_addc_u32 s31, s31, 0
    s_mov_b32 m0, s19
    s_add_u32 s19, s19, 1024
    global_load_lds_dwordx4 v45, s[30:31]
    s_add_u32 s30, s30, 16384
    s_addc_u32 s31, s31, 0
    s_mov_b32 m0, s19
    s_add_u32 s19, s19, 1024
    global_load_lds_dwordx4 v45, s[30:31]
    s_add_u32 s30, s30, 16384
    s_addc_u32 s31, s31, 0
    s_mov_b32 m0, s19
    s_add_u32 s19, s19, 1024
    global_load_lds_dwordx4 v45, s[30:31]
    s_add_u32 s30, s30, 16384
    s_addc_u32 s31, s31, 0
    s_mov_b32 m0, s19
    s_add_u32 s19, s19, 1024
    global_load_lds_dwordx4 v45, s[30:31]
    s_add_u32 s30, s30, 16384
    s_addc_u32 s31, s31, 0
    s_mov_b32 m0, s19
    s_add_u32 s19, s19, 1024
    global_load_lds_dwordx4 v45, s[30:31]
    s_add_u32 s30, s30, 16384
    s_addc_u32 s31, s31, 0
    s_mov_b32 m0, s19
    s_add_u32 s19, s19, 1024
    global_load_lds_dwordx4 v45, s[30:31]
    s_add_u32 s30, s30, 16384
    s_addc_u32 s31, s31, 0
    s_mov_b32 m0, s19
    s_add_u32 s19, s19, 1024
    global_load_lds_dwordx4 v45, s[30:31]
    s_add_u32 s30, s30, 16384
    s_addc_u32 s31, s31, 0
    s_mov_b32 m0, s19
    s_add_u32 s19, s19, 1024
    global_load_lds_dwordx4 v45, s[30:31]
    s_add_u32 s30, s30, 16384
    s_addc_u32 s31, s31, 0
    s_mov_b32 m0, s19
    s_add_u32 s19, s19, 1024
    global_load_lds_dwordx4 v45, s[30:31]
    s_add_u32 s30, s30, 16384
    s_addc_u32 s31, s31, 0
    s_mov_b32 m0, s19
    s_add_u32 s19, s19, 1024
    global_load_lds_dwordx4 v45, s[30:31]
    s_add_u32 s30, s30, 16384
    s_addc_u32 s31, s31, 0
    s_mov_b32 m0, s19
    s_add_u32 s19, s19, 1024
    global_load_lds_dwordx4 v45, s[30:31]
    s_add_u32 s30, s30, 16384
    s_addc_u32 s31, s31, 0
    s_mov_b32 m0, s19
    s_add_u32 s19, s19, 1024
    global_load_lds_dwordx4 v45, s[30:31]
    s_add_u32 s30, s30, 16384
    s_addc_u32 s31, s31, 0
    s_mov_b32 m0, s19
    s_add_u32 s19, s19, 1024
    global_load_lds_dwordx4 v45, s[30:31]
    s_add_u32 s30, s30, 16384
    s_addc_u32 s31, s31, 0
    s_mov_b32 m0, s19
    s_add_u32 s19, s19, 1024
    global_load_lds_dwordx4 v45, s[30:31]
    s_add_u32 s30, s30, 16384
    s_addc_u32 s31, s31, 0
    s_mov_b32 m0, s19
    s_add_u32 s19, s19, 1024
    global_load_lds_dwordx4 v45, s[30:31]
    s_add_u32 s30, s30, 16384
    s_addc_u32 s31, s31, 0
    s_mov_b32 m0, s19
    s_add_u32 s19, s19, 1024
    global_load_lds_dwordx4 v45, s[30:31]
    s_add_u32 s30, s30, 16384
    s_addc_u32 s31, s31, 0
    s_mov_b32 m0, s19
    s_add_u32 s19, s19, 1024
    global_load_lds_dwordx4 v45, s[30:31]
    s_add_u32 s30, s30, 16384
    s_addc_u32 s31, s31, 0
    s_mov_b32 m0, s19
    s_add_u32 s19, s19, 1024
    global_load_lds_dwordx4 v45, s[30:31]
    s_add_u32 s30, s30, 16384
    s_addc_u32 s31, s31, 0
    s_mov_b32 m0, s19
    s_add_u32 s19, s19, 1024
    global_load_lds_dwordx4 v45, s[30:31]
    s_add_u32 s30, s30, 16384
    s_addc_u32 s31, s31, 0
    s_mov_b32 m0, s19
    s_add_u32 s19, s19, 1024
    global_load_lds_dwordx4 v45, s[30:31]
    s_add_u32 s30, s30, 16384
    s_addc_u32 s31, s31, 0
    s_mov_b32 m0, s19
    s_add_u32 s19, s19, 1024
    global_load_lds_dwordx4 v45, s[30:31]
    s_add_u32 s30, s30, 16384
    s_addc_u32 s31, s31, 0
    s_mov_b32 m0, s19
    s_add_u32 s19, s19, 1024
    global_load_lds_dwordx4 v45, s[30:31]
    s_add_u32 s30, s30, 16384
    s_addc_u32 s31, s31, 0
    s_mov_b32 m0, s19
    s_add_u32 s19, s19, 1024
    global_load_lds_dwordx4 v45, s[30:31]
    s_add_u32 s30, s30, 16384
    s_addc_u32 s31, s31, 0
    s_mov_b32 m0, s19
    s_add_u32 s19, s19, 1024
    global_load_lds_dwordx4 v45, s[30:31]
    s_add_u32 s30, s30, 16384
    s_addc_u32 s31, s31, 0
    s_mov_b32 m0, s19
    s_add_u32 s19, s19, 1024
    global_load_lds_dwordx4 v45, s[30:31]
    s_add_u32 s30, s30, 16384
    s_addc_u32 s31, s31, 0
    s_mov_b32 m0, s19
    s_add_u32 s19, s19, 1024
    global_load_lds_dwordx4 v45, s[30:31]
    s_add_u32 s30, s30, 16384
    s_addc_u32 s31, s31, 0
    s_mov_b32 m0, s19
    s_add_u32 s19, s19, 1024
    global_load_lds_dwordx4 v45, s[30:31]
    s_add_u32 s30, s30, 16384
    s_addc_u32 s31, s31, 0
    s_mov_b32 m0, s19
    s_add_u32 s19, s19, 1024
    global_load_lds_dwordx4 v45, s[30:31]
    s_add_u32 s30, s30, 16384
    s_addc_u32 s31, s31, 0
    s_mov_b32 m0, s19
    s_add_u32 s19, s19, 1024
    global_load_lds_dwordx4 v45, s[30:31]
    s_add_u32 s30, s30, 16384
    s_addc_u32 s31, s31, 0
    s_waitcnt vmcnt(0)
    ds_read_b64_tr_b16 a[128:129], v46 offset:0
    ds_read_b64_tr_b16 a[130:131], v46 offset:1024
    ds_read_b64_tr_b16 a[132:133], v46 offset:512
    ds_read_b64_tr_b16 a[134:135], v46 offset:1536
    ds_read_b64_tr_b16 a[136:137], v46 offset:2048
    ds_read_b64_tr_b16 a[138:139], v46 offset:3072
    ds_read_b64_tr_b16 a[140:141], v46 offset:2560
    ds_read_b64_tr_b16 a[142:143], v46 offset:3584
    s_waitcnt lgkmcnt(0)
    ds_read_b64_tr_b16 a[144:145], v46 offset:4096
    ds_read_b64_tr_b16 a[146:147], v46 offset:5120
    ds_read_b64_tr_b16 a[148:149], v46 offset:4608
    ds_read_b64_tr_b16 a[150:151], v46 offset:5632
    ds_read_b64_tr_b16 a[152:153], v46 offset:6144
    ds_read_b64_tr_b16 a[154:155], v46 offset:7168
    ds_read_b64_tr_b16 a[156:157], v46 offset:6656
    ds_read_b64_tr_b16 a[158:159], v46 offset:7680
    s_waitcnt lgkmcnt(0)
    ds_read_b64_tr_b16 a[160:161], v46 offset:8192
    ds_read_b64_tr_b16 a[162:163], v46 offset:9216
    ds_read_b64_tr_b16 a[164:165], v46 offset:8704
    ds_read_b64_tr_b16 a[166:167], v46 offset:9728
    ds_read_b64_tr_b16 a[168:169], v46 offset:10240
    ds_read_b64_tr_b16 a[170:171], v46 offset:11264
    ds_read_b64_tr_b16 a[172:173], v46 offset:10752
    ds_read_b64_tr_b16 a[174:175], v46 offset:11776
    s_waitcnt lgkmcnt(0)
    ds_read_b64_tr_b16 a[176:177], v46 offset:12288
    ds_read_b64_tr_b16 a[178:179], v46 offset:13312
    ds_read_b64_tr_b16 a[180:181], v46 offset:12800
    ds_read_b64_tr_b16 a[182:183], v46 offset:13824
    ds_read_b64_tr_b16 a[184:185], v46 offset:14336
    ds_read_b64_tr_b16 a[186:187], v46 offset:15360
    ds_read_b64_tr_b16 a[188:189], v46 offset:14848
    ds_read_b64_tr_b16 a[190:191], v46 offset:15872
    s_waitcnt lgkmcnt(0)
    ds_read_b64_tr_b16 a[192:193], v46 offset:16384
    ds_read_b64_tr_b16 a[194:195], v46 offset:17408
    ds_read_b64_tr_b16 a[196:197], v46 offset:16896
    ds_read_b64_tr_b16 a[198:199], v46 offset:17920
    ds_read_b64_tr_b16 a[200:201], v46 offset:18432
    ds_read_b64_tr_b16 a[202:203], v46 offset:19456
    ds_read_b64_tr_b16 a[204:205], v46 offset:18944
    ds_read_b64_tr_b16 a[206:207], v46 offset:19968
    s_waitcnt lgkmcnt(0)
    ds_read_b64_tr_b16 a[208:209], v46 offset:20480
    ds_read_b64_tr_b16 a[210:211], v46 offset:21504
    ds_read_b64_tr_b16 a[212:213], v46 offset:20992
    ds_read_b64_tr_b16 a[214:215], v46 offset:22016
    ds_read_b64_tr_b16 a[216:217], v46 offset:22528
    ds_read_b64_tr_b16 a[218:219], v46 offset:23552
    ds_read_b64_tr_b16 a[220:221], v46 offset:23040
    ds_read_b64_tr_b16 a[222:223], v46 offset:24064
    s_waitcnt lgkmcnt(0)
    ds_read_b64_tr_b16 a[224:225], v46 offset:24576
    ds_read_b64_tr_b16 a[226:227], v46 offset:25600
    ds_read_b64_tr_b16 a[228:229], v46 offset:25088
    ds_read_b64_tr_b16 a[230:231], v46 offset:26112
    ds_read_b64_tr_b16 a[232:233], v46 offset:26624
    ds_read_b64_tr_b16 a[234:235], v46 offset:27648
    ds_read_b64_tr_b16 a[236:237], v46 offset:27136
    ds_read_b64_tr_b16 a[238:239], v46 offset:28160
    s_waitcnt lgkmcnt(0)
    ds_read_b64_tr_b16 a[240:241], v46 offset:28672
    ds_read_b64_tr_b16 a[242:243], v46 offset:29696
    ds_read_b64_tr_b16 a[244:245], v46 offset:29184
    ds_read_b64_tr_b16 a[246:247], v46 offset:30208
    ds_read_b64_tr_b16 a[248:249], v46 offset:30720
    ds_read_b64_tr_b16 a[250:251], v46 offset:31744
    ds_read_b64_tr_b16 a[252:253], v46 offset:31232
    ds_read_b64_tr_b16 a[254:255], v46 offset:32256
    s_waitcnt lgkmcnt(0)
    s_waitcnt lgkmcnt(0)
    s_barrier
    v_lshlrev_b32 v0, 4, v40
    v_xor_b32 v1, 0x10000, v0
    s_lshl_b32 s28, s5, 13
    s_mul_i32 s17, s6, 1024
    s_add_u32 s17, s17, 14336
    s_lshl_b32 s18, s33, 8
    s_add_u32 s17, s17, s18
    v_and_b32 v4, 1, v40
    v_lshlrev_b32 v4, 3, v4
    v_bfe_u32 v47, v40, 1, 2
    v_lshl_add_u32 v4, v47, 6, v4
    v_add_u32 v4, s17, v4
    s_mov_b32 s12, s8
    s_mov_b32 s13, s9
    s_mul_i32 s18, s6, 1024
    s_add_u32 s18, s18, 12288
    s_lshl_b32 s17, s4, 4
    s_add_u32 s17, s17, s5
    s_lshl_b32 s17, s17, 2
    s_add_u32 s18, s18, s17
    s_add_u32 s26, s8, s18
    s_addc_u32 s27, s9, 0
    s_mul_i32 s18, s6, 16777216
    s_add_u32 s18, s18, 150994944
    s_lshl_b32 s17, s33, 16
    s_lshl_b32 s19, s5, 13
    s_add_u32 s17, s17, s19
    s_add_u32 s18, s18, s17
    s_add_u32 s10, s8, s18
    s_addc_u32 s11, s9, 0
    s_mul_i32 s18, s6, 16777216
    s_add_u32 s18, s18, 184549376
    s_lshl_b32 s17, s33, 15
    s_lshl_b32 s19, s34, 13
    s_add_u32 s17, s17, s19
    s_lshl_b32 s19, s5, 11
    s_add_u32 s17, s17, s19
    s_add_u32 s18, s18, s17
    s_add_u32 s20, s8, s18
    s_addc_u32 s21, s9, 0
    s_load_dwordx2 s[30:31], s[0:1], 88
    s_mov_b32 s14, 1
    s_mov_b32 s7, 0
    v_mov_b32 v123, 248
    s_waitcnt lgkmcnt(0)
    s_mov_b32 s16, 0
Lp_204:
    global_load_dword v3, v123, s[30:31] sc1
    s_add_u32 s16, s16, 1
    s_cmp_gt_u32 s16, 262144
    s_cbranch_scc1 Lwito_202
    s_waitcnt vmcnt(0)
    v_cmp_gt_u32 vcc, s14, v3
    s_cbranch_vccnz Lp_204
    s_branch Lwisk_203
Lwito_202:
    s_load_dwordx2 s[30:31], s[0:1], 88
    s_waitcnt lgkmcnt(0)
    s_mov_b64 exec, 1
    v_mov_b32 v2, 176
    v_mov_b32 v3, s7
    v_add_u32 v3, 0x10000, v3
    global_store_dword v2, v3, s[30:31] sc1
    s_waitcnt vmcnt(0)
    s_endpgm
Lwisk_203:
    s_mov_b32 s7, 0
    s_mov_b32 s19, 0
    s_mov_b32 s35, 0
    s_mov_b32 s37, 0
    s_add_u32 s14, s19, 1
    s_and_b32 s17, s19, 1
    s_lshl_b32 s17, s17, 2
    v_add_u32 v2, s17, v4
    s_mov_b32 s16, 0
Lp_205:
    global_load_dword v3, v2, s[12:13] sc1
    s_add_u32 s16, s16, 1
    s_cmp_gt_u32 s16, 262144
    s_cbranch_scc1 LtoT5_200
    s_waitcnt vmcnt(0)
    v_cmp_gt_u32 vcc, s14, v3
    s_cbranch_vccnz Lp_205
    s_add_u32 s17, s28, 0
    s_mov_b32 m0, s17
    s_nop 0
    global_load_lds_dwordx4 v0, s[10:11] offset:0 sc1
    global_load_lds_dwordx4 v0, s[10:11] offset:1024 sc1
    global_load_lds_dwordx4 v0, s[10:11] offset:2048 sc1
    global_load_lds_dwordx4 v0, s[10:11] offset:3072 sc1
    s_add_u32 s10, s10, 4096
    s_addc_u32 s11, s11, 0
    s_add_u32 s17, s28, 4096
    s_mov_b32 m0, s17
    s_nop 0
    global_load_lds_dwordx4 v0, s[10:11] offset:0 sc1
    global_load_lds_dwordx4 v0, s[10:11] offset:1024 sc1
    global_load_lds_dwordx4 v0, s[10:11] offset:2048 sc1
    global_load_lds_dwordx4 v0, s[10:11] offset:3072 sc1
    s_add_u32 s10, s10, 28672
    s_addc_u32 s11, s11, 0
    s_add_u32 s17, s28, 32768
    s_mov_b32 m0, s17
    s_nop 0
    global_load_lds_dwordx4 v0, s[10:11] offset:0 sc1
    global_load_lds_dwordx4 v0, s[10:11] offset:1024 sc1
    global_load_lds_dwordx4 v0, s[10:11] offset:2048 sc1
    global_load_lds_dwordx4 v0, s[10:11] offset:3072 sc1
    s_add_u32 s10, s10, 4096
    s_addc_u32 s11, s11, 0
    s_add_u32 s17, s28, 36864
    s_mov_b32 m0, s17
    s_nop 0
    global_load_lds_dwordx4 v0, s[10:11] offset:0 sc1
    global_load_lds_dwordx4 v0, s[10:11] offset:1024 sc1
    global_load_lds_dwordx4 v0, s[10:11] offset:2048 sc1
    global_load_lds_dwordx4 v0, s[10:11] offset:3072 sc1
    s_add_u32 s10, s10, 225280
    s_addc_u32 s11, s11, 0
    s_waitcnt vmcnt(0)
    s_barrier
LitT5_201:
    v_xor_b32 v1, 0x10000, v1
    s_xor_b32 s28, s28, 0x10000
    s_add_u32 s19, s7, 1
    s_add_u32 s14, s19, 1
    s_and_b32 s17, s19, 1
    s_lshl_b32 s17, s17, 2
    v_add_u32 v2, s17, v4
    s_cmp_ge_u32 s19, 64
    s_cselect_b32 s15, 1, 0
    ds_read_b128 v[8:11], v1 offset:0
    ds_read_b128 v[12:15], v1 offset:1024
    ds_read_b128 v[16:19], v1 offset:2048
    ds_read_b128 v[20:23], v1 offset:3072
    s_waitcnt lgkmcnt(3)
    v_mfma_f32_32x32x16_bf16 v[32:47], a[0:3], v[8:11], 0
    ds_read_b128 v[8:11], v1 offset:4096
    s_waitcnt lgkmcnt(3)
    v_mfma_f32_32x32x16_bf16 v[32:47], a[4:7], v[12:15], v[32:47]
    global_load_dword v3, v2, s[12:13] sc1
    ds_read_b128 v[12:15], v1 offset:5120
    s_waitcnt lgkmcnt(3)
    v_mfma_f32_32x32x16_bf16 v[32:47], a[8:11], v[16:19], v[32:47]
    ds_read_b128 v[16:19], v1 offset:6144
    s_waitcnt lgkmcnt(3)
    v_mfma_f32_32x32x16_bf16 v[32:47], a[12:15], v[20:23], v[32:47]
    ds_read_b128 v[20:23], v1 offset:7168
    s_waitcnt lgkmcnt(3)
    v_mfma_f32_32x32x16_bf16 v[32:47], a[16:19], v[8:11], v[32:47]
    ds_read_b128 v[8:11], v1 offset:8192
    s_waitcnt lgkmcnt(3)
    v_mfma_f32_32x32x16_bf16 v[32:47], a[20:23], v[12:15], v[32:47]
    ds_read_b128 v[12:15], v1 offset:9216
    s_waitcnt lgkmcnt(3)
    v_mfma_f32_32x32x16_bf16 v[32:47], a[24:27], v[16:19], v[32:47]
    ds_read_b128 v[16:19], v1 offset:10240
    s_waitcnt lgkmcnt(3)
    v_mfma_f32_32x32x16_bf16 v[32:47], a[28:31], v[20:23], v[32:47]
    ds_read_b128 v[20:23], v1 offset:11264
    s_waitcnt lgkmcnt(3)
    v_mfma_f32_32x32x16_bf16 v[32:47], a[32:35], v[8:11], v[32:47]
    ds_read_b128 v[8:11], v1 offset:12288
    s_waitcnt lgkmcnt(3)
    v_mfma_f32_32x32x16_bf16 v[32:47], a[36:39], v[12:15], v[32:47]
    ds_read_b128 v[12:15], v1 offset:13312
    s_waitcnt lgkmcnt(3)
    v_mfma_f32_32x32x16_bf16 v[32:47], a[40:43], v[16:19], v[32:47]
    ds_read_b128 v[16:19], v1 offset:14336
    s_waitcnt lgkmcnt(3)
    v_mfma_f32_32x32x16_bf16 v[32:47], a[44:47], v[20:23], v[32:47]
    ds_read_b128 v[20:23], v1 offset:15360
    s_waitcnt lgkmcnt(3)
    v_mfma_f32_32x32x16_bf16 v[32:47], a[48:51], v[8:11], v[32:47]
    ds_read_b128 v[8:11], v1 offset:16384
    s_waitcnt lgkmcnt(3)
    v_mfma_f32_32x32x16_bf16 v[32:47], a[52:55], v[12:15], v[32:47]
    ds_read_b128 v[12:15], v1 offset:17408
    s_waitcnt lgkmcnt(3)
    v_mfma_f32_32x32x16_bf16 v[32:47], a[56:59], v[16:19], v[32:47]
    ds_read_b128 v[16:19], v1 offset:18432
    s_waitcnt lgkmcnt(3)
    v_mfma_f32_32x32x16_bf16 v[32:47], a[60:63], v[20:23], v[32:47]
    ds_read_b128 v[20:23], v1 offset:19456
    s_waitcnt lgkmcnt(3)
    v_mfma_f32_32x32x16_bf16 v[32:47], a[64:67], v[8:11], v[32:47]
    ds_read_b128 v[8:11], v1 offset:20480
    s_waitcnt lgkmcnt(3)
    v_mfma_f32_32x32x16_bf16 v[32:47], a[68:71], v[12:15], v[32:47]
    ds_read_b128 v[12:15], v1 offset:21504
    s_waitcnt lgkmcnt(3)
    v_mfma_f32_32x32x16_bf16 v[32:47], a[72:75], v[16:19], v[32:47]
    ds_read_b128 v[16:19], v1 offset:22528
    s_waitcnt lgkmcnt(3)
    v_mfma_f32_32x32x16_bf16 v[32:47], a[76:79], v[20:23], v[32:47]
    ds_read_b128 v[20:23], v1 offset:23552
    s_waitcnt lgkmcnt(3)
    v_mfma_f32_32x32x16_bf16 v[32:47], a[80:83], v[8:11], v[32:47]
    ds_read_b128 v[8:11], v1 offset:24576
    s_waitcnt lgkmcnt(3)
    v_mfma_f32_32x32x16_bf16 v[32:47], a[84:87], v[12:15], v[32:47]
    ds_read_b128 v[12:15], v1 offset:25600
    s_waitcnt lgkmcnt(3)
    v_mfma_f32_32x32x16_bf16 v[32:47], a[88:91], v[16:19], v[32:47]
    s_waitcnt vmcnt(0)
    s_barrier
    v_cmp_gt_u32 vcc, s14, v3
    s_cmp_eq_u32 s35, 0
    s_cbranch_scc1 Lnp_207
    v_mov_b32 v3, s7
    s_mov_b64 exec, 1
    global_store_dword v0, v3, s[26:27] sc1
    s_mov_b64 exec, -1
Lpub_208:
    s_mov_b32 s35, 0
Lnp_207:
    s_cmp_lg_u32 s15, 0
    s_cbranch_scc1 Lhk_206
    s_cbranch_vccnz Lnr_209
    s_mov_b32 s15, 1
    s_mov_b32 s37, 1
    s_branch Lhk_206
Lnr_209:
    global_load_dword v3, v2, s[12:13] sc1
Lhk_206:
    ds_read_b128 v[16:19], v1 offset:26624
    s_waitcnt lgkmcnt(3)
    v_mfma_f32_32x32x16_bf16 v[32:47], a[92:95], v[20:23], v[32:47]
    s_cmp_eq_u32 s37, 0
    s_cbranch_scc1 Lch_210
    s_add_u32 s17, s28, 0
    s_mov_b32 m0, s17
    s_nop 0
    global_load_lds_dwordx4 v0, s[10:11] offset:0 sc1
Lch_210:
    ds_read_b128 v[20:23], v1 offset:27648
    s_waitcnt lgkmcnt(3)
    v_mfma_f32_32x32x16_bf16 v[32:47], a[96:99], v[8:11], v[32:47]
    ds_read_b128 v[8:11], v1 offset:28672
    s_waitcnt lgkmcnt(3)
    v_mfma_f32_32x32x16_bf16 v[32:47], a[100:103], v[12:15], v[32:47]
    s_cmp_eq_u32 s37, 0
    s_cbranch_scc1 Lch_211
    global_load_lds_dwordx4 v0, s[10:11] offset:1024 sc1
Lch_211:
    ds_read_b128 v[12:15], v1 offset:29696
    s_waitcnt lgkmcnt(3)
    v_mfma_f32_32x32x16_bf16 v[32:47], a[104:107], v[16:19], v[32:47]
    ds_read_b128 v[16:19], v1 offset:30720
    s_waitcnt lgkmcnt(3)
    v_mfma_f32_32x32x16_bf16 v[32:47], a[108:111], v[20:23], v[32:47]
    s_cmp_eq_u32 s37, 0
    s_cbranch_scc1 Lch_212
    global_load_lds_dwordx4 v0, s[10:11] offset:2048 sc1
Lch_212:
    ds_read_b128 v[20:23], v1 offset:31744
    s_waitcnt lgkmcnt(3)
    v_mfma_f32_32x32x16_bf16 v[32:47], a[112:115], v[8:11], v[32:47]
    ds_read_b128 v[8:11], v1 offset:32768
    s_waitcnt lgkmcnt(3)
    v_mfma_f32_32x32x16_bf16 v[32:47], a[116:119], v[12:15], v[32:47]
    s_cmp_eq_u32 s37, 0
    s_cbranch_scc1 Lch_213
    global_load_lds_dwordx4 v0, s[10:11] offset:3072 sc1
    s_add_u32 s10, s10, 4096
    s_addc_u32 s11, s11, 0
Lch_213:
    ds_read_b128 v[12:15], v1 offset:33792
    s_waitcnt lgkmcnt(3)
    v_mfma_f32_32x32x16_bf16 v[32:47], a[120:123], v[16:19], v[32:47]
    ds_read_b128 v[16:19], v1 offset:34816
    s_waitcnt lgkmcnt(3)
    v_mfma_f32_32x32x16_bf16 v[32:47], a[124:127], v[20:23], v[32:47]
    s_cmp_eq_u32 s37, 0
    s_cbranch_scc1 Lch_214
    s_add_u32 s17, s28, 4096
    s_mov_b32 m0, s17
    s_nop 0
    global_load_lds_dwordx4 v0, s[10:11] offset:0 sc1
Lch_214:
    ds_read_b128 v[20:23], v1 offset:35840
    s_waitcnt lgkmcnt(3)
    v_mfma_f32_32x32x16_bf16 v[32:47], a[128:131], v[8:11], v[32:47]
    ds_read_b128 v[8:11], v1 offset:36864
    s_waitcnt lgkmcnt(3)
    v_mfma_f32_32x32x16_bf16 v[32:47], a[132:135], v[12:15], v[32:47]
    s_cmp_eq_u32 s37, 0
    s_cbranch_scc1 Lch_215
    global_load_lds_dwordx4 v0, s[10:11] offset:1024 sc1
Lch_215:
    ds_read_b128 v[12:15], v1 offset:37888
    s_waitcnt lgkmcnt(3)
    v_mfma_f32_32x32x16_bf16 v[32:47], a[136:139], v[16:19], v[32:47]
    ds_read_b128 v[16:19], v1 offset:38912
    s_waitcnt lgkmcnt(3)
    v_mfma_f32_32x32x16_bf16 v[32:47], a[140:143], v[20:23], v[32:47]
    s_cmp_eq_u32 s37, 0
    s_cbranch_scc1 Lch_216
    global_load_lds_dwordx4 v0, s[10:11] offset:2048 sc1
Lch_216:
    ds_read_b128 v[20:23], v1 offset:39936
    s_waitcnt lgkmcnt(3)
    v_mfma_f32_32x32x16_bf16 v[32:47], a[144:147], v[8:11], v[32:47]
    ds_read_b128 v[8:11], v1 offset:40960
    s_waitcnt lgkmcnt(3)
    v_mfma_f32_32x32x16_bf16 v[32:47], a[148:151], v[12:15], v[32:47]
    s_cmp_eq_u32 s37, 0
    s_cbranch_scc1 Lch_217
    global_load_lds_dwordx4 v0, s[10:11] offset:3072 sc1
    s_add_u32 s10, s10, 28672
    s_addc_u32 s11, s11, 0
Lch_217:
    ds_read_b128 v[12:15], v1 offset:41984
    s_waitcnt lgkmcnt(3)
    v_mfma_f32_32x32x16_bf16 v[32:47], a[152:155], v[16:19], v[32:47]
    ds_read_b128 v[16:19], v1 offset:43008
    s_waitcnt lgkmcnt(3)
    v_mfma_f32_32x32x16_bf16 v[32:47], a[156:159], v[20:23], v[32:47]
    s_cmp_eq_u32 s37, 0
    s_cbranch_scc1 Lch_218
    s_add_u32 s17, s28, 32768
    s_mov_b32 m0, s17
    s_nop 0
    global_load_lds_dwordx4 v0, s[10:11] offset:0 sc1
Lch_218:
    ds_read_b128 v[20:23], v1 offset:44032
    s_waitcnt lgkmcnt(3)
    v_mfma_f32_32x32x16_bf16 v[32:47], a[160:163], v[8:11], v[32:47]
    ds_read_b128 v[8:11], v1 offset:45056
    s_waitcnt lgkmcnt(3)
    v_mfma_f32_32x32x16_bf16 v[32:47], a[164:167], v[12:15], v[32:47]
    s_cmp_eq_u32 s37, 0
    s_cbranch_scc1 Lch_219
    global_load_lds_dwordx4 v0, s[10:11] offset:1024 sc1
Lch_219:
    ds_read_b128 v[12:15], v1 offset:46080
    s_waitcnt lgkmcnt(3)
    v_mfma_f32_32x32x16_bf16 v[32:47], a[168:171], v[16:19], v[32:47]
    ds_read_b128 v[16:19], v1 offset:47104
    s_waitcnt lgkmcnt(3)
    v_mfma_f32_32x32x16_bf16 v[32:47], a[172:175], v[20:23], v[32:47]
    s_cmp_eq_u32 s37, 0
    s_cbranch_scc1 Lch_220
    global_load_lds_dwordx4 v0, s[10:11] offset:2048 sc1
Lch_220:
    ds_read_b128 v[20:23], v1 offset:48128
    s_waitcnt lgkmcnt(3)
    v_mfma_f32_32x32x16_bf16 v[32:47], a[176:179], v[8:11], v[32:47]
    ds_read_b128 v[8:11], v1 offset:49152
    s_waitcnt lgkmcnt(3)
    v_mfma_f32_32x32x16_bf16 v[32:47], a[180:183], v[12:15], v[32:47]
    s_cmp_eq_u32 s37, 0
    s_cbranch_scc1 Lch_221
    global_load_lds_dwordx4 v0, s[10:11] offset:3072 sc1
    s_add_u32 s10, s10, 4096
    s_addc_u32 s11, s11, 0
Lch_221:
    ds_read_b128 v[12:15], v1 offset:50176
    s_waitcnt lgkmcnt(3)
    v_mfma_f32_32x32x16_bf16 v[32:47], a[184:187], v[16:19], v[32:47]
    ds_read_b128 v[16:19], v1 offset:51200
    s_waitcnt lgkmcnt(3)
    v_mfma_f32_32x32x16_bf16 v[32:47], a[188:191], v[20:23], v[32:47]
    s_cmp_eq_u32 s37, 0
    s_cbranch_scc1 Lch_222
    s_add_u32 s17, s28, 36864
    s_mov_b32 m0, s17
    s_nop 0
    global_load_lds_dwordx4 v0, s[10:11] offset:0 sc1
Lch_222:
    ds_read_b128 v[20:23], v1 offset:52224
    s_waitcnt lgkmcnt(3)
    v_mfma_f32_32x32x16_bf16 v[32:47], a[192:195], v[8:11], v[32:47]
    ds_read_b128 v[8:11], v1 offset:53248
    s_waitcnt lgkmcnt(3)
    v_mfma_f32_32x32x16_bf16 v[32:47], a[196:199], v[12:15], v[32:47]
    s_cmp_eq_u32 s37, 0
    s_cbranch_scc1 Lch_223
    global_load_lds_dwordx4 v0, s[10:11] offset:1024 sc1
Lch_223:
    ds_read_b128 v[12:15], v1 offset:54272
    s_waitcnt lgkmcnt(3)
    v_mfma_f32_32x32x16_bf16 v[32:47], a[200:203], v[16:19], v[32:47]
    ds_read_b128 v[16:19], v1 offset:55296
    s_waitcnt lgkmcnt(3)
    v_mfma_f32_32x32x16_bf16 v[32:47], a[204:207], v[20:23], v[32:47]
    s_cmp_eq_u32 s37, 0
    s_cbranch_scc1 Lch_224
    global_load_lds_dwordx4 v0, s[10:11] offset:2048 sc1
Lch_224:
    ds_read_b128 v[20:23], v1 offset:56320
    s_waitcnt lgkmcnt(3)
    v_mfma_f32_32x32x16_bf16 v[32:47], a[208:211], v[8:11], v[32:47]
    ds_read_b128 v[8:11], v1 offset:57344
    s_waitcnt lgkmcnt(3)
    v_mfma_f32_32x32x16_bf16 v[32:47], a[212:215], v[12:15], v[32:47]
    s_cmp_eq_u32 s37, 0
    s_cbranch_scc1 Lch_225
    global_load_lds_dwordx4 v0, s[10:11] offset:3072 sc1
    s_add_u32 s10, s10, 225280
    s_addc_u32 s11, s11, 0
    s_mov_b32 s37, 0
Lch_225:
    ds_read_b128 v[12:15], v1 offset:58368
    s_waitcnt lgkmcnt(3)
    v_mfma_f32_32x32x16_bf16 v[32:47], a[216:219], v[16:19], v[32:47]
    ds_read_b128 v[16:19], v1 offset:59392
    s_waitcnt lgkmcnt(3)
    v_mfma_f32_32x32x16_bf16 v[32:47], a[220:223], v[20:23], v[32:47]
    ds_read_b128 v[20:23], v1 offset:60416
    s_waitcnt lgkmcnt(3)
    v_mfma_f32_32x32x16_bf16 v[32:47], a[224:227], v[8:11], v[32:47]
    s_cmp_lg_u32 s15, 0
    s_cbranch_scc1 Lhk_226
    s_waitcnt vmcnt(0)
    v_cmp_gt_u32 vcc, s14, v3
    s_cbranch_vccnz Lnr1_227
    s_add_u32 s17, s28, 0
    s_mov_b32 m0, s17
    s_nop 0
    global_load_lds_dwordx4 v0, s[10:11] offset:0 sc1
    global_load_lds_dwordx4 v0, s[10:11] offset:1024 sc1
    global_load_lds_dwordx4 v0, s[10:11] offset:2048 sc1
    global_load_lds_dwordx4 v0, s[10:11] offset:3072 sc1
    s_add_u32 s10, s10, 4096
    s_addc_u32 s11, s11, 0
    s_add_u32 s17, s28, 4096
    s_mov_b32 m0, s17
    s_nop 0
    global_load_lds_dwordx4 v0, s[10:11] offset:0 sc1
    global_load_lds_dwordx4 v0, s[10:11] offset:1024 sc1
    global_load_lds_dwordx4 v0, s[10:11] offset:2048 sc1
    global_load_lds_dwordx4 v0, s[10:11] offset:3072 sc1
    s_add_u32 s10, s10, 28672
    s_addc_u32 s11, s11, 0
    s_add_u32 s17, s28, 32768
    s_mov_b32 m0, s17
    s_nop 0
    global_load_lds_dwordx4 v0, s[10:11] offset:0 sc1
    global_load_lds_dwordx4 v0, s[10:11] offset:1024 sc1
    global_load_lds_dwordx4 v0, s[10:11] offset:2048 sc1
    global_load_lds_dwordx4 v0, s[10:11] offset:3072 sc1
    s_add_u32 s10, s10, 4096
    s_addc_u32 s11, s11, 0
    s_add_u32 s17, s28, 36864
    s_mov_b32 m0, s17
    s_nop 0
    global_load_lds_dwordx4 v0, s[10:11] offset:0 sc1
    global_load_lds_dwordx4 v0, s[10:11] offset:1024 sc1
    global_load_lds_dwordx4 v0, s[10:11] offset:2048 sc1
    global_load_lds_dwordx4 v0, s[10:11] offset:3072 sc1
    s_add_u32 s10, s10, 225280
    s_addc_u32 s11, s11, 0
    s_mov_b32 s15, 1
    s_branch Lhk_226
Lnr1_227:
    global_load_dword v3, v2, s[12:13] sc1
Lhk_226:
    ds_read_b128 v[8:11], v1 offset:61440
    s_waitcnt lgkmcnt(3)
    v_mfma_f32_32x32x16_bf16 v[32:47], a[228:231], v[12:15], v[32:47]
    ds_read_b128 v[12:15], v1 offset:62464
    s_waitcnt lgkmcnt(3)
    v_mfma_f32_32x32x16_bf16 v[32:47], a[232:235], v[16:19], v[32:47]
    ds_read_b128 v[16:19], v1 offset:63488
    s_waitcnt lgkmcnt(3)
    v_mfma_f32_32x32x16_bf16 v[32:47], a[236:239], v[20:23], v[32:47]
    ds_read_b128 v[20:23], v1 offset:64512
    s_waitcnt lgkmcnt(3)
    v_mfma_f32_32x32x16_bf16 v[32:47], a[240:243], v[8:11], v[32:47]
    s_waitcnt lgkmcnt(2)
    v_mfma_f32_32x32x16_bf16 v[32:47], a[244:247], v[12:15], v[32:47]
    s_waitcnt lgkmcnt(1)
    v_mfma_f32_32x32x16_bf16 v[32:47], a[248:251], v[16:19], v[32:47]
    s_waitcnt lgkmcnt(0)
    v_mfma_f32_32x32x16_bf16 v[32:47], a[252:255], v[20:23], v[32:47]
    s_nop 11
    s_cmp_lg_u32 s15, 0
    s_cbranch_scc1 Lhk_228
    s_waitcnt vmcnt(0)
    v_cmp_gt_u32 vcc, s14, v3
    s_cbranch_vccnz Lnr2_229
    s_mov_b32 s37, 2
    s_branch Lhk_228
Lnr2_229:
    global_load_dword v3, v2, s[12:13] sc1
Lhk_228:
    v_cvt_pk_bf16_f32 v64, v32, v33
    v_cvt_pk_bf16_f32 v65, v34, v35
    v_cvt_pk_bf16_f32 v66, v36, v37
    v_cvt_pk_bf16_f32 v67, v38, v39
    s_nop 1
    v_permlane32_swap_b32 v64, v66
    v_permlane32_swap_b32 v65, v67
    global_store_dwordx4 v0, v[64:67], s[20:21] offset:0 sc1
    v_cvt_pk_bf16_f32 v68, v40, v41
    v_cvt_pk_bf16_f32 v69, v42, v43
    v_cvt_pk_bf16_f32 v70, v44, v45
    v_cvt_pk_bf16_f32 v71, v46, v47
    s_nop 1
    v_permlane32_swap_b32 v68, v70
    v_permlane32_swap_b32 v69, v71
    global_store_dwordx4 v0, v[68:71], s[20:21] offset:1024 sc1
    s_add_u32 s20, s20, 131072
    s_addc_u32 s21, s21, 0
    s_add_u32 s7, s7, 1
    s_cmp_lg_u32 s15, 0
    s_cbranch_scc1 Lh3_233
    s_cmp_eq_u32 s37, 2
    s_cbranch_scc1 Lh3_233
    s_waitcnt vmcnt(2)
    v_cmp_gt_u32 vcc, s14, v3
    s_cbranch_vccnz Lh3_233
    s_mov_b32 s37, 2
Lh3_233:
    s_cmp_lg_u32 s37, 2
    s_cbranch_scc1 Lng2_232
    s_add_u32 s17, s28, 0
    s_mov_b32 m0, s17
    s_nop 0
    global_load_lds_dwordx4 v0, s[10:11] offset:0 sc1
    global_load_lds_dwordx4 v0, s[10:11] offset:1024 sc1
    global_load_lds_dwordx4 v0, s[10:11] offset:2048 sc1
    global_load_lds_dwordx4 v0, s[10:11] offset:3072 sc1
    s_add_u32 s10, s10, 4096
    s_addc_u32 s11, s11, 0
    s_add_u32 s17, s28, 4096
    s_mov_b32 m0, s17
    s_nop 0
    global_load_lds_dwordx4 v0, s[10:11] offset:0 sc1
    global_load_lds_dwordx4 v0, s[10:11] offset:1024 sc1
    global_load_lds_dwordx4 v0, s[10:11] offset:2048 sc1
    global_load_lds_dwordx4 v0, s[10:11] offset:3072 sc1
    s_add_u32 s10, s10, 28672
    s_addc_u32 s11, s11, 0
    s_add_u32 s17, s28, 32768
    s_mov_b32 m0, s17
    s_nop 0
    global_load_lds_dwordx4 v0, s[10:11] offset:0 sc1
    global_load_lds_dwordx4 v0, s[10:11] offset:1024 sc1
    global_load_lds_dwordx4 v0, s[10:11] offset:2048 sc1
    global_load_lds_dwordx4 v0, s[10:11] offset:3072 sc1
    s_add_u32 s10, s10, 4096
    s_addc_u32 s11, s11, 0
    s_add_u32 s17, s28, 36864
    s_mov_b32 m0, s17
    s_nop 0
    global_load_lds_dwordx4 v0, s[10:11] offset:0 sc1
    global_load_lds_dwordx4 v0, s[10:11] offset:1024 sc1
    global_load_lds_dwordx4 v0, s[10:11] offset:2048 sc1
    global_load_lds_dwordx4 v0, s[10:11] offset:3072 sc1
    s_add_u32 s10, s10, 225280
    s_addc_u32 s11, s11, 0
    s_mov_b32 s37, 0
    s_waitcnt vmcnt(16)
    v_mov_b32 v3, s7
    s_mov_b64 exec, 1
    global_store_dword v0, v3, s[26:27] sc1
    s_mov_b64 exec, -1
Lpub_234:
    s_waitcnt vmcnt(9)
    s_branch Ljoin_231
Lng2_232:
    s_cmp_ge_u32 s7, 64
    s_cbranch_scc1 Llate_230
    s_cmp_eq_u32 s15, 0
    s_cbranch_scc1 Llate_230
    s_waitcnt vmcnt(2)
    s_mov_b32 s35, 1
    s_branch Ljoin_231
Llate_230:
    s_waitcnt vmcnt(0)
    v_mov_b32 v3, s7
    s_mov_b64 exec, 1
    global_store_dword v0, v3, s[26:27] sc1
    s_mov_b64 exec, -1
Lpub_235:
    s_cmp_ge_u32 s7, 64
    s_cbranch_scc1 Ljoin_231
    s_mov_b32 s16, 0
Lp_236:
    global_load_dword v3, v2, s[12:13] sc1
    s_add_u32 s16, s16, 1
    s_cmp_gt_u32 s16, 262144
    s_cbranch_scc1 LtoT5_200
    s_waitcnt vmcnt(0)
    v_cmp_gt_u32 vcc, s14, v3
    s_cbranch_vccnz Lp_236
    s_add_u32 s17, s28, 0
    s_mov_b32 m0, s17
    s_nop 0
    global_load_lds_dwordx4 v0, s[10:11] offset:0 sc1
    global_load_lds_dwordx4 v0, s[10:11] offset:1024 sc1
    global_load_lds_dwordx4 v0, s[10:11] offset:2048 sc1
    global_load_lds_dwordx4 v0, s[10:11] offset:3072 sc1
    s_add_u32 s10, s10, 4096
    s_addc_u32 s11, s11, 0
    s_add_u32 s17, s28, 4096
    s_mov_b32 m0, s17
    s_nop 0
    global_load_lds_dwordx4 v0, s[10:11] offset:0 sc1
    global_load_lds_dwordx4 v0, s[10:11] offset:1024 sc1
    global_load_lds_dwordx4 v0, s[10:11] offset:2048 sc1
    global_load_lds_dwordx4 v0, s[10:11] offset:3072 sc1
    s_add_u32 s10, s10, 28672
    s_addc_u32 s11, s11, 0
    s_add_u32 s17, s28, 32768
    s_mov_b32 m0, s17
    s_nop 0
    global_load_lds_dwordx4 v0, s[10:11] offset:0 sc1
    global_load_lds_dwordx4 v0, s[10:11] offset:1024 sc1
    global_load_lds_dwordx4 v0, s[10:11] offset:2048 sc1
    global_load_lds_dwordx4 v0, s[10:11] offset:3072 sc1
    s_add_u32 s10, s10, 4096
    s_addc_u32 s11, s11, 0
    s_add_u32 s17, s28, 36864
    s_mov_b32 m0, s17
    s_nop 0
    global_load_lds_dwordx4 v0, s[10:11] offset:0 sc1
    global_load_lds_dwordx4 v0, s[10:11] offset:1024 sc1
    global_load_lds_dwordx4 v0, s[10:11] offset:2048 sc1
    global_load_lds_dwordx4 v0, s[10:11] offset:3072 sc1
    s_add_u32 s10, s10, 225280
    s_addc_u32 s11, s11, 0
    s_waitcnt vmcnt(8)
Ljoin_231:
    s_barrier
    s_cmp_lt_u32 s7, 64
    s_cbranch_scc1 LitT5_201
    s_waitcnt vmcnt(0)
    s_endpgm
LtoT5_200:
    s_load_dwordx2 s[30:31], s[0:1], 88
    s_waitcnt lgkmcnt(0)
    s_mov_b64 exec, 1
    v_mov_b32 v2, 156
    v_mov_b32 v3, s7
    v_add_u32 v3, 0x10000, v3
    global_store_dword v2, v3, s[30:31] sc1
    s_waitcnt vmcnt(0)
    s_endpgm
ROLE_TA:
    s_lshl_b32 s33, s4, 2
    s_add_u32 s33, s33, s5
    v_and_b32 v40, 63, v0
    v_and_b32 v41, 15, v40
    v_lshrrev_b32 v42, 4, v40
    v_lshrrev_b32 v45, 3, v40
    v_mul_u32_u24 v45, 3072, v45
    v_and_b32 v46, 7, v40
    v_lshl_add_u32 v45, v46, 4, v45
    v_lshrrev_b32 v46, 2, v41
    v_lshl_add_u32 v46, v42, 3, v46
    v_lshlrev_b32 v46, 7, v46
    v_and_b32 v47, 3, v41
    v_lshl_add_u32 v46, v47, 3, v46
    s_lshl_b32 s18, s5, 5
    v_add_u32 v46, s18, v46
    s_cmp_lg_u32 s6, 0
    s_cbranch_scc1 Lwsg_239
    s_branch Lws_237
Lwsg_239:
    s_load_dwordx2 s[30:31], s[0:1], 88
    s_mov_b32 s14, 1
    s_mov_b32 s7, 0
    v_mov_b32 v2, 248
    s_waitcnt lgkmcnt(0)
    s_mov_b32 s16, 0
Lp_242:
    global_load_dword v3, v2, s[30:31] sc1
    s_add_u32 s16, s16, 1
    s_cmp_gt_u32 s16, 262144
    s_cbranch_scc1 Lwito_240
    s_waitcnt vmcnt(0)
    v_cmp_gt_u32 vcc, s14, v3
    s_cbranch_vccnz Lp_242
    s_branch Lwisk_241
Lwito_240:
    s_load_dwordx2 s[30:31], s[0:1], 88
    s_waitcnt lgkmcnt(0)
    s_mov_b64 exec, 1
    v_mov_b32 v2, 176
    v_mov_b32 v3, s7
    v_add_u32 v3, 0x10000, v3
    global_store_dword v2, v3, s[30:31] sc1
    s_waitcnt vmcnt(0)
    s_endpgm
Lwisk_241:
    v_mov_b32 v2, 0
    s_mov_b32 s12, s8
    s_mov_b32 s13, s9
    s_mov_b32 s14, 1
    s_mov_b32 s7, 0
    s_mov_b32 s16, 0
Lp_243:
    global_load_dword v3, v2, s[12:13] sc1
    s_add_u32 s16, s16, 1
    s_cmp_gt_u32 s16, 262144
    s_cbranch_scc1 Lwsto_238
    s_waitcnt vmcnt(0)
    v_cmp_gt_u32 vcc, s14, v3
    s_cbranch_vccnz Lp_243
    s_branch Lws_237
Lwsto_238:
    s_load_dwordx2 s[30:31], s[0:1], 88
    s_waitcnt lgkmcnt(0)
    s_mov_b64 exec, 1
    v_mov_b32 v2, 168
    v_mov_b32 v3, s7
    v_add_u32 v3, 0x10000, v3
    global_store_dword v2, v3, s[30:31] sc1
    s_waitcnt vmcnt(0)
    s_endpgm
Lws_237:
    s_load_dwordx2 s[30:31], s[0:1], 8
    s_lshl_b32 s17, s4, 7
    s_add_u32 s17, s17, 0
    s_mul_i32 s18, s5, 393216
    s_add_u32 s17, s17, s18
    s_lshl_b32 s19, s5, 14
    s_waitcnt lgkmcnt(0)
    s_add_u32 s30, s30, s17
    s_addc_u32 s31, s31, 0
    s_mov_b32 m0, s19
    s_add_u32 s19, s19, 1024
    global_load_lds_dwordx4 v45, s[30:31]
    s_add_u32 s30, s30, 24576
    s_addc_u32 s31, s31, 0
    s_mov_b32 m0, s19
    s_add_u32 s19, s19, 1024
    global_load_lds_dwordx4 v45, s[30:31]
    s_add_u32 s30, s30, 24576
    s_addc_u32 s31, s31, 0
    s_mov_b32 m0, s19
    s_add_u32 s19, s19, 1024
    global_load_lds_dwordx4 v45, s[30:31]
    s_add_u32 s30, s30, 24576
    s_addc_u32 s31, s31, 0
    s_mov_b32 m0, s19
    s_add_u32 s19, s19, 1024
    global_load_lds_dwordx4 v45, s[30:31]
    s_add_u32 s30, s30, 24576
    s_addc_u32 s31, s31, 0
    s_mov_b32 m0, s19
    s_add_u32 s19, s19, 1024
    global_load_lds_dwordx4 v45, s[30:31]
    s_add_u32 s30, s30, 24576
    s_addc_u32 s31, s31, 0
    s_mov_b32 m0, s19
    s_add_u32 s19, s19, 1024
    global_load_lds_dwordx4 v45, s[30:31]
    s_add_u32 s30, s30, 24576
    s_addc_u32 s31, s31, 0
    s_mov_b32 m0, s19
    s_add_u32 s19, s19, 1024
    global_load_lds_dwordx4 v45, s[30:31]
    s_add_u32 s30, s30, 24576
    s_addc_u32 s31, s31, 0
    s_mov_b32 m0, s19
    s_add_u32 s19, s19, 1024
    global_load_lds_dwordx4 v45, s[30:31]
    s_add_u32 s30, s30, 24576
    s_addc_u32 s31, s31, 0
    s_mov_b32 m0, s19
    s_add_u32 s19, s19, 1024
    global_load_lds_dwordx4 v45, s[30:31]
    s_add_u32 s30, s30, 24576
    s_addc_u32 s31, s31, 0
    s_mov_b32 m0, s19
    s_add_u32 s19, s19, 1024
    global_load_lds_dwordx4 v45, s[30:31]
    s_add_u32 s30, s30, 24576
    s_addc_u32 s31, s31, 0
    s_mov_b32 m0, s19
    s_add_u32 s19, s19, 1024
    global_load_lds_dwordx4 v45, s[30:31]
    s_add_u32 s30, s30, 24576
    s_addc_u32 s31, s31, 0
    s_mov_b32 m0, s19
    s_add_u32 s19, s19, 1024
    global_load_lds_dwordx4 v45, s[30:31]
    s_add_u32 s30, s30, 24576
    s_addc_u32 s31, s31, 0
    s_mov_b32 m0, s19
    s_add_u32 s19, s19, 1024
    global_load_lds_dwordx4 v45, s[30:31]
    s_add_u32 s30, s30, 24576
    s_addc_u32 s31, s31, 0
    s_mov_b32 m0, s19
    s_add_u32 s19, s19, 1024
    global_load_lds_dwordx4 v45, s[30:31]
    s_add_u32 s30, s30, 24576
    s_addc_u32 s31, s31, 0
    s_mov_b32 m0, s19
    s_add_u32 s19, s19, 1024
    global_load_lds_dwordx4 v45, s[30:31]
    s_add_u32 s30, s30, 24576
    s_addc_u32 s31, s31, 0
    s_mov_b32 m0, s19
    s_add_u32 s19, s19, 1024
    global_load_lds_dwordx4 v45, s[30:31]
    s_add_u32 s30, s30, 24576
    s_addc_u32 s31, s31, 0
    s_waitcnt vmcnt(0)
    s_barrier
    ds_read_b64_tr_b16 a[0:1], v46 offset:0
    ds_read_b64_tr_b16 a[2:3], v46 offset:512
    ds_read_b64_tr_b16 a[4:5], v46 offset:4096
    ds_read_b64_tr_b16 a[6:7], v46 offset:4608
    ds_read_b64_tr_b16 a[8:9], v46 offset:8192
    ds_read_b64_tr_b16 a[10:11], v46 offset:8704
    ds_read_b64_tr_b16 a[12:13], v46 offset:12288
    ds_read_b64_tr_b16 a[14:15], v46 offset:12800
    s_waitcnt lgkmcnt(0)
    ds_read_b64_tr_b16 a[16:17], v46 offset:16384
    ds_read_b64_tr_b16 a[18:19], v46 offset:16896
    ds_read_b64_tr_b16 a[20:21], v46 offset:20480
    ds_read_b64_tr_b16 a[22:23], v46 offset:20992
    ds_read_b64_tr_b16 a[24:25], v46 offset:24576
    ds_read_b64_tr_b16 a[26:27], v46 offset:25088
    ds_read_b64_tr_b16 a[28:29], v46 offset:28672
    ds_read_b64_tr_b16 a[30:31], v46 offset:29184
    s_waitcnt lgkmcnt(0)
    ds_read_b64_tr_b16 a[32:33], v46 offset:32768
    ds_read_b64_tr_b16 a[34:35], v46 offset:33280
    ds_read_b64_tr_b16 a[36:37], v46 offset:36864
    ds_read_b64_tr_b16 a[38:39], v46 offset:37376
    ds_read_b64_tr_b16 a[40:41], v46 offset:40960
    ds_read_b64_tr_b16 a[42:43], v46 offset:41472
    ds_read_b64_tr_b16 a[44:45], v46 offset:45056
    ds_read_b64_tr_b16 a[46:47], v46 offset:45568
    s_waitcnt lgkmcnt(0)
    ds_read_b64_tr_b16 a[48:49], v46 offset:49152
    ds_read_b64_tr_b16 a[50:51], v46 offset:49664
    ds_read_b64_tr_b16 a[52:53], v46 offset:53248
    ds_read_b64_tr_b16 a[54:55], v46 offset:53760
    ds_read_b64_tr_b16 a[56:57], v46 offset:57344
    ds_read_b64_tr_b16 a[58:59], v46 offset:57856
    ds_read_b64_tr_b16 a[60:61], v46 offset:61440
    ds_read_b64_tr_b16 a[62:63], v46 offset:61952
    s_waitcnt lgkmcnt(0)
    s_waitcnt lgkmcnt(0)
    s_barrier
    s_load_dwordx2 s[30:31], s[0:1], 8
    s_lshl_b32 s17, s4, 7
    s_add_u32 s17, s17, 1024
    s_mul_i32 s18, s5, 393216
    s_add_u32 s17, s17, s18
    s_lshl_b32 s19, s5, 14
    s_waitcnt lgkmcnt(0)
    s_add_u32 s30, s30, s17
    s_addc_u32 s31, s31, 0
    s_mov_b32 m0, s19
    s_add_u32 s19, s19, 1024
    global_load_lds_dwordx4 v45, s[30:31]
    s_add_u32 s30, s30, 24576
    s_addc_u32 s31, s31, 0
    s_mov_b32 m0, s19
    s_add_u32 s19, s19, 1024
    global_load_lds_dwordx4 v45, s[30:31]
    s_add_u32 s30, s30, 24576
    s_addc_u32 s31, s31, 0
    s_mov_b32 m0, s19
    s_add_u32 s19, s19, 1024
    global_load_lds_dwordx4 v45, s[30:31]
    s_add_u32 s30, s30, 24576
    s_addc_u32 s31, s31, 0
    s_mov_b32 m0, s19
    s_add_u32 s19, s19, 1024
    global_load_lds_dwordx4 v45, s[30:31]
    s_add_u32 s30, s30, 24576
    s_addc_u32 s31, s31, 0
    s_mov_b32 m0, s19
    s_add_u32 s19, s19, 1024
    global_load_lds_dwordx4 v45, s[30:31]
    s_add_u32 s30, s30, 24576
    s_addc_u32 s31, s31, 0
    s_mov_b32 m0, s19
    s_add_u32 s19, s19, 1024
    global_load_lds_dwordx4 v45, s[30:31]
    s_add_u32 s30, s30, 24576
    s_addc_u32 s31, s31, 0
    s_mov_b32 m0, s19
    s_add_u32 s19, s19, 1024
    global_load_lds_dwordx4 v45, s[30:31]
    s_add_u32 s30, s30, 24576
    s_addc_u32 s31, s31, 0
    s_mov_b32 m0, s19
    s_add_u32 s19, s19, 1024
    global_load_lds_dwordx4 v45, s[30:31]
    s_add_u32 s30, s30, 24576
    s_addc_u32 s31, s31, 0
    s_mov_b32 m0, s19
    s_add_u32 s19, s19, 1024
    global_load_lds_dwordx4 v45, s[30:31]
    s_add_u32 s30, s30, 24576
    s_addc_u32 s31, s31, 0
    s_mov_b32 m0, s19
    s_add_u32 s19, s19, 1024
    global_load_lds_dwordx4 v45, s[30:31]
    s_add_u32 s30, s30, 24576
    s_addc_u32 s31, s31, 0
    s_mov_b32 m0, s19
    s_add_u32 s19, s19, 1024
    global_load_lds_dwordx4 v45, s[30:31]
    s_add_u32 s30, s30, 24576
    s_addc_u32 s31, s31, 0
    s_mov_b32 m0, s19
    s_add_u32 s19, s19, 1024
    global_load_lds_dwordx4 v45, s[30:31]
    s_add_u32 s30, s30, 24576
    s_addc_u32 s31, s31, 0
    s_mov_b32 m0, s19
    s_add_u32 s19, s19, 1024
    global_load_lds_dwordx4 v45, s[30:31]
    s_add_u32 s30, s30, 24576
    s_addc_u32 s31, s31, 0
    s_mov_b32 m0, s19
    s_add_u32 s19, s19, 1024
    global_load_lds_dwordx4 v45, s[30:31]
    s_add_u32 s30, s30, 24576
    s_addc_u32 s31, s31, 0
    s_mov_b32 m0, s19
    s_add_u32 s19, s19, 1024
    global_load_lds_dwordx4 v45, s[30:31]
    s_add_u32 s30, s30, 24576
    s_addc_u32 s31, s31, 0
    s_mov_b32 m0, s19
    s_add_u32 s19, s19, 1024
    global_load_lds_dwordx4 v45, s[30:31]
    s_add_u32 s30, s30, 24576
    s_addc_u32 s31, s31, 0
    s_waitcnt vmcnt(0)
    s_barrier
    ds_read_b64_tr_b16 a[64:65], v46 offset:0
    ds_read_b64_tr_b16 a[66:67], v46 offset:512
    ds_read_b64_tr_b16 a[68:69], v46 offset:4096
    ds_read_b64_tr_b16 a[70:71], v46 offset:4608
    ds_read_b64_tr_b16 a[72:73], v46 offset:8192
    ds_read_b64_tr_b16 a[74:75], v46 offset:8704
    ds_read_b64_tr_b16 a[76:77], v46 offset:12288
    ds_read_b64_tr_b16 a[78:79], v46 offset:12800
    s_waitcnt lgkmcnt(0)
    ds_read_b64_tr_b16 a[80:81], v46 offset:16384
    ds_read_b64_tr_b16 a[82:83], v46 offset:16896
    ds_read_b64_tr_b16 a[84:85], v46 offset:20480
    ds_read_b64_tr_b16 a[86:87], v46 offset:20992
    ds_read_b64_tr_b16 a[88:89], v46 offset:24576
    ds_read_b64_tr_b16 a[90:91], v46 offset:25088
    ds_read_b64_tr_b16 a[92:93], v46 offset:28672
    ds_read_b64_tr_b16 a[94:95], v46 offset:29184
    s_waitcnt lgkmcnt(0)
    ds_read_b64_tr_b16 a[96:97], v46 offset:32768
    ds_read_b64_tr_b16 a[98:99], v46 offset:33280
    ds_read_b64_tr_b16 a[100:101], v46 offset:36864
    ds_read_b64_tr_b16 a[102:103], v46 offset:37376
    ds_read_b64_tr_b16 a[104:105], v46 offset:40960
    ds_read_b64_tr_b16 a[106:107], v46 offset:41472
    ds_read_b64_tr_b16 a[108:109], v46 offset:45056
    ds_read_b64_tr_b16 a[110:111], v46 offset:45568
    s_waitcnt lgkmcnt(0)
    ds_read_b64_tr_b16 a[112:113], v46 offset:49152
    ds_read_b64_tr_b16 a[114:115], v46 offset:49664
    ds_read_b64_tr_b16 a[116:117], v46 offset:53248
    ds_read_b64_tr_b16 a[118:119], v46 offset:53760
    ds_read_b64_tr_b16 a[120:121], v46 offset:57344
    ds_read_b64_tr_b16 a[122:123], v46 offset:57856
    ds_read_b64_tr_b16 a[124:125], v46 offset:61440
    ds_read_b64_tr_b16 a[126:127], v46 offset:61952
    s_waitcnt lgkmcnt(0)
    s_waitcnt lgkmcnt(0)
    s_barrier
    s_load_dwordx2 s[30:31], s[0:1], 8
    s_lshl_b32 s17, s4, 7
    s_add_u32 s17, s17, 2048
    s_mul_i32 s18, s5, 393216
    s_add_u32 s17, s17, s18
    s_lshl_b32 s19, s5, 14
    s_waitcnt lgkmcnt(0)
    s_add_u32 s30, s30, s17
    s_addc_u32 s31, s31, 0
    s_mov_b32 m0, s19
    s_add_u32 s19, s19, 1024
    global_load_lds_dwordx4 v45, s[30:31]
    s_add_u32 s30, s30, 24576
    s_addc_u32 s31, s31, 0
    s_mov_b32 m0, s19
    s_add_u32 s19, s19, 1024
    global_load_lds_dwordx4 v45, s[30:31]
    s_add_u32 s30, s30, 24576
    s_addc_u32 s31, s31, 0
    s_mov_b32 m0, s19
    s_add_u32 s19, s19, 1024
    global_load_lds_dwordx4 v45, s[30:31]
    s_add_u32 s30, s30, 24576
    s_addc_u32 s31, s31, 0
    s_mov_b32 m0, s19
    s_add_u32 s19, s19, 1024
    global_load_lds_dwordx4 v45, s[30:31]
    s_add_u32 s30, s30, 24576
    s_addc_u32 s31, s31, 0
    s_mov_b32 m0, s19
    s_add_u32 s19, s19, 1024
    global_load_lds_dwordx4 v45, s[30:31]
    s_add_u32 s30, s30, 24576
    s_addc_u32 s31, s31, 0
    s_mov_b32 m0, s19
    s_add_u32 s19, s19, 1024
    global_load_lds_dwordx4 v45, s[30:31]
    s_add_u32 s30, s30, 24576
    s_addc_u32 s31, s31, 0
    s_mov_b32 m0, s19
    s_add_u32 s19, s19, 1024
    global_load_lds_dwordx4 v45, s[30:31]
    s_add_u32 s30, s30, 24576
    s_addc_u32 s31, s31, 0
    s_mov_b32 m0, s19
    s_add_u32 s19, s19, 1024
    global_load_lds_dwordx4 v45, s[30:31]
    s_add_u32 s30, s30, 24576
    s_addc_u32 s31, s31, 0
    s_mov_b32 m0, s19
    s_add_u32 s19, s19, 1024
    global_load_lds_dwordx4 v45, s[30:31]
    s_add_u32 s30, s30, 24576
    s_addc_u32 s31, s31, 0
    s_mov_b32 m0, s19
    s_add_u32 s19, s19, 1024
    global_load_lds_dwordx4 v45, s[30:31]
    s_add_u32 s30, s30, 24576
    s_addc_u32 s31, s31, 0
    s_mov_b32 m0, s19
    s_add_u32 s19, s19, 1024
    global_load_lds_dwordx4 v45, s[30:31]
    s_add_u32 s30, s30, 24576
    s_addc_u32 s31, s31, 0
    s_mov_b32 m0, s19
    s_add_u32 s19, s19, 1024
    global_load_lds_dwordx4 v45, s[30:31]
    s_add_u32 s30, s30, 24576
    s_addc_u32 s31, s31, 0
    s_mov_b32 m0, s19
    s_add_u32 s19, s19, 1024
    global_load_lds_dwordx4 v45, s[30:31]
    s_add_u32 s30, s30, 24576
    s_addc_u32 s31, s31, 0
    s_mov_b32 m0, s19
    s_add_u32 s19, s19, 1024
    global_load_lds_dwordx4 v45, s[30:31]
    s_add_u32 s30, s30, 24576
    s_addc_u32 s31, s31, 0
    s_mov_b32 m0, s19
    s_add_u32 s19, s19, 1024
    global_load_lds_dwordx4 v45, s[30:31]
    s_add_u32 s30, s30, 24576
    s_addc_u32 s31, s31, 0
    s_mov_b32 m0, s19
    s_add_u32 s19, s19, 1024
    global_load_lds_dwordx4 v45, s[30:31]
    s_add_u32 s30, s30, 24576
    s_addc_u32 s31, s31, 0
    s_waitcnt vmcnt(0)
    s_barrier
    ds_read_b64_tr_b16 a[128:129], v46 offset:0
    ds_read_b64_tr_b16 a[130:131], v46 offset:512
    ds_read_b64_tr_b16 a[132:133], v46 offset:4096
    ds_read_b64_tr_b16 a[134:135], v46 offset:4608
    ds_read_b64_tr_b16 a[136:137], v46 offset:8192
    ds_read_b64_tr_b16 a[138:139], v46 offset:8704
    ds_read_b64_tr_b16 a[140:141], v46 offset:12288
    ds_read_b64_tr_b16 a[142:143], v46 offset:12800
    s_waitcnt lgkmcnt(0)
    ds_read_b64_tr_b16 a[144:145], v46 offset:16384
    ds_read_b64_tr_b16 a[146:147], v46 offset:16896
    ds_read_b64_tr_b16 a[148:149], v46 offset:20480
    ds_read_b64_tr_b16 a[150:151], v46 offset:20992
    ds_read_b64_tr_b16 a[152:153], v46 offset:24576
    ds_read_b64_tr_b16 a[154:155], v46 offset:25088
    ds_read_b64_tr_b16 a[156:157], v46 offset:28672
    ds_read_b64_tr_b16 a[158:159], v46 offset:29184
    s_waitcnt lgkmcnt(0)
    ds_read_b64_tr_b16 a[160:161], v46 offset:32768
    ds_read_b64_tr_b16 a[162:163], v46 offset:33280
    ds_read_b64_tr_b16 a[164:165], v46 offset:36864
    ds_read_b64_tr_b16 a[166:167], v46 offset:37376
    ds_read_b64_tr_b16 a[168:169], v46 offset:40960
    ds_read_b64_tr_b16 a[170:171], v46 offset:41472
    ds_read_b64_tr_b16 a[172:173], v46 offset:45056
    ds_read_b64_tr_b16 a[174:175], v46 offset:45568
    s_waitcnt lgkmcnt(0)
    ds_read_b64_tr_b16 a[176:177], v46 offset:49152
    ds_read_b64_tr_b16 a[178:179], v46 offset:49664
    ds_read_b64_tr_b16 a[180:181], v46 offset:53248
    ds_read_b64_tr_b16 a[182:183], v46 offset:53760
    ds_read_b64_tr_b16 a[184:185], v46 offset:57344
    ds_read_b64_tr_b16 a[186:187], v46 offset:57856
    ds_read_b64_tr_b16 a[188:189], v46 offset:61440
    ds_read_b64_tr_b16 a[190:191], v46 offset:61952
    s_waitcnt lgkmcnt(0)
    s_waitcnt lgkmcnt(0)
    s_barrier
    v_lshlrev_b32 v0, 4, v40
    v_lshlrev_b32 v1, 9, v42
    v_lshl_add_u32 v1, v41, 4, v1
    v_xor_b32 v1, 0x8000, v1
    s_lshl_b32 s28, s5, 12
    v_and_b32 v4, 1, v40
    v_lshlrev_b32 v4, 6, v4
    v_add_u32 v4, 19456, v4
    s_mov_b32 s12, s8
    s_mov_b32 s13, s9
    s_mov_b32 s34, 1052289595
    s_mul_i32 s18, s6, 1024
    s_add_u32 s18, s18, 16384
    s_lshl_b32 s17, s4, 4
    s_add_u32 s17, s17, s5
    s_lshl_b32 s17, s17, 2
    s_add_u32 s18, s18, s17
    s_add_u32 s26, s8, s18
    s_addc_u32 s27, s9, 0
    s_mul_i32 s18, s6, 2097152
    s_add_u32 s18, s18, 8388608
    s_lshl_b32 s17, s5, 12
    s_add_u32 s18, s18, s17
    s_add_u32 s10, s8, s18
    s_addc_u32 s11, s9, 0
    s_mul_i32 s18, s6, 2097152
    s_add_u32 s18, s18, 12582912
    s_lshl_b32 s17, s33, 10
    s_add_u32 s18, s18, s17
    s_add_u32 s20, s8, s18
    s_addc_u32 s21, s9, 0
    v_lshlrev_b32 v48, 2, v42
    v_add_u32 v49, 48, v48
    v_add_u32 v50, 64, v41
    v_sub_u32 v49, v50, v49
    v_and_b32 v50, 0xfffffff1, v49
    v_mov_b32 v96, 4286578688
    v_cmp_eq_u32 vcc, 0, v50
    s_nop 1
    v_mov_b32 v51, 0
    v_cndmask_b32 v96, v96, v51, vcc
    v_add_u32 v49, 49, v48
    v_add_u32 v50, 64, v41
    v_sub_u32 v49, v50, v49
    v_and_b32 v50, 0xfffffff1, v49
    v_mov_b32 v97, 4286578688
    v_cmp_eq_u32 vcc, 0, v50
    s_nop 1
    v_mov_b32 v51, 0
    v_cndmask_b32 v97, v97, v51, vcc
    v_add_u32 v49, 50, v48
    v_add_u32 v50, 64, v41
    v_sub_u32 v49, v50, v49
    v_and_b32 v50, 0xfffffff1, v49
    v_mov_b32 v98, 4286578688
    v_cmp_eq_u32 vcc, 0, v50
    s_nop 1
    v_mov_b32 v51, 0
    v_cndmask_b32 v98, v98, v51, vcc
    v_add_u32 v49, 51, v48
    v_add_u32 v50, 64, v41
    v_sub_u32 v49, v50, v49
    v_and_b32 v50, 0xfffffff1, v49
    v_mov_b32 v99, 4286578688
    v_cmp_eq_u32 vcc, 0, v50
    s_nop 1
    v_mov_b32 v51, 0
    v_cndmask_b32 v99, v99, v51, vcc
    v_add_u32 v49, 64, v48
    v_add_u32 v50, 64, v41
    v_sub_u32 v49, v50, v49
    v_and_b32 v50, 0xfffffff1, v49
    v_mov_b32 v100, 4286578688
    v_cmp_eq_u32 vcc, 0, v50
    s_nop 1
    v_mov_b32 v51, 0
    v_cndmask_b32 v100, v100, v51, vcc
    v_add_u32 v49, 65, v48
    v_add_u32 v50, 64, v41
    v_sub_u32 v49, v50, v49
    v_and_b32 v50, 0xfffffff1, v49
    v_mov_b32 v101, 4286578688
    v_cmp_eq_u32 vcc, 0, v50
    s_nop 1
    v_mov_b32 v51, 0
    v_cndmask_b32 v101, v101, v51, vcc
    v_add_u32 v49, 66, v48
    v_add_u32 v50, 64, v41
    v_sub_u32 v49, v50, v49
    v_and_b32 v50, 0xfffffff1, v49
    v_mov_b32 v102, 4286578688
    v_cmp_eq_u32 vcc, 0, v50
    s_nop 1
    v_mov_b32 v51, 0
    v_cndmask_b32 v102, v102, v51, vcc
    v_add_u32 v49, 67, v48
    v_add_u32 v50, 64, v41
    v_sub_u32 v49, v50, v49
    v_and_b32 v50, 0xfffffff1, v49
    v_mov_b32 v103, 4286578688
    v_cmp_eq_u32 vcc, 0, v50
    s_nop 1
    v_mov_b32 v51, 0
    v_cndmask_b32 v103, v103, v51, vcc
    v_mov_b32 v104, 4286578688
    v_mov_b32 v108, 1065369472
    v_mov_b32 v105, 4286578688
    v_mov_b32 v109, 1065369472
    v_mov_b32 v106, 4286578688
    v_mov_b32 v110, 1065369472
    v_mov_b32 v107, 4286578688
    v_mov_b32 v111, 1065369472
    v_mov_b32 v60, 0
    v_mov_b32 v66, 0
    v_mov_b32 v61, 0
    v_mov_b32 v67, 0
    s_load_dwordx2 s[30:31], s[0:1], 88
    s_mov_b32 s14, 1
    s_mov_b32 s7, 0
    v_mov_b32 v123, 248
    s_waitcnt lgkmcnt(0)
    s_mov_b32 s16, 0
Lp_248:
    global_load_dword v3, v123, s[30:31] sc1
    s_add_u32 s16, s16, 1
    s_cmp_gt_u32 s16, 262144
    s_cbranch_scc1 Lwito_246
    s_waitcnt vmcnt(0)
    v_cmp_gt_u32 vcc, s14, v3
    s_cbranch_vccnz Lp_248
    s_branch Lwisk_247
Lwito_246:
    s_load_dwordx2 s[30:31], s[0:1], 88
    s_waitcnt lgkmcnt(0)
    s_mov_b64 exec, 1
    v_mov_b32 v2, 176
    v_mov_b32 v3, s7
    v_add_u32 v3, 0x10000, v3
    global_store_dword v2, v3, s[30:31] sc1
    s_waitcnt vmcnt(0)
    s_endpgm
Lwisk_247:
    s_mov_b32 s7, 0
    s_mov_b32 s19, 0
    s_mov_b32 s35, 0
    s_mov_b32 s37, 0
    s_add_u32 s14, s19, 1
    s_mul_i32 s14, s14, s6
    s_and_b32 s17, s19, 1
    s_lshl_b32 s17, s17, 7
    v_add_u32 v2, s17, v4
    s_mov_b32 s16, 0
Lp_249:
    global_load_dword v3, v2, s[12:13] sc1
    s_add_u32 s16, s16, 1
    s_cmp_gt_u32 s16, 262144
    s_cbranch_scc1 LtoTA_244
    s_waitcnt vmcnt(0)
    v_cmp_gt_u32 vcc, s14, v3
    s_cbranch_vccnz Lp_249
    s_add_u32 s17, s28, 0
    s_mov_b32 m0, s17
    s_nop 0
    global_load_lds_dwordx4 v0, s[10:11] offset:0 sc1
    global_load_lds_dwordx4 v0, s[10:11] offset:1024 sc1
    global_load_lds_dwordx4 v0, s[10:11] offset:2048 sc1
    global_load_lds_dwordx4 v0, s[10:11] offset:3072 sc1
    s_add_u32 s10, s10, 16384
    s_addc_u32 s11, s11, 0
    s_add_u32 s17, s28, 16384
    s_mov_b32 m0, s17
    s_nop 0
    global_load_lds_dwordx4 v0, s[10:11] offset:0 sc1
    global_load_lds_dwordx4 v0, s[10:11] offset:1024 sc1
    global_load_lds_dwordx4 v0, s[10:11] offset:2048 sc1
    global_load_lds_dwordx4 v0, s[10:11] offset:3072 sc1
    s_add_u32 s10, s10, 16384
    s_addc_u32 s11, s11, 0
    s_waitcnt vmcnt(0)
    s_barrier
LitTA_245:
    v_xor_b32 v1, 0x8000, v1
    s_xor_b32 s28, s28, 0x8000
    s_add_u32 s19, s7, 1
    s_add_u32 s14, s19, 1
    s_mul_i32 s14, s14, s6
    s_and_b32 s17, s19, 1
    s_lshl_b32 s17, s17, 7
    v_add_u32 v2, s17, v4
    s_cmp_ge_u32 s19, 64
    s_cselect_b32 s15, 1, 0
    ds_read_b128 v[8:11], v1 offset:0
    ds_read_b128 v[12:15], v1 offset:256
    ds_read_b128 v[16:19], v1 offset:2048
    ds_read_b128 v[20:23], v1 offset:2304
    ds_read_b128 v[24:27], v1 offset:4096
    ds_read_b128 v[28:31], v1 offset:4352
    s_waitcnt lgkmcnt(4)
    v_mfma_f32_16x16x32_bf16 v[32:35], a[0:3], v[8:11], 0
    v_mfma_f32_16x16x32_bf16 v[40:43], a[64:67], v[8:11], 0
    v_mfma_f32_16x16x32_bf16 v[48:51], v[8:11], a[128:131], 0
    v_mfma_f32_16x16x32_bf16 v[36:39], a[0:3], v[12:15], 0
    v_mfma_f32_16x16x32_bf16 v[44:47], a[64:67], v[12:15], 0
    v_mfma_f32_16x16x32_bf16 v[52:55], v[12:15], a[128:131], 0
    global_load_dword v3, v2, s[12:13] sc1
    ds_read_b128 v[8:11], v1 offset:6144
    ds_read_b128 v[12:15], v1 offset:6400
    s_waitcnt lgkmcnt(4)
    v_mfma_f32_16x16x32_bf16 v[32:35], a[4:7], v[16:19], v[32:35]
    v_mfma_f32_16x16x32_bf16 v[40:43], a[68:71], v[16:19], v[40:43]
    v_mfma_f32_16x16x32_bf16 v[48:51], v[16:19], a[132:135], v[48:51]
    v_mfma_f32_16x16x32_bf16 v[36:39], a[4:7], v[20:23], v[36:39]
    v_mfma_f32_16x16x32_bf16 v[44:47], a[68:71], v[20:23], v[44:47]
    v_mfma_f32_16x16x32_bf16 v[52:55], v[20:23], a[132:135], v[52:55]
    ds_read_b128 v[16:19], v1 offset:8192
    ds_read_b128 v[20:23], v1 offset:8448
    s_waitcnt lgkmcnt(4)
    v_mfma_f32_16x16x32_bf16 v[32:35], a[8:11], v[24:27], v[32:35]
    v_mfma_f32_16x16x32_bf16 v[40:43], a[72:75], v[24:27], v[40:43]
    v_mfma_f32_16x16x32_bf16 v[48:51], v[24:27], a[136:139], v[48:51]
    v_mfma_f32_16x16x32_bf16 v[36:39], a[8:11], v[28:31], v[36:39]
    v_mfma_f32_16x16x32_bf16 v[44:47], a[72:75], v[28:31], v[44:47]
    v_mfma_f32_16x16x32_bf16 v[52:55], v[28:31], a[136:139], v[52:55]
    ds_read_b128 v[24:27], v1 offset:10240
    ds_read_b128 v[28:31], v1 offset:10496
    s_waitcnt lgkmcnt(4)
    v_mfma_f32_16x16x32_bf16 v[32:35], a[12:15], v[8:11], v[32:35]
    v_mfma_f32_16x16x32_bf16 v[40:43], a[76:79], v[8:11], v[40:43]
    v_mfma_f32_16x16x32_bf16 v[48:51], v[8:11], a[140:143], v[48:51]
    v_mfma_f32_16x16x32_bf16 v[36:39], a[12:15], v[12:15], v[36:39]
    v_mfma_f32_16x16x32_bf16 v[44:47], a[76:79], v[12:15], v[44:47]
    v_mfma_f32_16x16x32_bf16 v[52:55], v[12:15], a[140:143], v[52:55]
    ds_read_b128 v[8:11], v1 offset:12288
    ds_read_b128 v[12:15], v1 offset:12544
    s_waitcnt lgkmcnt(4)
    v_mfma_f32_16x16x32_bf16 v[32:35], a[16:19], v[16:19], v[32:35]
    v_mfma_f32_16x16x32_bf16 v[40:43], a[80:83], v[16:19], v[40:43]
    v_mfma_f32_16x16x32_bf16 v[48:51], v[16:19], a[144:147], v[48:51]
    v_mfma_f32_16x16x32_bf16 v[36:39], a[16:19], v[20:23], v[36:39]
    v_mfma_f32_16x16x32_bf16 v[44:47], a[80:83], v[20:23], v[44:47]
    v_mfma_f32_16x16x32_bf16 v[52:55], v[20:23], a[144:147], v[52:55]
    ds_read_b128 v[16:19], v1 offset:14336
    ds_read_b128 v[20:23], v1 offset:14592
    s_waitcnt lgkmcnt(4)
    v_mfma_f32_16x16x32_bf16 v[32:35], a[20:23], v[24:27], v[32:35]
    v_mfma_f32_16x16x32_bf16 v[40:43], a[84:87], v[24:27], v[40:43]
    v_mfma_f32_16x16x32_bf16 v[48:51], v[24:27], a[148:151], v[48:51]
    v_mfma_f32_16x16x32_bf16 v[36:39], a[20:23], v[28:31], v[36:39]
    v_mfma_f32_16x16x32_bf16 v[44:47], a[84:87], v[28:31], v[44:47]
    v_mfma_f32_16x16x32_bf16 v[52:55], v[28:31], a[148:151], v[52:55]
    s_waitcnt vmcnt(0)
    s_barrier
    v_cmp_gt_u32 vcc, s14, v3
    s_cmp_eq_u32 s35, 0
    s_cbranch_scc1 Lnp_251
    v_mov_b32 v3, s7
    s_mov_b64 exec, 1
    global_store_dword v0, v3, s[26:27] sc1
    s_mov_b64 exec, -1
Lpub_252:
    s_mov_b32 s35, 0
Lnp_251:
    s_cmp_lg_u32 s15, 0
    s_cbranch_scc1 Lhk_250
    s_cbranch_vccnz Lnr_253
    s_mov_b32 s15, 1
    s_mov_b32 s37, 1
    s_branch Lhk_250
Lnr_253:
    global_load_dword v3, v2, s[12:13] sc1
Lhk_250:
    ds_read_b128 v[24:27], v1 offset:16384
    ds_read_b128 v[28:31], v1 offset:16640
    s_waitcnt lgkmcnt(4)
    v_mfma_f32_16x16x32_bf16 v[32:35], a[24:27], v[8:11], v[32:35]
    v_mfma_f32_16x16x32_bf16 v[40:43], a[88:91], v[8:11], v[40:43]
    v_mfma_f32_16x16x32_bf16 v[48:51], v[8:11], a[152:155], v[48:51]
    v_mfma_f32_16x16x32_bf16 v[36:39], a[24:27], v[12:15], v[36:39]
    v_mfma_f32_16x16x32_bf16 v[44:47], a[88:91], v[12:15], v[44:47]
    v_mfma_f32_16x16x32_bf16 v[52:55], v[12:15], a[152:155], v[52:55]
    s_cmp_eq_u32 s37, 0
    s_cbranch_scc1 Lch_254
    s_add_u32 s17, s28, 0
    s_mov_b32 m0, s17
    s_nop 0
    global_load_lds_dwordx4 v0, s[10:11] offset:0 sc1
Lch_254:
    s_cmp_eq_u32 s37, 0
    s_cbranch_scc1 Lch_255
    global_load_lds_dwordx4 v0, s[10:11] offset:1024 sc1
Lch_255:
    ds_read_b128 v[8:11], v1 offset:18432
    ds_read_b128 v[12:15], v1 offset:18688
    s_waitcnt lgkmcnt(4)
    v_mfma_f32_16x16x32_bf16 v[32:35], a[28:31], v[16:19], v[32:35]
    v_mfma_f32_16x16x32_bf16 v[40:43], a[92:95], v[16:19], v[40:43]
    v_mfma_f32_16x16x32_bf16 v[48:51], v[16:19], a[156:159], v[48:51]
    v_mfma_f32_16x16x32_bf16 v[36:39], a[28:31], v[20:23], v[36:39]
    v_mfma_f32_16x16x32_bf16 v[44:47], a[92:95], v[20:23], v[44:47]
    v_mfma_f32_16x16x32_bf16 v[52:55], v[20:23], a[156:159], v[52:55]
    s_cmp_eq_u32 s37, 0
    s_cbranch_scc1 Lch_256
    global_load_lds_dwordx4 v0, s[10:11] offset:2048 sc1
Lch_256:
    s_cmp_eq_u32 s37, 0
    s_cbranch_scc1 Lch_257
    global_load_lds_dwordx4 v0, s[10:11] offset:3072 sc1
    s_add_u32 s10, s10, 16384
    s_addc_u32 s11, s11, 0
Lch_257:
    ds_read_b128 v[16:19], v1 offset:20480
    ds_read_b128 v[20:23], v1 offset:20736
    s_waitcnt lgkmcnt(4)
    v_mfma_f32_16x16x32_bf16 v[32:35], a[32:35], v[24:27], v[32:35]
    v_mfma_f32_16x16x32_bf16 v[40:43], a[96:99], v[24:27], v[40:43]
    v_mfma_f32_16x16x32_bf16 v[48:51], v[24:27], a[160:163], v[48:51]
    v_mfma_f32_16x16x32_bf16 v[36:39], a[32:35], v[28:31], v[36:39]
    v_mfma_f32_16x16x32_bf16 v[44:47], a[96:99], v[28:31], v[44:47]
    v_mfma_f32_16x16x32_bf16 v[52:55], v[28:31], a[160:163], v[52:55]
    s_cmp_eq_u32 s37, 0
    s_cbranch_scc1 Lch_258
    s_add_u32 s17, s28, 16384
    s_mov_b32 m0, s17
    s_nop 0
    global_load_lds_dwordx4 v0, s[10:11] offset:0 sc1
Lch_258:
    s_cmp_eq_u32 s37, 0
    s_cbranch_scc1 Lch_259
    global_load_lds_dwordx4 v0, s[10:11] offset:1024 sc1
Lch_259:
    ds_read_b128 v[24:27], v1 offset:22528
    ds_read_b128 v[28:31], v1 offset:22784
    s_waitcnt lgkmcnt(4)
    v_mfma_f32_16x16x32_bf16 v[32:35], a[36:39], v[8:11], v[32:35]
    v_mfma_f32_16x16x32_bf16 v[40:43], a[100:103], v[8:11], v[40:43]
    v_mfma_f32_16x16x32_bf16 v[48:51], v[8:11], a[164:167], v[48:51]
    v_mfma_f32_16x16x32_bf16 v[36:39], a[36:39], v[12:15], v[36:39]
    v_mfma_f32_16x16x32_bf16 v[44:47], a[100:103], v[12:15], v[44:47]
    v_mfma_f32_16x16x32_bf16 v[52:55], v[12:15], a[164:167], v[52:55]
    s_cmp_eq_u32 s37, 0
    s_cbranch_scc1 Lch_260
    global_load_lds_dwordx4 v0, s[10:11] offset:2048 sc1
Lch_260:
    s_cmp_eq_u32 s37, 0
    s_cbranch_scc1 Lch_261
    global_load_lds_dwordx4 v0, s[10:11] offset:3072 sc1
    s_add_u32 s10, s10, 16384
    s_addc_u32 s11, s11, 0
    s_mov_b32 s37, 0
Lch_261:
    ds_read_b128 v[8:11], v1 offset:24576
    ds_read_b128 v[12:15], v1 offset:24832
    s_waitcnt lgkmcnt(4)
    v_mfma_f32_16x16x32_bf16 v[32:35], a[40:43], v[16:19], v[32:35]
    v_mfma_f32_16x16x32_bf16 v[40:43], a[104:107], v[16:19], v[40:43]
    v_mfma_f32_16x16x32_bf16 v[48:51], v[16:19], a[168:171], v[48:51]
    v_mfma_f32_16x16x32_bf16 v[36:39], a[40:43], v[20:23], v[36:39]
    v_mfma_f32_16x16x32_bf16 v[44:47], a[104:107], v[20:23], v[44:47]
    v_mfma_f32_16x16x32_bf16 v[52:55], v[20:23], a[168:171], v[52:55]
    ds_read_b128 v[16:19], v1 offset:26624
    ds_read_b128 v[20:23], v1 offset:26880
    s_waitcnt lgkmcnt(4)
    v_mfma_f32_16x16x32_bf16 v[32:35], a[44:47], v[24:27], v[32:35]
    v_mfma_f32_16x16x32_bf16 v[40:43], a[108:111], v[24:27], v[40:43]
    v_mfma_f32_16x16x32_bf16 v[48:51], v[24:27], a[172:175], v[48:51]
    v_mfma_f32_16x16x32_bf16 v[36:39], a[44:47], v[28:31], v[36:39]
    v_mfma_f32_16x16x32_bf16 v[44:47], a[108:111], v[28:31], v[44:47]
    v_mfma_f32_16x16x32_bf16 v[52:55], v[28:31], a[172:175], v[52:55]
    ds_read_b128 v[24:27], v1 offset:28672
    ds_read_b128 v[28:31], v1 offset:28928
    s_waitcnt lgkmcnt(4)
    v_mfma_f32_16x16x32_bf16 v[32:35], a[48:51], v[8:11], v[32:35]
    v_mfma_f32_16x16x32_bf16 v[40:43], a[112:115], v[8:11], v[40:43]
    v_mfma_f32_16x16x32_bf16 v[48:51], v[8:11], a[176:179], v[48:51]
    v_mfma_f32_16x16x32_bf16 v[36:39], a[48:51], v[12:15], v[36:39]
    v_mfma_f32_16x16x32_bf16 v[44:47], a[112:115], v[12:15], v[44:47]
    v_mfma_f32_16x16x32_bf16 v[52:55], v[12:15], a[176:179], v[52:55]
    s_cmp_lg_u32 s15, 0
    s_cbranch_scc1 Lhk_262
    s_waitcnt vmcnt(0)
    v_cmp_gt_u32 vcc, s14, v3
    s_cbranch_vccnz Lnr1_263
    s_add_u32 s17, s28, 0
    s_mov_b32 m0, s17
    s_nop 0
    global_load_lds_dwordx4 v0, s[10:11] offset:0 sc1
    global_load_lds_dwordx4 v0, s[10:11] offset:1024 sc1
    global_load_lds_dwordx4 v0, s[10:11] offset:2048 sc1
    global_load_lds_dwordx4 v0, s[10:11] offset:3072 sc1
    s_add_u32 s10, s10, 16384
    s_addc_u32 s11, s11, 0
    s_add_u32 s17, s28, 16384
    s_mov_b32 m0, s17
    s_nop 0
    global_load_lds_dwordx4 v0, s[10:11] offset:0 sc1
    global_load_lds_dwordx4 v0, s[10:11] offset:1024 sc1
    global_load_lds_dwordx4 v0, s[10:11] offset:2048 sc1
    global_load_lds_dwordx4 v0, s[10:11] offset:3072 sc1
    s_add_u32 s10, s10, 16384
    s_addc_u32 s11, s11, 0
    s_mov_b32 s15, 1
    s_branch Lhk_262
Lnr1_263:
    global_load_dword v3, v2, s[12:13] sc1
Lhk_262:
    ds_read_b128 v[8:11], v1 offset:30720
    ds_read_b128 v[12:15], v1 offset:30976
    s_waitcnt lgkmcnt(4)
    v_mfma_f32_16x16x32_bf16 v[32:35], a[52:55], v[16:19], v[32:35]
    v_mfma_f32_16x16x32_bf16 v[40:43], a[116:119], v[16:19], v[40:43]
    v_mfma_f32_16x16x32_bf16 v[48:51], v[16:19], a[180:183], v[48:51]
    v_mfma_f32_16x16x32_bf16 v[36:39], a[52:55], v[20:23], v[36:39]
    v_mfma_f32_16x16x32_bf16 v[44:47], a[116:119], v[20:23], v[44:47]
    v_mfma_f32_16x16x32_bf16 v[52:55], v[20:23], a[180:183], v[52:55]
    s_waitcnt lgkmcnt(2)
    v_mfma_f32_16x16x32_bf16 v[32:35], a[56:59], v[24:27], v[32:35]
    v_mfma_f32_16x16x32_bf16 v[40:43], a[120:123], v[24:27], v[40:43]
    v_mfma_f32_16x16x32_bf16 v[48:51], v[24:27], a[184:187], v[48:51]
    v_mfma_f32_16x16x32_bf16 v[36:39], a[56:59], v[28:31], v[36:39]
    v_mfma_f32_16x16x32_bf16 v[44:47], a[120:123], v[28:31], v[44:47]
    v_mfma_f32_16x16x32_bf16 v[52:55], v[28:31], a[184:187], v[52:55]
    s_waitcnt lgkmcnt(0)
    v_mfma_f32_16x16x32_bf16 v[32:35], a[60:63], v[8:11], v[32:35]
    v_mfma_f32_16x16x32_bf16 v[40:43], a[124:127], v[8:11], v[40:43]
    v_mfma_f32_16x16x32_bf16 v[48:51], v[8:11], a[188:191], v[48:51]
    v_mfma_f32_16x16x32_bf16 v[36:39], a[60:63], v[12:15], v[36:39]
    v_mfma_f32_16x16x32_bf16 v[44:47], a[124:127], v[12:15], v[44:47]
    v_mfma_f32_16x16x32_bf16 v[52:55], v[12:15], a[188:191], v[52:55]
    s_nop 7
    v_cvt_pk_bf16_f32 v56, v32, v33
    v_cvt_pk_bf16_f32 v57, v34, v35
    v_cvt_pk_bf16_f32 v62, v40, v41
    v_cvt_pk_bf16_f32 v63, v42, v43
    v_cvt_pk_bf16_f32 v68, v48, v49
    v_cvt_pk_bf16_f32 v69, v50, v51
    v_cvt_pk_bf16_f32 v58, v36, v37
    v_cvt_pk_bf16_f32 v59, v38, v39
    v_cvt_pk_bf16_f32 v64, v44, v45
    v_cvt_pk_bf16_f32 v65, v46, v47
    v_cvt_pk_bf16_f32 v70, v52, v53
    v_cvt_pk_bf16_f32 v71, v54, v55
    s_nop 1
    v_mfma_f32_16x16x16_bf16 v[72:75], v[60:61], v[56:57], 0
    v_mfma_f32_16x16x16_bf16 v[76:79], v[62:63], v[56:57], 0
    s_nop 7
    v_fma_f32 v72, v72, s34, v104
    v_fma_f32 v73, v73, s34, v105
    v_fma_f32 v74, v74, s34, v106
    v_fma_f32 v75, v75, s34, v107
    v_fma_f32 v76, v76, s34, v100
    v_fma_f32 v77, v77, s34, v101
    v_fma_f32 v78, v78, s34, v102
    v_fma_f32 v79, v79, s34, v103
    v_max3_f32 v112, v72, v73, v74
    v_max3_f32 v112, v112, v75, v76
    v_max3_f32 v112, v112, v77, v78
    v_max_f32 v112, v112, v79
    v_mov_b32 v113, v112
    s_nop 1
    v_permlane32_swap_b32 v112, v113
    v_max_f32 v112, v112, v113
    v_mov_b32 v113, v112
    s_nop 1
    v_permlane16_swap_b32 v112, v113
    v_max_f32 v112, v112, v113
    v_sub_f32 v72, v72, v112
    v_sub_f32 v73, v73, v112
    v_sub_f32 v74, v74, v112
    v_sub_f32 v75, v75, v112
    v_sub_f32 v76, v76, v112
    v_sub_f32 v77, v77, v112
    v_sub_f32 v78, v78, v112
    v_sub_f32 v79, v79, v112
    v_exp_f32 v72, v72
    v_exp_f32 v73, v73
    v_exp_f32 v74, v74
    v_exp_f32 v75, v75
    v_exp_f32 v76, v76
    v_exp_f32 v77, v77
    v_exp_f32 v78, v78
    v_exp_f32 v79, v79
    s_nop 0
    v_cvt_pk_bf16_f32 v80, v72, v73
    v_cvt_pk_bf16_f32 v81, v74, v75
    v_cvt_pk_bf16_f32 v82, v76, v77
    v_cvt_pk_bf16_f32 v83, v78, v79
    s_nop 1
    v_mfma_f32_16x16x32_bf16 v[84:87], v[108:111], v[80:83], 0
    v_mfma_f32_16x16x32_bf16 v[88:91], v[66:69], v[80:83], 0
    s_nop 6
    v_rcp_f32 v84, v84
    s_nop 0
    v_mul_f32 v88, v88, v84
    v_mul_f32 v89, v89, v84
    v_mul_f32 v90, v90, v84
    v_mul_f32 v91, v91, v84
    v_cvt_pk_bf16_f32 v92, v88, v89
    v_cvt_pk_bf16_f32 v93, v90, v91
    s_nop 1
    v_mfma_f32_16x16x16_bf16 v[72:75], v[62:63], v[58:59], 0
    v_mfma_f32_16x16x16_bf16 v[76:79], v[64:65], v[58:59], 0
    s_nop 7
    v_fma_f32 v72, v72, s34, v96
    v_fma_f32 v73, v73, s34, v97
    v_fma_f32 v74, v74, s34, v98
    v_fma_f32 v75, v75, s34, v99
    v_fma_f32 v76, v76, s34, v100
    v_fma_f32 v77, v77, s34, v101
    v_fma_f32 v78, v78, s34, v102
    v_fma_f32 v79, v79, s34, v103
    v_max3_f32 v112, v72, v73, v74
    v_max3_f32 v112, v112, v75, v76
    v_max3_f32 v112, v112, v77, v78
    v_max_f32 v112, v112, v79
    v_mov_b32 v113, v112
    s_nop 1
    v_permlane32_swap_b32 v112, v113
    v_max_f32 v112, v112, v113
    v_mov_b32 v113, v112
    s_nop 1
    v_permlane16_swap_b32 v112, v113
    v_max_f32 v112, v112, v113
    v_sub_f32 v72, v72, v112
    v_sub_f32 v73, v73, v112
    v_sub_f32 v74, v74, v112
    v_sub_f32 v75, v75, v112
    v_sub_f32 v76, v76, v112
    v_sub_f32 v77, v77, v112
    v_sub_f32 v78, v78, v112
    v_sub_f32 v79, v79, v112
    v_exp_f32 v72, v72
    v_exp_f32 v73, v73
    v_exp_f32 v74, v74
    v_exp_f32 v75, v75
    v_exp_f32 v76, v76
    v_exp_f32 v77, v77
    v_exp_f32 v78, v78
    v_exp_f32 v79, v79
    s_nop 0
    v_cvt_pk_bf16_f32 v80, v72, v73
    v_cvt_pk_bf16_f32 v81, v74, v75
    v_cvt_pk_bf16_f32 v82, v76, v77
    v_cvt_pk_bf16_f32 v83, v78, v79
    s_nop 1
    v_mfma_f32_16x16x32_bf16 v[84:87], v[108:111], v[80:83], 0
    v_mfma_f32_16x16x32_bf16 v[88:91], v[68:71], v[80:83], 0
    s_nop 6
    v_rcp_f32 v84, v84
    s_nop 0
    v_mul_f32 v88, v88, v84
    v_mul_f32 v89, v89, v84
    v_mul_f32 v90, v90, v84
    v_mul_f32 v91, v91, v84
    v_cvt_pk_bf16_f32 v94, v88, v89
    v_cvt_pk_bf16_f32 v95, v90, v91
    s_cmp_lg_u32 s15, 0
    s_cbranch_scc1 Lhk_264
    s_waitcnt vmcnt(0)
    v_cmp_gt_u32 vcc, s14, v3
    s_cbranch_vccnz Lnr2_265
    s_mov_b32 s37, 2
    s_branch Lhk_264
Lnr2_265:
    global_load_dword v3, v2, s[12:13] sc1
Lhk_264:
    s_nop 1
    v_permlane16_swap_b32 v92, v94
    v_permlane16_swap_b32 v93, v95
    global_store_dwordx4 v0, v[92:95], s[20:21] sc1
    v_mov_b32 v60, v64
    v_mov_b32 v61, v65
    v_mov_b32 v66, v70
    v_mov_b32 v67, v71
    v_mov_b32 v104, v96
    v_mov_b32 v105, v97
    v_mov_b32 v106, v98
    v_mov_b32 v107, v99
    s_add_u32 s20, s20, 32768
    s_addc_u32 s21, s21, 0
    s_add_u32 s7, s7, 1
    s_cmp_lg_u32 s15, 0
    s_cbranch_scc1 Lh3_269
    s_cmp_eq_u32 s37, 2
    s_cbranch_scc1 Lh3_269
    s_waitcnt vmcnt(1)
    v_cmp_gt_u32 vcc, s14, v3
    s_cbranch_vccnz Lh3_269
    s_mov_b32 s37, 2
Lh3_269:
    s_cmp_lg_u32 s37, 2
    s_cbranch_scc1 Lng2_268
    s_add_u32 s17, s28, 0
    s_mov_b32 m0, s17
    s_nop 0
    global_load_lds_dwordx4 v0, s[10:11] offset:0 sc1
    global_load_lds_dwordx4 v0, s[10:11] offset:1024 sc1
    global_load_lds_dwordx4 v0, s[10:11] offset:2048 sc1
    global_load_lds_dwordx4 v0, s[10:11] offset:3072 sc1
    s_add_u32 s10, s10, 16384
    s_addc_u32 s11, s11, 0
    s_add_u32 s17, s28, 16384
    s_mov_b32 m0, s17
    s_nop 0
    global_load_lds_dwordx4 v0, s[10:11] offset:0 sc1
    global_load_lds_dwordx4 v0, s[10:11] offset:1024 sc1
    global_load_lds_dwordx4 v0, s[10:11] offset:2048 sc1
    global_load_lds_dwordx4 v0, s[10:11] offset:3072 sc1
    s_add_u32 s10, s10, 16384
    s_addc_u32 s11, s11, 0
    s_mov_b32 s37, 0
    s_waitcnt vmcnt(8)
    v_mov_b32 v3, s7
    s_mov_b64 exec, 1
    global_store_dword v0, v3, s[26:27] sc1
    s_mov_b64 exec, -1
Lpub_270:
    s_waitcnt vmcnt(5)
    s_branch Ljoin_267
Lng2_268:
    s_cmp_ge_u32 s7, 64
    s_cbranch_scc1 Llate_266
    s_cmp_eq_u32 s15, 0
    s_cbranch_scc1 Llate_266
    s_waitcnt vmcnt(1)
    s_mov_b32 s35, 1
    s_branch Ljoin_267
Llate_266:
    s_waitcnt vmcnt(0)
    v_mov_b32 v3, s7
    s_mov_b64 exec, 1
    global_store_dword v0, v3, s[26:27] sc1
    s_mov_b64 exec, -1
Lpub_271:
    s_cmp_ge_u32 s7, 64
    s_cbranch_scc1 Ljoin_267
    s_mov_b32 s16, 0
Lp_272:
    global_load_dword v3, v2, s[12:13] sc1
    s_add_u32 s16, s16, 1
    s_cmp_gt_u32 s16, 262144
    s_cbranch_scc1 LtoTA_244
    s_waitcnt vmcnt(0)
    v_cmp_gt_u32 vcc, s14, v3
    s_cbranch_vccnz Lp_272
    s_add_u32 s17, s28, 0
    s_mov_b32 m0, s17
    s_nop 0
    global_load_lds_dwordx4 v0, s[10:11] offset:0 sc1
    global_load_lds_dwordx4 v0, s[10:11] offset:1024 sc1
    global_load_lds_dwordx4 v0, s[10:11] offset:2048 sc1
    global_load_lds_dwordx4 v0, s[10:11] offset:3072 sc1
    s_add_u32 s10, s10, 16384
    s_addc_u32 s11, s11, 0
    s_add_u32 s17, s28, 16384
    s_mov_b32 m0, s17
    s_nop 0
    global_load_lds_dwordx4 v0, s[10:11] offset:0 sc1
    global_load_lds_dwordx4 v0, s[10:11] offset:1024 sc1
    global_load_lds_dwordx4 v0, s[10:11] offset:2048 sc1
    global_load_lds_dwordx4 v0, s[10:11] offset:3072 sc1
    s_add_u32 s10, s10, 16384
    s_addc_u32 s11, s11, 0
    s_waitcnt vmcnt(4)
Ljoin_267:
    s_barrier
    s_cmp_lt_u32 s7, 64
    s_cbranch_scc1 LitTA_245
    s_waitcnt vmcnt(0)
    s_endpgm
LtoTA_244:
    s_load_dwordx2 s[30:31], s[0:1], 88
    s_waitcnt lgkmcnt(0)
    s_mov_b64 exec, 1
    v_mov_b32 v2, 152
    v_mov_b32 v3, s7
    v_add_u32 v3, 0x10000, v3
    global_store_dword v2, v3, s[30:31] sc1
    s_waitcnt vmcnt(0)
    s_endpgm
ROLE_T4:
    s_lshl_b32 s17, s4, 2
    s_add_u32 s17, s17, s5
    s_lshr_b32 s33, s17, 1
    s_and_b32 s34, s17, 1
    v_and_b32 v240, 63, v0
    v_and_b32 v241, 15, v240
    v_lshrrev_b32 v242, 4, v240
    v_lshlrev_b32 v0, 4, v240
    v_lshlrev_b32 v4, 9, v242
    v_lshl_add_u32 v4, v241, 4, v4
    v_add_u32 v5, 4096, v4
    v_lshrrev_b32 v243, 2, v241
    v_lshl_add_u32 v243, v242, 3, v243
    v_lshlrev_b32 v243, 4, v243
    v_and_b32 v244, 1, v241
    v_lshl_add_u32 v243, v244, 3, v243
    s_lshl_b32 s28, s5, 11
    v_add_u32 v6, s28, v243
    v_and_b32 v243, 1, v242
    v_lshlrev_b32 v8, 3, v243
    v_lshl_add_u32 v8, v241, 4, v8
    s_mov_b32 s12, s8
    s_mov_b32 s13, s9
    s_mov_b32 s35, 1040356334
    s_mul_i32 s17, s6, 2048
    s_add_u32 s17, s17, 0
    s_lshl_b32 s18, s33, 6
    s_add_u32 s17, s17, s18
    v_mov_b32 v2, s17
    s_mul_i32 s17, s6, 4096
    s_add_u32 s17, s17, 4096
    s_lshl_b32 s18, s33, 7
    s_add_u32 s17, s17, s18
    v_and_b32 v244, 7, v240
    v_min_u32 v244, 5, v244
    v_lshlrev_b32 v243, 4, v244
    v_add_u32 v7, s17, v243
    s_mul_i32 s18, s6, 1024
    s_add_u32 s18, s18, 14336
    s_lshl_b32 s17, s4, 4
    s_add_u32 s17, s17, s5
    s_lshl_b32 s17, s17, 2
    s_add_u32 s18, s18, s17
    s_add_u32 s26, s8, s18
    s_addc_u32 s27, s9, 0
    s_mul_i32 s18, s6, 16777216
    s_add_u32 s18, s18, 50331648
    s_lshl_b32 s17, s33, 13
    s_lshl_b32 s19, s34, 18
    s_add_u32 s17, s17, s19
    s_add_u32 s18, s18, s17
    s_add_u32 s36, s8, s18
    s_addc_u32 s37, s9, 0
    s_mul_i32 s18, s6, 16777216
    s_add_u32 s18, s18, 83886080
    s_lshl_b32 s17, s33, 13
    s_lshl_b32 s19, s34, 18
    s_add_u32 s17, s17, s19
    s_add_u32 s18, s18, s17
    s_add_u32 s38, s8, s18
    s_addc_u32 s39, s9, 0
    s_mul_i32 s18, s6, 16777216
    s_add_u32 s18, s18, 117440512
    s_lshl_b32 s17, s33, 13
    s_lshl_b32 s19, s34, 18
    s_add_u32 s17, s17, s19
    s_add_u32 s18, s18, s17
    s_add_u32 s40, s8, s18
    s_addc_u32 s41, s9, 0
    s_mul_i32 s18, s6, 16777216
    s_add_u32 s18, s18, 150994944
    s_lshl_b32 s17, s33, 13
    s_lshl_b32 s19, s34, 18
    s_add_u32 s17, s17, s19
    s_add_u32 s18, s18, s17
    s_add_u32 s46, s8, s18
    s_addc_u32 s47, s9, 0
    s_mul_i32 s18, s6, 4194304
    s_add_u32 s18, s18, 25165824
    s_lshl_b32 s17, s33, 11
    s_lshl_b32 s19, s34, 16
    s_add_u32 s17, s17, s19
    s_add_u32 s18, s18, s17
    s_add_u32 s42, s8, s18
    s_addc_u32 s43, s9, 0
    s_mul_i32 s18, s6, 4194304
    s_add_u32 s18, s18, 33554432
    s_lshl_b32 s17, s33, 11
    s_lshl_b32 s19, s34, 16
    s_add_u32 s17, s17, s19
    s_add_u32 s18, s18, s17
    s_add_u32 s44, s8, s18
    s_addc_u32 s45, s9, 0
    v_mov_b32 v243, 4286578688
    v_mov_b32 v244, 0
    v_cmp_gt_u32 vcc, 2, v242
    s_nop 1
    v_cndmask_b32 v208, v243, v244, vcc
    v_lshlrev_b32 v245, 2, v242
    v_add_u32 v245, 0, v245
    v_cmp_le_u32 vcc, v245, v241
    s_nop 1
    v_cndmask_b32 v212, v243, v244, vcc
    v_mov_b32 v216, 1065369472
    v_cmp_gt_u32 vcc, 2, v242
    s_nop 1
    v_cndmask_b32 v209, v243, v244, vcc
    v_lshlrev_b32 v245, 2, v242
    v_add_u32 v245, 1, v245
    v_cmp_le_u32 vcc, v245, v241
    s_nop 1
    v_cndmask_b32 v213, v243, v244, vcc
    v_mov_b32 v217, 1065369472
    v_cmp_gt_u32 vcc, 2, v242
    s_nop 1
    v_cndmask_b32 v210, v243, v244, vcc
    v_lshlrev_b32 v245, 2, v242
    v_add_u32 v245, 2, v245
    v_cmp_le_u32 vcc, v245, v241
    s_nop 1
    v_cndmask_b32 v214, v243, v244, vcc
    v_mov_b32 v218, 1065369472
    v_cmp_gt_u32 vcc, 2, v242
    s_nop 1
    v_cndmask_b32 v211, v243, v244, vcc
    v_lshlrev_b32 v245, 2, v242
    v_add_u32 v245, 3, v245
    v_cmp_le_u32 vcc, v245, v241
    s_nop 1
    v_cndmask_b32 v215, v243, v244, vcc
    v_mov_b32 v219, 1065369472
    s_load_dwordx2 s[30:31], s[0:1], 88
    s_mov_b32 s14, 1
    s_mov_b32 s7, 0
    v_mov_b32 v243, 248
    s_waitcnt lgkmcnt(0)
    s_mov_b32 s16, 0
Lp_277:
    global_load_dword v244, v243, s[30:31] sc1
    s_add_u32 s16, s16, 1
    s_cmp_gt_u32 s16, 262144
    s_cbranch_scc1 Lwito_275
    s_waitcnt vmcnt(0)
    v_cmp_gt_u32 vcc, s14, v244
    s_cbranch_vccnz Lp_277
    s_branch Lwisk_276
Lwito_275:
    s_load_dwordx2 s[30:31], s[0:1], 88
    s_waitcnt lgkmcnt(0)
    s_mov_b64 exec, 1
    v_mov_b32 v2, 176
    v_mov_b32 v3, s7
    v_add_u32 v3, 0x10000, v3
    global_store_dword v2, v3, s[30:31] sc1
    s_waitcnt vmcnt(0)
    s_endpgm
Lwisk_276:
    s_mov_b32 s7, s34
LitT4_274:
    s_add_u32 s14, s7, 1
    s_mov_b32 s16, 0
Lp_278:
    global_load_dword v3, v7, s[12:13] sc1
    s_add_u32 s16, s16, 1
    s_cmp_gt_u32 s16, 262144
    s_cbranch_scc1 LtoT4_273
    s_waitcnt vmcnt(0)
    v_cmp_gt_u32 vcc, s14, v3
    s_cbranch_vccnz Lp_278
    global_load_dwordx4 v[16:19], v4, s[36:37] offset:0 sc1
    global_load_dwordx4 v[32:35], v4, s[36:37] offset:256 sc1
    global_load_dwordx4 v[48:51], v4, s[38:39] offset:0 sc1
    global_load_dwordx4 v[64:67], v4, s[38:39] offset:256 sc1
    global_load_dwordx4 v[20:23], v4, s[36:37] offset:2048 sc1
    global_load_dwordx4 v[36:39], v4, s[36:37] offset:2304 sc1
    global_load_dwordx4 v[52:55], v4, s[38:39] offset:2048 sc1
    global_load_dwordx4 v[68:71], v4, s[38:39] offset:2304 sc1
    global_load_dwordx4 v[24:27], v5, s[36:37] offset:0 sc1
    global_load_dwordx4 v[40:43], v5, s[36:37] offset:256 sc1
    global_load_dwordx4 v[56:59], v5, s[38:39] offset:0 sc1
    global_load_dwordx4 v[72:75], v5, s[38:39] offset:256 sc1
    global_load_dwordx4 v[28:31], v5, s[36:37] offset:2048 sc1
    global_load_dwordx4 v[44:47], v5, s[36:37] offset:2304 sc1
    global_load_dwordx4 v[60:63], v5, s[38:39] offset:2048 sc1
    global_load_dwordx4 v[76:79], v5, s[38:39] offset:2304 sc1
    global_load_dwordx4 v[96:99], v4, s[40:41] offset:0 sc1
    global_load_dwordx4 v[100:103], v4, s[40:41] offset:256 sc1
    global_load_dwordx4 v[104:107], v4, s[40:41] offset:2048 sc1
    global_load_dwordx4 v[108:111], v4, s[40:41] offset:2304 sc1
    global_load_dwordx4 v[112:115], v5, s[40:41] offset:0 sc1
    global_load_dwordx4 v[116:119], v5, s[40:41] offset:256 sc1
    global_load_dwordx4 v[120:123], v5, s[40:41] offset:2048 sc1
    global_load_dwordx4 v[124:127], v5, s[40:41] offset:2304 sc1
    s_add_u32 s36, s36, 524288
    s_addc_u32 s37, s37, 0
    s_add_u32 s38, s38, 524288
    s_addc_u32 s39, s39, 0
    s_add_u32 s40, s40, 524288
    s_addc_u32 s41, s41, 0
    s_mov_b32 s16, 0
Lp_279:
    global_load_dword v3, v2, s[12:13] sc1
    s_add_u32 s16, s16, 1
    s_cmp_gt_u32 s16, 262144
    s_cbranch_scc1 LtoT4_273
    s_waitcnt vmcnt(0)
    v_cmp_gt_u32 vcc, s14, v3
    s_cbranch_vccnz Lp_279
    s_mov_b32 m0, s28
    s_nop 0
    global_load_lds_dwordx4 v0, s[42:43] sc1
    global_load_lds_dwordx4 v0, s[42:43] offset:1024 sc1
    global_load_dwordx2 v[128:129], v8, s[44:45] offset:0 sc1
    global_load_dwordx2 v[130:131], v8, s[44:45] offset:256 sc1
    global_load_dwordx2 v[132:133], v8, s[44:45] offset:512 sc1
    global_load_dwordx2 v[134:135], v8, s[44:45] offset:768 sc1
    global_load_dwordx2 v[136:137], v8, s[44:45] offset:1024 sc1
    global_load_dwordx2 v[138:139], v8, s[44:45] offset:1280 sc1
    global_load_dwordx2 v[140:141], v8, s[44:45] offset:1536 sc1
    global_load_dwordx2 v[142:143], v8, s[44:45] offset:1792 sc1
    s_add_u32 s42, s42, 131072
    s_addc_u32 s43, s43, 0
    s_add_u32 s44, s44, 131072
    s_addc_u32 s45, s45, 0
    s_waitcnt vmcnt(8)
    ds_read_b64_tr_b16 v[80:81], v6 offset:0
    ds_read_b64_tr_b16 v[82:83], v6 offset:64
    ds_read_b64_tr_b16 v[84:85], v6 offset:512
    ds_read_b64_tr_b16 v[86:87], v6 offset:576
    ds_read_b64_tr_b16 v[88:89], v6 offset:1024
    ds_read_b64_tr_b16 v[90:91], v6 offset:1088
    ds_read_b64_tr_b16 v[92:93], v6 offset:1536
    ds_read_b64_tr_b16 v[94:95], v6 offset:1600
    s_waitcnt lgkmcnt(0)
    v_mfma_f32_16x16x32_bf16 v[144:147], v[80:83], v[16:19], 0
    v_mfma_f32_16x16x32_bf16 v[148:151], v[48:51], v[16:19], 0
    v_mfma_f32_16x16x32_bf16 v[144:147], v[84:87], v[20:23], v[144:147]
    v_mfma_f32_16x16x32_bf16 v[148:151], v[52:55], v[20:23], v[148:151]
    v_mfma_f32_16x16x32_bf16 v[144:147], v[88:91], v[24:27], v[144:147]
    v_mfma_f32_16x16x32_bf16 v[148:151], v[56:59], v[24:27], v[148:151]
    v_mfma_f32_16x16x32_bf16 v[144:147], v[92:95], v[28:31], v[144:147]
    v_mfma_f32_16x16x32_bf16 v[148:151], v[60:63], v[28:31], v[148:151]
    s_nop 7
    v_fma_f32 v144, v144, s35, v208
    v_fma_f32 v145, v145, s35, v209
    v_fma_f32 v146, v146, s35, v210
    v_fma_f32 v147, v147, s35, v211
    v_fma_f32 v148, v148, s35, v212
    v_fma_f32 v149, v149, s35, v213
    v_fma_f32 v150, v150, s35, v214
    v_fma_f32 v151, v151, s35, v215
    v_max3_f32 v168, v144, v145, v146
    v_max3_f32 v168, v168, v147, v148
    v_max3_f32 v168, v168, v149, v150
    v_max_f32 v168, v168, v151
    v_mov_b32 v169, v168
    s_nop 1
    v_permlane32_swap_b32 v168, v169
    v_max_f32 v168, v168, v169
    v_mov_b32 v169, v168
    s_nop 1
    v_permlane16_swap_b32 v168, v169
    v_max_f32 v168, v168, v169
    v_sub_f32 v144, v144, v168
    v_sub_f32 v145, v145, v168
    v_sub_f32 v146, v146, v168
    v_sub_f32 v147, v147, v168
    v_sub_f32 v148, v148, v168
    v_sub_f32 v149, v149, v168
    v_sub_f32 v150, v150, v168
    v_sub_f32 v151, v151, v168
    v_exp_f32 v144, v144
    v_exp_f32 v145, v145
    v_exp_f32 v146, v146
    v_exp_f32 v147, v147
    v_exp_f32 v148, v148
    v_exp_f32 v149, v149
    v_exp_f32 v150, v150
    v_exp_f32 v151, v151
    s_nop 0
    v_cvt_pk_bf16_f32 v160, v144, v145
    v_cvt_pk_bf16_f32 v161, v146, v147
    v_cvt_pk_bf16_f32 v156, v148, v149
    v_cvt_pk_bf16_f32 v157, v150, v151
    s_waitcnt vmcnt(0)
    s_nop 1
    v_mfma_f32_16x16x16_bf16 v[164:167], v[216:217], v[156:157], 0
    v_mfma_f32_16x16x16_bf16 v[172:175], v[96:97], v[156:157], 0
    v_mfma_f32_16x16x16_bf16 v[176:179], v[100:101], v[156:157], 0
    v_mfma_f32_16x16x16_bf16 v[180:183], v[104:105], v[156:157], 0
    v_mfma_f32_16x16x16_bf16 v[184:187], v[108:109], v[156:157], 0
    v_mfma_f32_16x16x16_bf16 v[188:191], v[112:113], v[156:157], 0
    v_mfma_f32_16x16x16_bf16 v[192:195], v[116:117], v[156:157], 0
    v_mfma_f32_16x16x16_bf16 v[196:199], v[120:121], v[156:157], 0
    v_mfma_f32_16x16x16_bf16 v[200:203], v[124:125], v[156:157], 0
    v_mfma_f32_16x16x16_bf16 v[164:167], v[216:217], v[160:161], v[164:167]
    v_mfma_f32_16x16x16_bf16 v[172:175], v[128:129], v[160:161], v[172:175]
    v_mfma_f32_16x16x16_bf16 v[176:179], v[130:131], v[160:161], v[176:179]
    v_mfma_f32_16x16x16_bf16 v[180:183], v[132:133], v[160:161], v[180:183]
    v_mfma_f32_16x16x16_bf16 v[184:187], v[134:135], v[160:161], v[184:187]
    v_mfma_f32_16x16x16_bf16 v[188:191], v[136:137], v[160:161], v[188:191]
    v_mfma_f32_16x16x16_bf16 v[192:195], v[138:139], v[160:161], v[192:195]
    v_mfma_f32_16x16x16_bf16 v[196:199], v[140:141], v[160:161], v[196:199]
    v_mfma_f32_16x16x16_bf16 v[200:203], v[142:143], v[160:161], v[200:203]
    v_rcp_f32 v164, v164
    s_nop 7
    v_mul_f32 v172, v172, v164
    v_mul_f32 v173, v173, v164
    v_mul_f32 v174, v174, v164
    v_mul_f32 v175, v175, v164
    v_mul_f32 v176, v176, v164
    v_mul_f32 v177, v177, v164
    v_mul_f32 v178, v178, v164
    v_mul_f32 v179, v179, v164
    v_cvt_pk_bf16_f32 v172, v172, v173
    v_cvt_pk_bf16_f32 v173, v174, v175
    v_cvt_pk_bf16_f32 v174, v176, v177
    v_cvt_pk_bf16_f32 v175, v178, v179
    global_store_dwordx4 v4, v[172:175], s[46:47] offset:0 sc1
    v_mul_f32 v180, v180, v164
    v_mul_f32 v181, v181, v164
    v_mul_f32 v182, v182, v164
    v_mul_f32 v183, v183, v164
    v_mul_f32 v184, v184, v164
    v_mul_f32 v185, v185, v164
    v_mul_f32 v186, v186, v164
    v_mul_f32 v187, v187, v164
    v_cvt_pk_bf16_f32 v180, v180, v181
    v_cvt_pk_bf16_f32 v181, v182, v183
    v_cvt_pk_bf16_f32 v182, v184, v185
    v_cvt_pk_bf16_f32 v183, v186, v187
    global_store_dwordx4 v4, v[180:183], s[46:47] offset:2048 sc1
    v_mul_f32 v188, v188, v164
    v_mul_f32 v189, v189, v164
    v_mul_f32 v190, v190, v164
    v_mul_f32 v191, v191, v164
    v_mul_f32 v192, v192, v164
    v_mul_f32 v193, v193, v164
    v_mul_f32 v194, v194, v164
    v_mul_f32 v195, v195, v164
    v_cvt_pk_bf16_f32 v188, v188, v189
    v_cvt_pk_bf16_f32 v189, v190, v191
    v_cvt_pk_bf16_f32 v190, v192, v193
    v_cvt_pk_bf16_f32 v191, v194, v195
    global_store_dwordx4 v5, v[188:191], s[46:47] offset:0 sc1
    v_mul_f32 v196, v196, v164
    v_mul_f32 v197, v197, v164
    v_mul_f32 v198, v198, v164
    v_mul_f32 v199, v199, v164
    v_mul_f32 v200, v200, v164
    v_mul_f32 v201, v201, v164
    v_mul_f32 v202, v202, v164
    v_mul_f32 v203, v203, v164
    v_cvt_pk_bf16_f32 v196, v196, v197
    v_cvt_pk_bf16_f32 v197, v198, v199
    v_cvt_pk_bf16_f32 v198, v200, v201
    v_cvt_pk_bf16_f32 v199, v202, v203
    global_store_dwordx4 v5, v[196:199], s[46:47] offset:2048 sc1
    s_nop 1
    v_mfma_f32_16x16x32_bf16 v[144:147], v[80:83], v[32:35], 0
    v_mfma_f32_16x16x32_bf16 v[148:151], v[48:51], v[32:35], 0
    v_mfma_f32_16x16x32_bf16 v[152:155], v[64:67], v[32:35], 0
    v_mfma_f32_16x16x32_bf16 v[144:147], v[84:87], v[36:39], v[144:147]
    v_mfma_f32_16x16x32_bf16 v[148:151], v[52:55], v[36:39], v[148:151]
    v_mfma_f32_16x16x32_bf16 v[152:155], v[68:71], v[36:39], v[152:155]
    v_mfma_f32_16x16x32_bf16 v[144:147], v[88:91], v[40:43], v[144:147]
    v_mfma_f32_16x16x32_bf16 v[148:151], v[56:59], v[40:43], v[148:151]
    v_mfma_f32_16x16x32_bf16 v[152:155], v[72:75], v[40:43], v[152:155]
    v_mfma_f32_16x16x32_bf16 v[144:147], v[92:95], v[44:47], v[144:147]
    v_mfma_f32_16x16x32_bf16 v[148:151], v[60:63], v[44:47], v[148:151]
    v_mfma_f32_16x16x32_bf16 v[152:155], v[76:79], v[44:47], v[152:155]
    s_nop 7
    v_fma_f32 v144, v144, s35, v208
    v_fma_f32 v145, v145, s35, v209
    v_fma_f32 v146, v146, s35, v210
    v_fma_f32 v147, v147, s35, v211
    v_mul_f32 v148, s35, v148
    v_mul_f32 v149, s35, v149
    v_mul_f32 v150, s35, v150
    v_mul_f32 v151, s35, v151
    v_fma_f32 v152, v152, s35, v212
    v_fma_f32 v153, v153, s35, v213
    v_fma_f32 v154, v154, s35, v214
    v_fma_f32 v155, v155, s35, v215
    v_max3_f32 v168, v144, v145, v146
    v_max3_f32 v168, v168, v147, v148
    v_max3_f32 v168, v168, v149, v150
    v_max3_f32 v168, v168, v151, v152
    v_max3_f32 v168, v168, v153, v154
    v_max_f32 v168, v168, v155
    v_mov_b32 v169, v168
    s_nop 1
    v_permlane32_swap_b32 v168, v169
    v_max_f32 v168, v168, v169
    v_mov_b32 v169, v168
    s_nop 1
    v_permlane16_swap_b32 v168, v169
    v_max_f32 v168, v168, v169
    v_sub_f32 v144, v144, v168
    v_sub_f32 v145, v145, v168
    v_sub_f32 v146, v146, v168
    v_sub_f32 v147, v147, v168
    v_sub_f32 v148, v148, v168
    v_sub_f32 v149, v149, v168
    v_sub_f32 v150, v150, v168
    v_sub_f32 v151, v151, v168
    v_sub_f32 v152, v152, v168
    v_sub_f32 v153, v153, v168
    v_sub_f32 v154, v154, v168
    v_sub_f32 v155, v155, v168
    v_exp_f32 v144, v144
    v_exp_f32 v145, v145
    v_exp_f32 v146, v146
    v_exp_f32 v147, v147
    v_exp_f32 v148, v148
    v_exp_f32 v149, v149
    v_exp_f32 v150, v150
    v_exp_f32 v151, v151
    v_exp_f32 v152, v152
    v_exp_f32 v153, v153
    v_exp_f32 v154, v154
    v_exp_f32 v155, v155
    s_nop 0
    v_cvt_pk_bf16_f32 v160, v144, v145
    v_cvt_pk_bf16_f32 v161, v146, v147
    v_cvt_pk_bf16_f32 v156, v148, v149
    v_cvt_pk_bf16_f32 v157, v150, v151
    v_cvt_pk_bf16_f32 v158, v152, v153
    v_cvt_pk_bf16_f32 v159, v154, v155
    s_nop 1
    v_mfma_f32_16x16x32_bf16 v[164:167], v[216:219], v[156:159], 0
    v_mfma_f32_16x16x32_bf16 v[172:175], v[96:99], v[156:159], 0
    v_mfma_f32_16x16x32_bf16 v[176:179], v[100:103], v[156:159], 0
    v_mfma_f32_16x16x32_bf16 v[180:183], v[104:107], v[156:159], 0
    v_mfma_f32_16x16x32_bf16 v[184:187], v[108:111], v[156:159], 0
    v_mfma_f32_16x16x32_bf16 v[188:191], v[112:115], v[156:159], 0
    v_mfma_f32_16x16x32_bf16 v[192:195], v[116:119], v[156:159], 0
    v_mfma_f32_16x16x32_bf16 v[196:199], v[120:123], v[156:159], 0
    v_mfma_f32_16x16x32_bf16 v[200:203], v[124:127], v[156:159], 0
    v_mfma_f32_16x16x16_bf16 v[164:167], v[216:217], v[160:161], v[164:167]
    v_mfma_f32_16x16x16_bf16 v[172:175], v[128:129], v[160:161], v[172:175]
    v_mfma_f32_16x16x16_bf16 v[176:179], v[130:131], v[160:161], v[176:179]
    v_mfma_f32_16x16x16_bf16 v[180:183], v[132:133], v[160:161], v[180:183]
    v_mfma_f32_16x16x16_bf16 v[184:187], v[134:135], v[160:161], v[184:187]
    v_mfma_f32_16x16x16_bf16 v[188:191], v[136:137], v[160:161], v[188:191]
    v_mfma_f32_16x16x16_bf16 v[192:195], v[138:139], v[160:161], v[192:195]
    v_mfma_f32_16x16x16_bf16 v[196:199], v[140:141], v[160:161], v[196:199]
    v_mfma_f32_16x16x16_bf16 v[200:203], v[142:143], v[160:161], v[200:203]
    v_rcp_f32 v164, v164
    s_nop 7
    v_mul_f32 v172, v172, v164
    v_mul_f32 v173, v173, v164
    v_mul_f32 v174, v174, v164
    v_mul_f32 v175, v175, v164
    v_mul_f32 v176, v176, v164
    v_mul_f32 v177, v177, v164
    v_mul_f32 v178, v178, v164
    v_mul_f32 v179, v179, v164
    v_cvt_pk_bf16_f32 v172, v172, v173
    v_cvt_pk_bf16_f32 v173, v174, v175
    v_cvt_pk_bf16_f32 v174, v176, v177
    v_cvt_pk_bf16_f32 v175, v178, v179
    global_store_dwordx4 v4, v[172:175], s[46:47] offset:256 sc1
    v_mul_f32 v180, v180, v164
    v_mul_f32 v181, v181, v164
    v_mul_f32 v182, v182, v164
    v_mul_f32 v183, v183, v164
    v_mul_f32 v184, v184, v164
    v_mul_f32 v185, v185, v164
    v_mul_f32 v186, v186, v164
    v_mul_f32 v187, v187, v164
    v_cvt_pk_bf16_f32 v180, v180, v181
    v_cvt_pk_bf16_f32 v181, v182, v183
    v_cvt_pk_bf16_f32 v182, v184, v185
    v_cvt_pk_bf16_f32 v183, v186, v187
    global_store_dwordx4 v4, v[180:183], s[46:47] offset:2304 sc1
    v_mul_f32 v188, v188, v164
    v_mul_f32 v189, v189, v164
    v_mul_f32 v190, v190, v164
    v_mul_f32 v191, v191, v164
    v_mul_f32 v192, v192, v164
    v_mul_f32 v193, v193, v164
    v_mul_f32 v194, v194, v164
    v_mul_f32 v195, v195, v164
    v_cvt_pk_bf16_f32 v188, v188, v189
    v_cvt_pk_bf16_f32 v189, v190, v191
    v_cvt_pk_bf16_f32 v190, v192, v193
    v_cvt_pk_bf16_f32 v191, v194, v195
    global_store_dwordx4 v5, v[188:191], s[46:47] offset:256 sc1
    v_mul_f32 v196, v196, v164
    v_mul_f32 v197, v197, v164
    v_mul_f32 v198, v198, v164
    v_mul_f32 v199, v199, v164
    v_mul_f32 v200, v200, v164
    v_mul_f32 v201, v201, v164
    v_mul_f32 v202, v202, v164
    v_mul_f32 v203, v203, v164
    v_cvt_pk_bf16_f32 v196, v196, v197
    v_cvt_pk_bf16_f32 v197, v198, v199
    v_cvt_pk_bf16_f32 v198, v200, v201
    v_cvt_pk_bf16_f32 v199, v202, v203
    global_store_dwordx4 v5, v[196:199], s[46:47] offset:2304 sc1
    s_nop 1
    s_add_u32 s46, s46, 524288
    s_addc_u32 s47, s47, 0
    s_waitcnt vmcnt(0)
    s_add_u32 s17, s7, 1
    v_mov_b32 v3, s17
    s_mov_b64 exec, 1
    global_store_dword v0, v3, s[26:27] sc1
    s_mov_b64 exec, -1
    s_add_u32 s7, s7, 2
    s_cmp_lt_u32 s7, 64
    s_cbranch_scc1 LitT4_274
    s_waitcnt vmcnt(0)
    s_endpgm
LtoT4_273:
    s_load_dwordx2 s[30:31], s[0:1], 88
    s_waitcnt lgkmcnt(0)
    s_mov_b64 exec, 1
    v_mov_b32 v2, 160
    v_mov_b32 v3, s7
    v_add_u32 v3, 0x10000, v3
    global_store_dword v2, v3, s[30:31] sc1
    s_waitcnt vmcnt(0)
    s_endpgm
ROLE_T6:
    s_lshr_b32 s33, s4, 1
    s_and_b32 s34, s4, 1
    v_and_b32 v240, 63, v0
    v_and_b32 v241, 15, v240
    v_lshrrev_b32 v242, 4, v240
    s_lshl_b32 s17, s5, 2
    v_add_u32 v243, s17, v242
    s_lshl_b32 s17, s34, 4
    v_add_u32 v244, s17, v241
    v_lshlrev_b32 v0, 4, v240
    v_lshlrev_b32 v4, 12, v243
    v_lshl_add_u32 v4, v244, 4, v4
    v_lshlrev_b32 v5, 11, v243
    v_lshl_add_u32 v5, v244, 4, v5
    v_lshlrev_b32 v6, 10, v244
    v_lshl_add_u32 v6, v243, 6, v6
    s_lshl_b32 s17, s5, 7
    v_lshlrev_b32 v8, 3, v241
    v_add_u32 v7, s17, v8
    s_mul_i32 s17, s6, 1024
    s_add_u32 s17, s17, 12288
    v_and_b32 v2, 3, v240
    v_lshlrev_b32 v2, 2, v2
    v_lshrrev_b32 v245, 2, v240
    v_lshl_add_u32 v2, v245, 6, v2
    v_add_u32 v2, s17, v2
    s_mov_b32 s12, s8
    s_mov_b32 s13, s9
    s_mul_i32 s18, s6, 256
    s_add_u32 s18, s18, 19456
    s_lshl_b32 s17, s4, 6
    s_add_u32 s18, s18, s17
    s_add_u32 s26, s8, s18
    s_addc_u32 s27, s9, 0
    s_mul_i32 s18, s6, 16777216
    s_add_u32 s18, s18, 184549376
    s_lshl_b32 s17, s33, 17
    s_add_u32 s17, s17, 0
    s_add_u32 s18, s18, s17
    s_add_u32 s36, s8, s18
    s_addc_u32 s37, s9, 0
    s_mul_i32 s18, s6, 16777216
    s_add_u32 s18, s18, 184549376
    s_lshl_b32 s17, s33, 17
    s_add_u32 s17, s17, 32768
    s_add_u32 s18, s18, s17
    s_add_u32 s38, s8, s18
    s_addc_u32 s39, s9, 0
    s_mul_i32 s18, s6, 16777216
    s_add_u32 s18, s18, 184549376
    s_lshl_b32 s17, s33, 17
    s_add_u32 s17, s17, 65536
    s_add_u32 s18, s18, s17
    s_add_u32 s40, s8, s18
    s_addc_u32 s41, s9, 0
    s_mul_i32 s18, s6, 16777216
    s_add_u32 s18, s18, 184549376
    s_lshl_b32 s17, s33, 17
    s_add_u32 s17, s17, 98304
    s_add_u32 s18, s18, s17
    s_add_u32 s42, s8, s18
    s_addc_u32 s43, s9, 0
    s_mul_i32 s18, s6, 2097152
    s_add_u32 s18, s18, 16777216
    s_lshl_b32 s17, s33, 15
    s_add_u32 s18, s18, s17
    s_add_u32 s44, s8, s18
    s_addc_u32 s45, s9, 0
    s_mul_i32 s18, s6, 0
    s_add_u32 s18, s18, 6291456
    s_lshl_b32 s17, s33, 15
    s_add_u32 s18, s18, s17
    s_add_u32 s46, s8, s18
    s_addc_u32 s47, s9, 0
    s_mul_i32 s18, s6, 0
    s_add_u32 s18, s18, 10485760
    s_lshl_b32 s17, s33, 15
    s_add_u32 s18, s18, s17
    s_add_u32 s48, s8, s18
    s_addc_u32 s49, s9, 0
    s_load_dwordx2 s[50:51], s[0:1], 80
    s_lshl_b32 s17, s33, 15
    s_waitcnt lgkmcnt(0)
    s_add_u32 s50, s50, s17
    s_addc_u32 s51, s51, 0
    s_load_dwordx2 s[30:31], s[0:1], 88
    s_mov_b32 s14, 1
    s_mov_b32 s7, 0
    v_mov_b32 v245, 248
    s_waitcnt lgkmcnt(0)
    s_mov_b32 s16, 0
Lp_284:
    global_load_dword v246, v245, s[30:31] sc1
    s_add_u32 s16, s16, 1
    s_cmp_gt_u32 s16, 262144
    s_cbranch_scc1 Lwito_282
    s_waitcnt vmcnt(0)
    v_cmp_gt_u32 vcc, s14, v246
    s_cbranch_vccnz Lp_284
    s_branch Lwisk_283
Lwito_282:
    s_load_dwordx2 s[30:31], s[0:1], 88
    s_waitcnt lgkmcnt(0)
    s_mov_b64 exec, 1
    v_mov_b32 v2, 176
    v_mov_b32 v3, s7
    v_add_u32 v3, 0x10000, v3
    global_store_dword v2, v3, s[30:31] sc1
    s_waitcnt vmcnt(0)
    s_endpgm
Lwisk_283:
    s_mov_b32 s7, s33
LitT6_281:
    s_add_u32 s14, s7, 1
    s_mov_b32 s16, 0
Lp_285:
    global_load_dword v3, v2, s[12:13] sc1
    s_add_u32 s16, s16, 1
    s_cmp_gt_u32 s16, 262144
    s_cbranch_scc1 LtoT6_280
    s_waitcnt vmcnt(0)
    v_cmp_gt_u32 vcc, s14, v3
    s_cbranch_vccnz Lp_285
    global_load_dwordx4 v[144:147], v5, s[44:45] offset:0 sc1
    global_load_dwordx4 v[148:151], v5, s[44:45] offset:512 sc1
    global_load_dwordx4 v[152:155], v5, s[44:45] offset:1024 sc1
    global_load_dwordx4 v[156:159], v5, s[44:45] offset:1536 sc1
    global_load_dwordx4 v[16:19], v5, s[36:37] offset:0 sc1
    global_load_dwordx4 v[20:23], v5, s[36:37] offset:512 sc1
    global_load_dwordx4 v[24:27], v5, s[36:37] offset:1024 sc1
    global_load_dwordx4 v[28:31], v5, s[36:37] offset:1536 sc1
    s_add_u32 s36, s36, 262144
    s_addc_u32 s37, s37, 0
    global_load_dwordx4 v[32:35], v5, s[38:39] offset:0 sc1
    global_load_dwordx4 v[36:39], v5, s[38:39] offset:512 sc1
    global_load_dwordx4 v[40:43], v5, s[38:39] offset:1024 sc1
    global_load_dwordx4 v[44:47], v5, s[38:39] offset:1536 sc1
    s_add_u32 s38, s38, 262144
    s_addc_u32 s39, s39, 0
    global_load_dwordx4 v[48:51], v5, s[40:41] offset:0 sc1
    global_load_dwordx4 v[52:55], v5, s[40:41] offset:512 sc1
    global_load_dwordx4 v[56:59], v5, s[40:41] offset:1024 sc1
    global_load_dwordx4 v[60:63], v5, s[40:41] offset:1536 sc1
    s_add_u32 s40, s40, 262144
    s_addc_u32 s41, s41, 0
    global_load_dwordx4 v[64:67], v5, s[42:43] offset:0 sc1
    global_load_dwordx4 v[68:71], v5, s[42:43] offset:512 sc1
    global_load_dwordx4 v[72:75], v5, s[42:43] offset:1024 sc1
    global_load_dwordx4 v[76:79], v5, s[42:43] offset:1536 sc1
    s_add_u32 s42, s42, 262144
    s_addc_u32 s43, s43, 0
    s_add_u32 s44, s44, 65536
    s_addc_u32 s45, s45, 0
    s_mov_b32 s17, 0x00003f80
    s_mov_b32 s18, 0x3f800000
    s_waitcnt vmcnt(16)
    v_dot2_f32_bf16 v96, v144, s17, 0
    v_dot2_f32_bf16 v97, v144, s18, 0
    v_dot2_f32_bf16 v98, v145, s17, 0
    v_dot2_f32_bf16 v99, v145, s18, 0
    v_dot2_f32_bf16 v100, v146, s17, 0
    v_dot2_f32_bf16 v101, v146, s18, 0
    v_dot2_f32_bf16 v102, v147, s17, 0
    v_dot2_f32_bf16 v103, v147, s18, 0
    v_dot2_f32_bf16 v104, v148, s17, 0
    v_dot2_f32_bf16 v105, v148, s18, 0
    v_dot2_f32_bf16 v106, v149, s17, 0
    v_dot2_f32_bf16 v107, v149, s18, 0
    v_dot2_f32_bf16 v108, v150, s17, 0
    v_dot2_f32_bf16 v109, v150, s18, 0
    v_dot2_f32_bf16 v110, v151, s17, 0
    v_dot2_f32_bf16 v111, v151, s18, 0
    v_dot2_f32_bf16 v112, v152, s17, 0
    v_dot2_f32_bf16 v113, v152, s18, 0
    v_dot2_f32_bf16 v114, v153, s17, 0
    v_dot2_f32_bf16 v115, v153, s18, 0
    v_dot2_f32_bf16 v116, v154, s17, 0
    v_dot2_f32_bf16 v117, v154, s18, 0
    v_dot2_f32_bf16 v118, v155, s17, 0
    v_dot2_f32_bf16 v119, v155, s18, 0
    v_dot2_f32_bf16 v120, v156, s17, 0
    v_dot2_f32_bf16 v121, v156, s18, 0
    v_dot2_f32_bf16 v122, v157, s17, 0
    v_dot2_f32_bf16 v123, v157, s18, 0
    v_dot2_f32_bf16 v124, v158, s17, 0
    v_dot2_f32_bf16 v125, v158, s18, 0
    v_dot2_f32_bf16 v126, v159, s17, 0
    v_dot2_f32_bf16 v127, v159, s18, 0
    s_waitcnt vmcnt(12)
    v_dot2_f32_bf16 v96, v16, s17, v96
    v_dot2_f32_bf16 v97, v16, s18, v97
    v_dot2_f32_bf16 v98, v17, s17, v98
    v_dot2_f32_bf16 v99, v17, s18, v99
    v_dot2_f32_bf16 v100, v18, s17, v100
    v_dot2_f32_bf16 v101, v18, s18, v101
    v_dot2_f32_bf16 v102, v19, s17, v102
    v_dot2_f32_bf16 v103, v19, s18, v103
    v_dot2_f32_bf16 v104, v20, s17, v104
    v_dot2_f32_bf16 v105, v20, s18, v105
    v_dot2_f32_bf16 v106, v21, s17, v106
    v_dot2_f32_bf16 v107, v21, s18, v107
    v_dot2_f32_bf16 v108, v22, s17, v108
    v_dot2_f32_bf16 v109, v22, s18, v109
    v_dot2_f32_bf16 v110, v23, s17, v110
    v_dot2_f32_bf16 v111, v23, s18, v111
    v_dot2_f32_bf16 v112, v24, s17, v112
    v_dot2_f32_bf16 v113, v24, s18, v113
    v_dot2_f32_bf16 v114, v25, s17, v114
    v_dot2_f32_bf16 v115, v25, s18, v115
    v_dot2_f32_bf16 v116, v26, s17, v116
    v_dot2_f32_bf16 v117, v26, s18, v117
    v_dot2_f32_bf16 v118, v27, s17, v118
    v_dot2_f32_bf16 v119, v27, s18, v119
    v_dot2_f32_bf16 v120, v28, s17, v120
    v_dot2_f32_bf16 v121, v28, s18, v121
    v_dot2_f32_bf16 v122, v29, s17, v122
    v_dot2_f32_bf16 v123, v29, s18, v123
    v_dot2_f32_bf16 v124, v30, s17, v124
    v_dot2_f32_bf16 v125, v30, s18, v125
    v_dot2_f32_bf16 v126, v31, s17, v126
    v_dot2_f32_bf16 v127, v31, s18, v127
    s_waitcnt vmcnt(8)
    v_dot2_f32_bf16 v96, v32, s17, v96
    v_dot2_f32_bf16 v97, v32, s18, v97
    v_dot2_f32_bf16 v98, v33, s17, v98
    v_dot2_f32_bf16 v99, v33, s18, v99
    v_dot2_f32_bf16 v100, v34, s17, v100
    v_dot2_f32_bf16 v101, v34, s18, v101
    v_dot2_f32_bf16 v102, v35, s17, v102
    v_dot2_f32_bf16 v103, v35, s18, v103
    v_dot2_f32_bf16 v104, v36, s17, v104
    v_dot2_f32_bf16 v105, v36, s18, v105
    v_dot2_f32_bf16 v106, v37, s17, v106
    v_dot2_f32_bf16 v107, v37, s18, v107
    v_dot2_f32_bf16 v108, v38, s17, v108
    v_dot2_f32_bf16 v109, v38, s18, v109
    v_dot2_f32_bf16 v110, v39, s17, v110
    v_dot2_f32_bf16 v111, v39, s18, v111
    v_dot2_f32_bf16 v112, v40, s17, v112
    v_dot2_f32_bf16 v113, v40, s18, v113
    v_dot2_f32_bf16 v114, v41, s17, v114
    v_dot2_f32_bf16 v115, v41, s18, v115
    v_dot2_f32_bf16 v116, v42, s17, v116
    v_dot2_f32_bf16 v117, v42, s18, v117
    v_dot2_f32_bf16 v118, v43, s17, v118
    v_dot2_f32_bf16 v119, v43, s18, v119
    v_dot2_f32_bf16 v120, v44, s17, v120
    v_dot2_f32_bf16 v121, v44, s18, v121
    v_dot2_f32_bf16 v122, v45, s17, v122
    v_dot2_f32_bf16 v123, v45, s18, v123
    v_dot2_f32_bf16 v124, v46, s17, v124
    v_dot2_f32_bf16 v125, v46, s18, v125
    v_dot2_f32_bf16 v126, v47, s17, v126
    v_dot2_f32_bf16 v127, v47, s18, v127
    s_waitcnt vmcnt(4)
    v_dot2_f32_bf16 v96, v48, s17, v96
    v_dot2_f32_bf16 v97, v48, s18, v97
    v_dot2_f32_bf16 v98, v49, s17, v98
    v_dot2_f32_bf16 v99, v49, s18, v99
    v_dot2_f32_bf16 v100, v50, s17, v100
    v_dot2_f32_bf16 v101, v50, s18, v101
    v_dot2_f32_bf16 v102, v51, s17, v102
    v_dot2_f32_bf16 v103, v51, s18, v103
    v_dot2_f32_bf16 v104, v52, s17, v104
    v_dot2_f32_bf16 v105, v52, s18, v105
    v_dot2_f32_bf16 v106, v53, s17, v106
    v_dot2_f32_bf16 v107, v53, s18, v107
    v_dot2_f32_bf16 v108, v54, s17, v108
    v_dot2_f32_bf16 v109, v54, s18, v109
    v_dot2_f32_bf16 v110, v55, s17, v110
    v_dot2_f32_bf16 v111, v55, s18, v111
    v_dot2_f32_bf16 v112, v56, s17, v112
    v_dot2_f32_bf16 v113, v56, s18, v113
    v_dot2_f32_bf16 v114, v57, s17, v114
    v_dot2_f32_bf16 v115, v57, s18, v115
    v_dot2_f32_bf16 v116, v58, s17, v116
    v_dot2_f32_bf16 v117, v58, s18, v117
    v_dot2_f32_bf16 v118, v59, s17, v118
    v_dot2_f32_bf16 v119, v59, s18, v119
    v_dot2_f32_bf16 v120, v60, s17, v120
    v_dot2_f32_bf16 v121, v60, s18, v121
    v_dot2_f32_bf16 v122, v61, s17, v122
    v_dot2_f32_bf16 v123, v61, s18, v123
    v_dot2_f32_bf16 v124, v62, s17, v124
    v_dot2_f32_bf16 v125, v62, s18, v125
    v_dot2_f32_bf16 v126, v63, s17, v126
    v_dot2_f32_bf16 v127, v63, s18, v127
    s_waitcnt vmcnt(0)
    v_dot2_f32_bf16 v96, v64, s17, v96
    v_dot2_f32_bf16 v97, v64, s18, v97
    v_dot2_f32_bf16 v98, v65, s17, v98
    v_dot2_f32_bf16 v99, v65, s18, v99
    v_dot2_f32_bf16 v100, v66, s17, v100
    v_dot2_f32_bf16 v101, v66, s18, v101
    v_dot2_f32_bf16 v102, v67, s17, v102
    v_dot2_f32_bf16 v103, v67, s18, v103
    v_dot2_f32_bf16 v104, v68, s17, v104
    v_dot2_f32_bf16 v105, v68, s18, v105
    v_dot2_f32_bf16 v106, v69, s17, v106
    v_dot2_f32_bf16 v107, v69, s18, v107
    v_dot2_f32_bf16 v108, v70, s17, v108
    v_dot2_f32_bf16 v109, v70, s18, v109
    v_dot2_f32_bf16 v110, v71, s17, v110
    v_dot2_f32_bf16 v111, v71, s18, v111
    v_dot2_f32_bf16 v112, v72, s17, v112
    v_dot2_f32_bf16 v113, v72, s18, v113
    v_dot2_f32_bf16 v114, v73, s17, v114
    v_dot2_f32_bf16 v115, v73, s18, v115
    v_dot2_f32_bf16 v116, v74, s17, v116
    v_dot2_f32_bf16 v117, v74, s18, v117
    v_dot2_f32_bf16 v118, v75, s17, v118
    v_dot2_f32_bf16 v119, v75, s18, v119
    v_dot2_f32_bf16 v120, v76, s17, v120
    v_dot2_f32_bf16 v121, v76, s18, v121
    v_dot2_f32_bf16 v122, v77, s17, v122
    v_dot2_f32_bf16 v123, v77, s18, v123
    v_dot2_f32_bf16 v124, v78, s17, v124
    v_dot2_f32_bf16 v125, v78, s18, v125
    v_dot2_f32_bf16 v126, v79, s17, v126
    v_dot2_f32_bf16 v127, v79, s18, v127
    s_nop 2
    v_cvt_pk_bf16_f32 v144, v96, v97
    v_cvt_pk_bf16_f32 v145, v98, v99
    v_cvt_pk_bf16_f32 v146, v100, v101
    v_cvt_pk_bf16_f32 v147, v102, v103
    v_cvt_pk_bf16_f32 v148, v104, v105
    v_cvt_pk_bf16_f32 v149, v106, v107
    v_cvt_pk_bf16_f32 v150, v108, v109
    v_cvt_pk_bf16_f32 v151, v110, v111
    v_cvt_pk_bf16_f32 v152, v112, v113
    v_cvt_pk_bf16_f32 v153, v114, v115
    v_cvt_pk_bf16_f32 v154, v116, v117
    v_cvt_pk_bf16_f32 v155, v118, v119
    v_cvt_pk_bf16_f32 v156, v120, v121
    v_cvt_pk_bf16_f32 v157, v122, v123
    v_cvt_pk_bf16_f32 v158, v124, v125
    v_cvt_pk_bf16_f32 v159, v126, v127
    s_cmp_lg_u32 s6, 0
    s_cbranch_scc1 Lt6o_286
    global_store_dwordx4 v5, v[144:147], s[46:47] offset:0 sc1
    global_store_dwordx4 v5, v[148:151], s[46:47] offset:512 sc1
    global_store_dwordx4 v5, v[152:155], s[46:47] offset:1024 sc1
    global_store_dwordx4 v5, v[156:159], s[46:47] offset:1536 sc1
    v_mov_b32 v176, 0
    v_mov_b32 v177, 0
    s_mov_b32 s17, 1065369472
    v_dot2_f32_bf16 v176, v144, s17, v176
    v_dot2_f32_bf16 v177, v144, v144, v177
    v_dot2_f32_bf16 v176, v145, s17, v176
    v_dot2_f32_bf16 v177, v145, v145, v177
    v_dot2_f32_bf16 v176, v146, s17, v176
    v_dot2_f32_bf16 v177, v146, v146, v177
    v_dot2_f32_bf16 v176, v147, s17, v176
    v_dot2_f32_bf16 v177, v147, v147, v177
    v_dot2_f32_bf16 v176, v148, s17, v176
    v_dot2_f32_bf16 v177, v148, v148, v177
    v_dot2_f32_bf16 v176, v149, s17, v176
    v_dot2_f32_bf16 v177, v149, v149, v177
    v_dot2_f32_bf16 v176, v150, s17, v176
    v_dot2_f32_bf16 v177, v150, v150, v177
    v_dot2_f32_bf16 v176, v151, s17, v176
    v_dot2_f32_bf16 v177, v151, v151, v177
    v_dot2_f32_bf16 v176, v152, s17, v176
    v_dot2_f32_bf16 v177, v152, v152, v177
    v_dot2_f32_bf16 v176, v153, s17, v176
    v_dot2_f32_bf16 v177, v153, v153, v177
    v_dot2_f32_bf16 v176, v154, s17, v176
    v_dot2_f32_bf16 v177, v154, v154, v177
    v_dot2_f32_bf16 v176, v155, s17, v176
    v_dot2_f32_bf16 v177, v155, v155, v177
    v_dot2_f32_bf16 v176, v156, s17, v176
    v_dot2_f32_bf16 v177, v156, v156, v177
    v_dot2_f32_bf16 v176, v157, s17, v176
    v_dot2_f32_bf16 v177, v157, v157, v177
    v_dot2_f32_bf16 v176, v158, s17, v176
    v_dot2_f32_bf16 v177, v158, v158, v177
    v_dot2_f32_bf16 v176, v159, s17, v176
    v_dot2_f32_bf16 v177, v159, v159, v177
    s_nop 2
    v_mov_b32 v178, v176
    s_nop 1
    v_permlane32_swap_b32 v176, v178
    v_add_f32 v176, v176, v178
    v_mov_b32 v178, v176
    s_nop 1
    v_permlane16_swap_b32 v176, v178
    v_add_f32 v176, v176, v178
    v_mov_b32 v178, v177
    s_nop 1
    v_permlane32_swap_b32 v177, v178
    v_add_f32 v177, v177, v178
    v_mov_b32 v178, v177
    s_nop 1
    v_permlane16_swap_b32 v177, v178
    v_add_f32 v177, v177, v178
    ds_write_b64 v7, v[176:177]
    s_waitcnt lgkmcnt(0)
    s_barrier
    ds_read_b64 v[180:181], v8 offset:0
    ds_read_b64 v[182:183], v8 offset:128
    ds_read_b64 v[184:185], v8 offset:256
    ds_read_b64 v[186:187], v8 offset:384
    s_waitcnt lgkmcnt(0)
    v_add_f32 v180, v180, v182
    v_add_f32 v181, v181, v183
    v_add_f32 v184, v184, v186
    v_add_f32 v185, v185, v187
    v_add_f32 v176, v180, v184
    v_add_f32 v177, v181, v185
    v_mul_f32 v176, 0x3b000000, v176
    v_mul_f32 v177, 0x3b000000, v177
    v_fma_f32 v177, -v176, v176, v177
    v_max_f32 v177, 0, v177
    v_add_f32 v177, 0x3727c5ac, v177
    v_rsq_f32 v177, v177
    s_nop 0
    v_lshlrev_b32 v178, 16, v144
    v_and_b32 v179, 0xffff0000, v144
    v_sub_f32 v178, v178, v176
    v_sub_f32 v179, v179, v176
    v_mul_f32 v178, v178, v177
    v_mul_f32 v179, v179, v177
    v_cvt_pk_bf16_f32 v160, v178, v179
    v_lshlrev_b32 v178, 16, v145
    v_and_b32 v179, 0xffff0000, v145
    v_sub_f32 v178, v178, v176
    v_sub_f32 v179, v179, v176
    v_mul_f32 v178, v178, v177
    v_mul_f32 v179, v179, v177
    v_cvt_pk_bf16_f32 v161, v178, v179
    v_lshlrev_b32 v178, 16, v146
    v_and_b32 v179, 0xffff0000, v146
    v_sub_f32 v178, v178, v176
    v_sub_f32 v179, v179, v176
    v_mul_f32 v178, v178, v177
    v_mul_f32 v179, v179, v177
    v_cvt_pk_bf16_f32 v162, v178, v179
    v_lshlrev_b32 v178, 16, v147
    v_and_b32 v179, 0xffff0000, v147
    v_sub_f32 v178, v178, v176
    v_sub_f32 v179, v179, v176
    v_mul_f32 v178, v178, v177
    v_mul_f32 v179, v179, v177
    v_cvt_pk_bf16_f32 v163, v178, v179
    v_lshlrev_b32 v178, 16, v148
    v_and_b32 v179, 0xffff0000, v148
    v_sub_f32 v178, v178, v176
    v_sub_f32 v179, v179, v176
    v_mul_f32 v178, v178, v177
    v_mul_f32 v179, v179, v177
    v_cvt_pk_bf16_f32 v164, v178, v179
    v_lshlrev_b32 v178, 16, v149
    v_and_b32 v179, 0xffff0000, v149
    v_sub_f32 v178, v178, v176
    v_sub_f32 v179, v179, v176
    v_mul_f32 v178, v178, v177
    v_mul_f32 v179, v179, v177
    v_cvt_pk_bf16_f32 v165, v178, v179
    v_lshlrev_b32 v178, 16, v150
    v_and_b32 v179, 0xffff0000, v150
    v_sub_f32 v178, v178, v176
    v_sub_f32 v179, v179, v176
    v_mul_f32 v178, v178, v177
    v_mul_f32 v179, v179, v177
    v_cvt_pk_bf16_f32 v166, v178, v179
    v_lshlrev_b32 v178, 16, v151
    v_and_b32 v179, 0xffff0000, v151
    v_sub_f32 v178, v178, v176
    v_sub_f32 v179, v179, v176
    v_mul_f32 v178, v178, v177
    v_mul_f32 v179, v179, v177
    v_cvt_pk_bf16_f32 v167, v178, v179
    v_lshlrev_b32 v178, 16, v152
    v_and_b32 v179, 0xffff0000, v152
    v_sub_f32 v178, v178, v176
    v_sub_f32 v179, v179, v176
    v_mul_f32 v178, v178, v177
    v_mul_f32 v179, v179, v177
    v_cvt_pk_bf16_f32 v168, v178, v179
    v_lshlrev_b32 v178, 16, v153
    v_and_b32 v179, 0xffff0000, v153
    v_sub_f32 v178, v178, v176
    v_sub_f32 v179, v179, v176
    v_mul_f32 v178, v178, v177
    v_mul_f32 v179, v179, v177
    v_cvt_pk_bf16_f32 v169, v178, v179
    v_lshlrev_b32 v178, 16, v154
    v_and_b32 v179, 0xffff0000, v154
    v_sub_f32 v178, v178, v176
    v_sub_f32 v179, v179, v176
    v_mul_f32 v178, v178, v177
    v_mul_f32 v179, v179, v177
    v_cvt_pk_bf16_f32 v170, v178, v179
    v_lshlrev_b32 v178, 16, v155
    v_and_b32 v179, 0xffff0000, v155
    v_sub_f32 v178, v178, v176
    v_sub_f32 v179, v179, v176
    v_mul_f32 v178, v178, v177
    v_mul_f32 v179, v179, v177
    v_cvt_pk_bf16_f32 v171, v178, v179
    v_lshlrev_b32 v178, 16, v156
    v_and_b32 v179, 0xffff0000, v156
    v_sub_f32 v178, v178, v176
    v_sub_f32 v179, v179, v176
    v_mul_f32 v178, v178, v177
    v_mul_f32 v179, v179, v177
    v_cvt_pk_bf16_f32 v172, v178, v179
    v_lshlrev_b32 v178, 16, v157
    v_and_b32 v179, 0xffff0000, v157
    v_sub_f32 v178, v178, v176
    v_sub_f32 v179, v179, v176
    v_mul_f32 v178, v178, v177
    v_mul_f32 v179, v179, v177
    v_cvt_pk_bf16_f32 v173, v178, v179
    v_lshlrev_b32 v178, 16, v158
    v_and_b32 v179, 0xffff0000, v158
    v_sub_f32 v178, v178, v176
    v_sub_f32 v179, v179, v176
    v_mul_f32 v178, v178, v177
    v_mul_f32 v179, v179, v177
    v_cvt_pk_bf16_f32 v174, v178, v179
    v_lshlrev_b32 v178, 16, v159
    v_and_b32 v179, 0xffff0000, v159
    v_sub_f32 v178, v178, v176
    v_sub_f32 v179, v179, v176
    v_mul_f32 v178, v178, v177
    v_mul_f32 v179, v179, v177
    v_cvt_pk_bf16_f32 v175, v178, v179
    global_store_dwordx4 v5, v[160:163], s[48:49] offset:0 sc1
    global_store_dwordx4 v5, v[164:167], s[48:49] offset:512 sc1
    global_store_dwordx4 v5, v[168:171], s[48:49] offset:1024 sc1
    global_store_dwordx4 v5, v[172:175], s[48:49] offset:1536 sc1
    s_branch Lt6e_287
Lt6o_286:
    global_store_dwordx4 v6, v[144:147], s[50:51] offset:0 nt
    global_store_dwordx4 v6, v[148:151], s[50:51] offset:16 nt
    global_store_dwordx4 v6, v[152:155], s[50:51] offset:32 nt
    global_store_dwordx4 v6, v[156:159], s[50:51] offset:48 nt
Lt6e_287:
    s_add_u32 s46, s46, 65536
    s_addc_u32 s47, s47, 0
    s_add_u32 s48, s48, 65536
    s_addc_u32 s49, s49, 0
    s_add_u32 s50, s50, 65536
    s_addc_u32 s51, s51, 0
    s_waitcnt vmcnt(0)
    s_barrier
    s_add_u32 s19, s7, 1
    s_cmp_lg_u32 s5, 0
    s_cbranch_scc1 Lpub_288
    v_mov_b32 v3, s19
    s_mov_b64 exec, 1
    global_store_dword v0, v3, s[26:27] sc1
    s_mov_b64 exec, -1
Lpub_288:
    s_add_u32 s7, s7, 2
    s_cmp_lt_u32 s7, 64
    s_cbranch_scc1 LitT6_281
    s_waitcnt vmcnt(0)
    s_endpgm
LtoT6_280:
    s_load_dwordx2 s[30:31], s[0:1], 88
    s_waitcnt lgkmcnt(0)
    s_mov_b64 exec, 1
    v_mov_b32 v2, 164
    v_mov_b32 v3, s7
    v_add_u32 v3, 0x10000, v3
    global_store_dword v2, v3, s[30:31] sc1
    s_waitcnt vmcnt(0)
    s_endpgm
CODE_END:
.section .rodata,"a"
.p2align 6
.amdhsa_kernel interleave_layers__sliding_local_dilated__memory_aug_recurrent_mem_tr__prompt_kernel
.amdhsa_next_free_vgpr 512
.amdhsa_next_free_sgpr 102
.amdhsa_accum_offset 256
.amdhsa_group_segment_fixed_size 0
.amdhsa_kernarg_size 104
.amdhsa_user_sgpr_count 2
.amdhsa_user_sgpr_kernarg_segment_ptr 1
.amdhsa_system_sgpr_workgroup_id_x 1
.amdhsa_float_denorm_mode_32 3
.end_amdhsa_kernel
.text
```
